```python
import torch

def _softmax(x, axis=-1):
    return torch.softmax(x, dim=axis)
def _gelu(x):
    return torch.nn.functional.gelu(x, approximate="tanh")
def _silu(x):
    return torch.nn.functional.silu(x)
def _sigmoid(x):
    return torch.sigmoid(x)
def _layernorm(x, axis=-1, eps=1e-5):
    m = x.mean(dim=axis, keepdim=True)
    v = x.var(dim=axis, keepdim=True, unbiased=False)
    return (x - m) / torch.sqrt(v + eps)
def _scatter_add(tgt, idx, src, axis=0):
    return tgt.clone().index_add_(axis, idx, src)
def _segment_sum(src, seg, n):
    out = torch.zeros((n,) + src.shape[1:], dtype=src.dtype)
    return out.index_add_(0, seg, src)
def _pad(x, pw):
    flat = tuple(v for pair in reversed(pw) for v in pair)
    return torch.nn.functional.pad(x, flat)

kernel_name = 'gated_mix__ssm_conv_s5__linear_kernel_hedgehog__prompt'

def setup_inputs():

    _w = (lambda a: (lambda t: t.to(torch.bfloat16) if t.is_floating_point() else t)(torch.as_tensor(a)))
    def _A_setup():
        B, S, D = 1, 2048, 640
        P = D
        Lambda_re = -0.5 * (lambda _x: torch.exp(torch.as_tensor(_x)))((lambda *s: torch.randn(*s, dtype=torch.bfloat16) * 0.4)(P))
        Lambda_im = (lambda *s: torch.randn(*s, dtype=torch.bfloat16) * 0.4)(P) * 1.0
        B_re = (lambda *s: torch.randn(*s, dtype=torch.bfloat16) * 0.4)(P, D) * (D ** -0.5)
        B_im = (lambda *s: torch.randn(*s, dtype=torch.bfloat16) * 0.4)(P, D) * (D ** -0.5)
        C_re = (lambda *s: torch.randn(*s, dtype=torch.bfloat16) * 0.4)(D, P) * (P ** -0.5)
        C_im = (lambda *s: torch.randn(*s, dtype=torch.bfloat16) * 0.4)(D, P) * (P ** -0.5)
        log_dt = (lambda *s: torch.randn(*s, dtype=torch.bfloat16) * 0.4)(P) * 0.3 - 2.0
        Dskip = (lambda *s: torch.randn(*s, dtype=torch.bfloat16) * 0.05)(D)
        return {
            "x": _w((lambda *s: torch.randn(*s, dtype=torch.bfloat16) * 0.05)(B, S, D)),
            "Lambda_re": _w(Lambda_re),
            "Lambda_im": _w(Lambda_im),
            "B_re": _w(B_re),
            "B_im": _w(B_im),
            "C_re": _w(C_re),
            "C_im": _w(C_im),
            "log_dt": _w(log_dt),
            "Dskip": _w(Dskip),
        }
    _A_in = _A_setup()

    def _B_setup():
        B, S, D, H = 1, 2048, 640, 32
        Dh = D // H
        return {
            "x": _w((lambda *s: torch.randn(*s, dtype=torch.bfloat16) * 0.05)(B, S, D)),
            "wqkv": _w((lambda *s: torch.randn(*s, dtype=torch.bfloat16) * 0.8)(D, 3 * D)),
            "w_phi": _w((lambda *s: torch.randn(*s, dtype=torch.bfloat16) * 0.8)(H, Dh, Dh) * (Dh ** -0.5)),
            "wo": _w((lambda *s: torch.randn(*s, dtype=torch.bfloat16) * 0.05)(D, D)),
        }
    _B_in = _B_setup()

    return {
        "A_x": _A_in["x"],
        "A_Lambda_re": _A_in["Lambda_re"],
        "A_Lambda_im": _A_in["Lambda_im"],
        "A_B_re": _A_in["B_re"],
        "A_B_im": _A_in["B_im"],
        "A_C_re": _A_in["C_re"],
        "A_C_im": _A_in["C_im"],
        "A_log_dt": _A_in["log_dt"],
        "A_Dskip": _A_in["Dskip"],
        "B_x": _B_in["x"],
        "B_wqkv": _B_in["wqkv"],
        "B_w_phi": _B_in["w_phi"],
        "B_wo": _B_in["wo"],
        "gate_w": _w((lambda *s: torch.randn(*s, dtype=torch.bfloat16) * 0.05)(640) * 16.0),
    }

def reference(A_x, A_Lambda_re, A_Lambda_im, A_B_re, A_B_im, A_C_re, A_C_im, A_log_dt, A_Dskip, B_x, B_wqkv, B_w_phi, B_wo, gate_w):
    def _A_ref(x, Lambda_re, Lambda_im, B_re, B_im, C_re, C_im, log_dt, Dskip):
        Bsz, L, H = x.shape
        Lam = Lambda_re + 1j * Lambda_im
        Bmat = B_re + 1j * B_im
        Cmat = C_re + 1j * C_im
        dt = torch.exp(log_dt)
        Lam_bar = torch.exp(dt * Lam)
        B_bar = ((Lam_bar - 1.0) / Lam)[:, None] * Bmat
        Bu = torch.einsum("bld,pd->blp", x + 0j, B_bar)
        h = torch.zeros_like(Bu[:, 0, :])
        hs = []
        for t in range(L):
            h = Lam_bar[None, :] * h + Bu[:, t, :]
            hs.append(h)
        hseq = torch.stack(hs, 1)
        y = 2.0 * torch.einsum("blp,dp->bld", hseq, Cmat).real + x * Dskip[None, None, :]
        return y

    def _B_ref(x, wqkv, w_phi, wo):
        B, S, D = x.shape
        H = 32; Dh = D // H
        qkv = (lambda x, *d: x.permute(*d))((x @ wqkv).reshape(B, S, 3, H, Dh), 2, 0, 3, 1, 4)
        q, k, v = qkv[0], qkv[1], qkv[2]
        pq = torch.einsum("bhsd,hdf->bhsf", q, w_phi)
        pk = torch.einsum("bhsd,hdf->bhsf", k, w_phi)
        phi_q = torch.concatenate([_softmax(pq, axis=-1), _softmax(-pq, axis=-1)], axis=-1)
        phi_k = torch.concatenate([_softmax(pk, axis=-1), _softmax(-pk, axis=-1)], axis=-1)
        kv = torch.einsum("bhsf,bhsd->bhfd", phi_k, v)
        z  = torch.einsum("bhsf->bhf", phi_k)
        num = torch.einsum("bhqf,bhfd->bhqd", phi_q, kv)
        den = torch.einsum("bhqf,bhf->bhq", phi_q, z)[..., None] + 1e-6
        o = num / den
        return (lambda x, *d: x.permute(*d))(o, 0, 2, 1, 3).reshape(B, S, D) @ wo

    x = A_x
    g = _sigmoid((x * gate_w).sum(-1, keepdims=True))
    a = _A_ref(x, A_Lambda_re, A_Lambda_im, A_B_re, A_B_im, A_C_re, A_C_im, A_log_dt, A_Dskip)
    b = _B_ref(x, B_wqkv, B_w_phi, B_wo)
    return g * a + (1 - g) * b
```

```asm
; @launch grid=(256,1,1) block=(512,1,1) lds=163840
.amdgcn_target "amdgcn-amd-amdhsa--gfx950"
.text
.globl gated_mix__ssm_conv_s5__linear_kernel_hedgehog__prompt_kernel
.p2align 8
.type gated_mix__ssm_conv_s5__linear_kernel_hedgehog__prompt_kernel,@function
gated_mix__ssm_conv_s5__linear_kernel_hedgehog__prompt_kernel:
    s_cmp_ge_u32 s2, 256
    s_cbranch_scc1 gated_mix__ssm_conv_s5__linear_kernel_hedgehog__prompt_kernel_end
    s_load_dwordx2 s[24:25], s[0:1], 0
    s_load_dwordx4 s[20:23], s[0:1], 24
    s_load_dwordx2 s[18:19], s[0:1], 80
    v_lshrrev_b32 v1, 6, v0
    s_nop 0
    v_readfirstlane_b32 s3, v1
    s_and_b32 s4, s2, 7
    s_lshr_b32 s5, s2, 3
    s_and_b32 s6, s4, 1
    s_lshl_b32 s6, s6, 3
    s_and_b32 s7, s5, 7
    s_add_u32 s26, s6, s7
    s_lshr_b32 s6, s4, 1
    s_lshl_b32 s6, s6, 2
    s_lshr_b32 s29, s5, 3
    s_add_u32 s28, s6, s29
    s_lshr_b32 s27, s28, 1
    s_add_u32 s30, s7, s29
    s_and_b32 s30, s30, 3
    s_mul_i32 s30, s30, 5
    s_lshr_b32 s30, s30, 1
    s_and_b32 s4, s28, 1
    s_cmp_ge_u32 s3, 4
    s_cbranch_scc1 gated_mix__ssm_conv_s5__linear_kernel_hedgehog__prompt_kernel_loaders
    s_cmp_eq_u32 s4, 0
    s_cbranch_scc1 gated_mix__ssm_conv_s5__linear_kernel_hedgehog__prompt_kernel_cpA
    s_branch gated_mix__ssm_conv_s5__linear_kernel_hedgehog__prompt_kernel_cpB
gated_mix__ssm_conv_s5__linear_kernel_hedgehog__prompt_kernel_loaders:
    s_cmp_eq_u32 s4, 0
    s_cbranch_scc0 gated_mix__ssm_conv_s5__linear_kernel_hedgehog__prompt_kernel_ldB
gated_mix__ssm_conv_s5__linear_kernel_hedgehog__prompt_kernel_ldA:
    s_cmp_lg_u32 s3, 4
    s_cbranch_scc1 gated_mix__ssm_conv_s5__linear_kernel_hedgehog__prompt_kernel_noelect1
    s_cmp_ge_u32 s2, 8
    s_cbranch_scc1 gated_mix__ssm_conv_s5__linear_kernel_hedgehog__prompt_kernel_noelect1
    s_load_dwordx2 s[40:41], s[0:1], 120
    s_memrealtime s[42:43]
    s_waitcnt lgkmcnt(0)
    s_or_b32 s42, s42, 1
    v_mov_b32 v100, s42
    v_mov_b32 v101, s43
    v_mov_b32 v102, 0
    v_mov_b32 v103, 0
    v_mov_b32 v104, 128
    s_mov_b64 s[60:61], exec
    s_mov_b64 exec, 1
    global_atomic_cmpswap_x2 v104, v[100:103], s[40:41] sc1
    s_mov_b64 exec, s[60:61]
gated_mix__ssm_conv_s5__linear_kernel_hedgehog__prompt_kernel_noelect1:
    s_sub_u32 s31, s3, 4
    v_and_b32 v2, 63, v0
    v_lshrrev_b32 v12, 3, v2
    v_and_b32 v13, 3, v12
    v_and_b32 v14, 1, v13
    v_lshlrev_b32 v14, 2, v14
    v_lshrrev_b32 v15, 1, v13
    v_add_u32 v14, v14, v15
    v_lshrrev_b32 v15, 5, v2
    v_lshl_add_u32 v14, v15, 3, v14
    s_and_b32 s62, s31, 1
    s_lshl_b32 s63, s62, 4
    s_and_b32 s4, s31, 2
    s_add_u32 s63, s63, s4
    v_add_u32 v14, s63, v14
    v_mul_u32_u24 v14, 1280, v14
    s_lshl_b32 s63, s62, 2
    v_lshrrev_b32 v15, 4, v2
    v_add_u32 v15, s63, v15
    v_and_b32 v16, 7, v2
    v_xor_b32 v15, v15, v16
    v_lshlrev_b32 v15, 4, v15
    v_add_u32 v3, v14, v15
    s_mul_i32 s4, s26, 163840
    s_lshl_b32 s5, s31, 10
    s_add_u32 s40, s4, 0
    s_add_u32 s84, s5, 0
    s_add_u32 s41, s4, 40960
    s_add_u32 s85, s5, 4096
    s_add_u32 s42, s4, 81920
    s_add_u32 s86, s5, 8192
    s_add_u32 s43, s4, 122880
    s_add_u32 s87, s5, 12288
    s_lshl_b32 s56, s30, 7
    s_mul_i32 s57, s30, 245760
    s_mov_b32 s58, 0
    s_waitcnt lgkmcnt(0)
    s_mov_b32 s8, s24
    s_and_b32 s9, s25, 0xffff
    s_mov_b32 s10, 2621440
    s_mov_b32 s11, 0x20000
    s_add_u32 s62, s40, s56
    s_add_u32 m0, s84, s58
    s_nop 0
    buffer_load_dwordx4 v3, s[8:11], s62 offen lds
    s_add_u32 s62, s41, s56
    s_add_u32 m0, s85, s58
    s_nop 0
    buffer_load_dwordx4 v3, s[8:11], s62 offen lds
    s_add_u32 s62, s42, s56
    s_add_u32 m0, s86, s58
    s_nop 0
    buffer_load_dwordx4 v3, s[8:11], s62 offen lds
    s_add_u32 s62, s43, s56
    s_add_u32 m0, s87, s58
    s_nop 0
    buffer_load_dwordx4 v3, s[8:11], s62 offen lds
    s_and_b32 s62, s31, 1
    s_lshl_b32 s63, s62, 3
    v_add_u32 v14, s63, v12
    v_mul_u32_u24 v14, 1280, v14
    v_add_u32 v4, v14, v15
    s_cmp_ge_u32 s31, 2
    s_cselect_b32 s36, s22, s20
    s_cselect_b32 s37, s23, s21
    s_and_b32 s37, s37, 0xffff
    s_mov_b32 s38, 819200
    s_mov_b32 s39, 0x20000
    s_mul_i32 s4, s27, 102400
    s_add_u32 s44, s4, 0
    s_add_u32 s88, s5, 38912
    s_add_u32 s62, s44, s56
    s_add_u32 m0, s88, s58
    s_nop 0
    buffer_load_dwordx4 v4, s[36:39], s62 offen lds
    s_mov_b32 s12, s18
    s_and_b32 s13, s19, 0xffff
    s_mov_b32 s14, 2457600
    s_mov_b32 s15, 0x20000
    s_add_u32 s62, s31, 0
    s_sub_u32 s63, s62, 11
    s_cmp_ge_u32 s62, 11
    s_cselect_b32 s62, s63, s62
    s_cselect_b32 s4, 1, 0
    s_mul_i32 s45, s4, 1280
    s_add_u32 s45, s45, 1280
    s_mul_i32 s89, s4, 11264
    s_add_u32 s89, s89, 16384
    s_lshl_b32 s63, s62, 10
    s_add_u32 s89, s89, s63
    s_mul_i32 s63, s27, 160
    s_add_u32 s45, s45, s63
    s_lshl_b32 s62, s62, 6
    v_add_u32 v12, s62, v2
    v_mul_u32_u24 v13, 745, v12
    v_lshrrev_b32 v13, 16, v13
    v_mul_u32_u24 v14, 88, v13
    v_sub_u32 v14, v12, v14
    v_mul_u32_u24 v15, 205, v14
    v_lshrrev_b32 v15, 11, v15
    v_mul_u32_u24 v16, 10, v15
    v_sub_u32 v16, v14, v16
    v_lshl_add_u32 v15, v13, 3, v15
    v_mul_u32_u24 v15, 3840, v15
    v_lshl_add_u32 v15, v16, 4, v15
    v_cmp_gt_u32 vcc, 80, v14
    v_mov_b32 v16, 0x7fffffff
    s_nop 0
    v_cndmask_b32 v6, v16, v15, vcc
    s_add_u32 s62, s45, s57
    s_add_u32 m0, s89, s58
    s_nop 0
    buffer_load_dwordx4 v6, s[12:15], s62 offen lds
    s_add_u32 s62, s31, 4
    s_sub_u32 s63, s62, 11
    s_cmp_ge_u32 s62, 11
    s_cselect_b32 s62, s63, s62
    s_cselect_b32 s4, 1, 0
    s_mul_i32 s46, s4, 1280
    s_add_u32 s46, s46, 1280
    s_mul_i32 s90, s4, 11264
    s_add_u32 s90, s90, 16384
    s_lshl_b32 s63, s62, 10
    s_add_u32 s90, s90, s63
    s_mul_i32 s63, s27, 160
    s_add_u32 s46, s46, s63
    s_lshl_b32 s62, s62, 6
    v_add_u32 v12, s62, v2
    v_mul_u32_u24 v13, 745, v12
    v_lshrrev_b32 v13, 16, v13
    v_mul_u32_u24 v14, 88, v13
    v_sub_u32 v14, v12, v14
    v_mul_u32_u24 v15, 205, v14
    v_lshrrev_b32 v15, 11, v15
    v_mul_u32_u24 v16, 10, v15
    v_sub_u32 v16, v14, v16
    v_lshl_add_u32 v15, v13, 3, v15
    v_mul_u32_u24 v15, 3840, v15
    v_lshl_add_u32 v15, v16, 4, v15
    v_cmp_gt_u32 vcc, 80, v14
    v_mov_b32 v16, 0x7fffffff
    s_nop 0
    v_cndmask_b32 v7, v16, v15, vcc
    s_add_u32 s62, s46, s57
    s_add_u32 m0, s90, s58
    s_nop 0
    buffer_load_dwordx4 v7, s[12:15], s62 offen lds
    s_add_u32 s62, s31, 8
    s_sub_u32 s63, s62, 11
    s_cmp_ge_u32 s62, 11
    s_cselect_b32 s62, s63, s62
    s_cselect_b32 s4, 1, 0
    s_mul_i32 s47, s4, 1280
    s_add_u32 s47, s47, 1280
    s_mul_i32 s91, s4, 11264
    s_add_u32 s91, s91, 16384
    s_lshl_b32 s63, s62, 10
    s_add_u32 s91, s91, s63
    s_mul_i32 s63, s27, 160
    s_add_u32 s47, s47, s63
    s_lshl_b32 s62, s62, 6
    v_add_u32 v12, s62, v2
    v_mul_u32_u24 v13, 745, v12
    v_lshrrev_b32 v13, 16, v13
    v_mul_u32_u24 v14, 88, v13
    v_sub_u32 v14, v12, v14
    v_mul_u32_u24 v15, 205, v14
    v_lshrrev_b32 v15, 11, v15
    v_mul_u32_u24 v16, 10, v15
    v_sub_u32 v16, v14, v16
    v_lshl_add_u32 v15, v13, 3, v15
    v_mul_u32_u24 v15, 3840, v15
    v_lshl_add_u32 v15, v16, 4, v15
    v_cmp_gt_u32 vcc, 80, v14
    v_mov_b32 v16, 0x7fffffff
    s_nop 0
    v_cndmask_b32 v8, v16, v15, vcc
    s_add_u32 s62, s47, s57
    s_add_u32 m0, s91, s58
    s_nop 0
    buffer_load_dwordx4 v8, s[12:15], s62 offen lds
    s_add_u32 s62, s31, 12
    s_sub_u32 s63, s62, 11
    s_cmp_ge_u32 s62, 11
    s_cselect_b32 s62, s63, s62
    s_cselect_b32 s4, 1, 0
    s_mul_i32 s48, s4, 1280
    s_add_u32 s48, s48, 1280
    s_mul_i32 s92, s4, 11264
    s_add_u32 s92, s92, 16384
    s_lshl_b32 s63, s62, 10
    s_add_u32 s92, s92, s63
    s_mul_i32 s63, s27, 160
    s_add_u32 s48, s48, s63
    s_lshl_b32 s62, s62, 6
    v_add_u32 v12, s62, v2
    v_mul_u32_u24 v13, 745, v12
    v_lshrrev_b32 v13, 16, v13
    v_mul_u32_u24 v14, 88, v13
    v_sub_u32 v14, v12, v14
    v_mul_u32_u24 v15, 205, v14
    v_lshrrev_b32 v15, 11, v15
    v_mul_u32_u24 v16, 10, v15
    v_sub_u32 v16, v14, v16
    v_lshl_add_u32 v15, v13, 3, v15
    v_mul_u32_u24 v15, 3840, v15
    v_lshl_add_u32 v15, v16, 4, v15
    v_cmp_gt_u32 vcc, 80, v14
    v_mov_b32 v16, 0x7fffffff
    s_nop 0
    v_cndmask_b32 v9, v16, v15, vcc
    s_add_u32 s62, s48, s57
    s_add_u32 m0, s92, s58
    s_nop 0
    buffer_load_dwordx4 v9, s[12:15], s62 offen lds
    s_add_u32 s62, s31, 16
    s_sub_u32 s63, s62, 11
    s_cmp_ge_u32 s62, 11
    s_cselect_b32 s62, s63, s62
    s_cselect_b32 s4, 1, 0
    s_mul_i32 s49, s4, 1280
    s_add_u32 s49, s49, 1280
    s_mul_i32 s93, s4, 11264
    s_add_u32 s93, s93, 16384
    s_lshl_b32 s63, s62, 10
    s_add_u32 s93, s93, s63
    s_mul_i32 s63, s27, 160
    s_add_u32 s49, s49, s63
    s_lshl_b32 s62, s62, 6
    v_add_u32 v12, s62, v2
    v_mul_u32_u24 v13, 745, v12
    v_lshrrev_b32 v13, 16, v13
    v_mul_u32_u24 v14, 88, v13
    v_sub_u32 v14, v12, v14
    v_mul_u32_u24 v15, 205, v14
    v_lshrrev_b32 v15, 11, v15
    v_mul_u32_u24 v16, 10, v15
    v_sub_u32 v16, v14, v16
    v_lshl_add_u32 v15, v13, 3, v15
    v_mul_u32_u24 v15, 3840, v15
    v_lshl_add_u32 v15, v16, 4, v15
    v_cmp_gt_u32 vcc, 80, v14
    v_mov_b32 v16, 0x7fffffff
    s_nop 0
    v_cndmask_b32 v10, v16, v15, vcc
    s_add_u32 s62, s49, s57
    s_add_u32 m0, s93, s58
    s_nop 0
    buffer_load_dwordx4 v10, s[12:15], s62 offen lds
    s_add_u32 s62, s31, 20
    s_sub_u32 s63, s62, 11
    s_cmp_ge_u32 s62, 11
    s_cselect_b32 s62, s63, s62
    s_cselect_b32 s4, 1, 0
    s_mul_i32 s50, s4, 1280
    s_add_u32 s50, s50, 1280
    s_mul_i32 s94, s4, 11264
    s_add_u32 s94, s94, 16384
    s_lshl_b32 s63, s62, 10
    s_add_u32 s94, s94, s63
    s_mul_i32 s63, s27, 160
    s_add_u32 s50, s50, s63
    s_lshl_b32 s62, s62, 6
    v_add_u32 v12, s62, v2
    v_mul_u32_u24 v13, 745, v12
    v_lshrrev_b32 v13, 16, v13
    v_mul_u32_u24 v14, 88, v13
    v_sub_u32 v14, v12, v14
    v_mul_u32_u24 v15, 205, v14
    v_lshrrev_b32 v15, 11, v15
    v_mul_u32_u24 v16, 10, v15
    v_sub_u32 v16, v14, v16
    v_lshl_add_u32 v15, v13, 3, v15
    v_mul_u32_u24 v15, 3840, v15
    v_lshl_add_u32 v15, v16, 4, v15
    v_cmp_gt_u32 vcc, 80, v14
    v_mov_b32 v16, 0x7fffffff
    s_nop 0
    v_cndmask_b32 v11, v16, v15, vcc
    s_cmp_ge_u32 s31, 2
    s_cbranch_scc1 gated_mix__ssm_conv_s5__linear_kernel_hedgehog__prompt_kernel_skipdma2
    s_add_u32 s62, s50, s57
    s_add_u32 m0, s94, s58
    s_nop 0
    buffer_load_dwordx4 v11, s[12:15], s62 offen lds
gated_mix__ssm_conv_s5__linear_kernel_hedgehog__prompt_kernel_skipdma2:
    s_add_u32 s56, s56, 128
    s_add_u32 s57, s57, 245760
    s_cmp_ge_u32 s56, 1280
    s_cselect_b32 s56, 0, s56
    s_cselect_b32 s57, 0, s57
    s_add_u32 s58, s58, 44032
    s_cmp_ge_u32 s58, 132096
    s_cselect_b32 s58, 0, s58
    s_mov_b32 s59, -2
    s_mov_b32 s83, 7
gated_mix__ssm_conv_s5__linear_kernel_hedgehog__prompt_kernel_ldloop3:
    s_cmp_eq_u32 s59, -2
    s_cbranch_scc1 gated_mix__ssm_conv_s5__linear_kernel_hedgehog__prompt_kernel_ldb04
    s_waitcnt vmcnt(10)
    s_barrier
gated_mix__ssm_conv_s5__linear_kernel_hedgehog__prompt_kernel_ldb04:
    s_add_u32 s62, s40, s56
    s_add_u32 m0, s84, s58
    s_nop 0
    buffer_load_dwordx4 v3, s[8:11], s62 offen lds
    s_add_u32 s62, s41, s56
    s_add_u32 m0, s85, s58
    s_nop 0
    buffer_load_dwordx4 v3, s[8:11], s62 offen lds
    s_add_u32 s62, s42, s56
    s_add_u32 m0, s86, s58
    s_nop 0
    buffer_load_dwordx4 v3, s[8:11], s62 offen lds
    s_add_u32 s62, s43, s56
    s_add_u32 m0, s87, s58
    s_nop 0
    buffer_load_dwordx4 v3, s[8:11], s62 offen lds
    s_add_u32 s62, s44, s56
    s_add_u32 m0, s88, s58
    s_nop 0
    buffer_load_dwordx4 v4, s[36:39], s62 offen lds
    s_add_u32 s62, s45, s57
    s_add_u32 m0, s89, s58
    s_nop 0
    buffer_load_dwordx4 v6, s[12:15], s62 offen lds
    s_add_u32 s62, s46, s57
    s_add_u32 m0, s90, s58
    s_nop 0
    buffer_load_dwordx4 v7, s[12:15], s62 offen lds
    s_add_u32 s62, s47, s57
    s_add_u32 m0, s91, s58
    s_nop 0
    buffer_load_dwordx4 v8, s[12:15], s62 offen lds
    s_add_u32 s62, s48, s57
    s_add_u32 m0, s92, s58
    s_nop 0
    buffer_load_dwordx4 v9, s[12:15], s62 offen lds
    s_add_u32 s62, s49, s57
    s_add_u32 m0, s93, s58
    s_nop 0
    buffer_load_dwordx4 v10, s[12:15], s62 offen lds
    s_cmp_ge_u32 s31, 2
    s_cbranch_scc1 gated_mix__ssm_conv_s5__linear_kernel_hedgehog__prompt_kernel_skipdma5
    s_add_u32 s62, s50, s57
    s_add_u32 m0, s94, s58
    s_nop 0
    buffer_load_dwordx4 v11, s[12:15], s62 offen lds
gated_mix__ssm_conv_s5__linear_kernel_hedgehog__prompt_kernel_skipdma5:
    s_add_u32 s56, s56, 128
    s_add_u32 s57, s57, 245760
    s_cmp_ge_u32 s56, 1280
    s_cselect_b32 s56, 0, s56
    s_cselect_b32 s57, 0, s57
    s_add_u32 s58, s58, 44032
    s_cmp_ge_u32 s58, 132096
    s_cselect_b32 s58, 0, s58
    s_add_u32 s59, s59, 1
    s_cmp_lg_u32 s59, s83
    s_cbranch_scc1 gated_mix__ssm_conv_s5__linear_kernel_hedgehog__prompt_kernel_ldloop3
    s_cmp_eq_u32 s3, 4
    s_cbranch_scc1 gated_mix__ssm_conv_s5__linear_kernel_hedgehog__prompt_kernel_helper6
    v_and_b32 v120, 63, v0
    v_and_b32 v121, 15, v0
    v_bfe_u32 v122, v0, 4, 2
    v_lshlrev_b32 v123, 4, v120
    v_mov_b32 v139, 0x7fffffff
    s_and_b32 s98, s2, 7
    s_lshr_b32 s99, s2, 3
    s_and_b32 s100, s99, 7
    s_lshr_b32 s99, s99, 3
    s_lshl_b32 s98, s98, 2
    s_add_u32 s98, s98, s99
    s_sub_u32 s99, s3, 5
    s_lshl_b32 s99, s99, 5
    s_add_u32 s98, s98, s99
    s_mul_i32 s99, s100, 40
    s_add_u32 s99, s99, s98
    s_mul_i32 s100, s100, 20
    s_add_u32 s100, s100, s98
    s_add_u32 s100, s100, 280
    s_cmp_lt_u32 s98, 40
    s_cselect_b32 s29, s99, s100
    s_cmp_ge_u32 s98, 60
    s_cselect_b32 s29, 999, s29
    s_mov_b32 s95, 0
    s_cmp_eq_u32 s3, 7
    s_cbranch_scc1 gated_mix__ssm_conv_s5__linear_kernel_hedgehog__prompt_kernel_sg8
    s_cmp_ge_u32 s29, 320
    s_cbranch_scc1 gated_mix__ssm_conv_s5__linear_kernel_hedgehog__prompt_kernel_sw7
    s_mov_b32 s95, 1
    s_load_dwordx4 s[16:19], s[0:1], 40
    s_load_dwordx4 s[20:23], s[0:1], 8
    s_load_dwordx2 s[24:25], s[0:1], 56
    s_mul_i32 s30, s29, 1639
    s_lshr_b32 s30, s30, 16
    s_mul_i32 s60, s30, 40
    s_sub_u32 s60, s29, s60
    s_mul_i32 s61, s30, 5
    v_mul_u32_u24 v128, 1280, v121
    v_and_b32 v129, 1, v122
    v_lshl_add_u32 v128, v129, 4, v128
    s_lshl_b32 s30, s60, 5
    v_lshl_add_u32 v124, v121, 1, s30
    s_mul_i32 s51, s61, 20480
    s_add_u32 s51, s51, s30
    s_waitcnt lgkmcnt(0)
    s_mov_b32 s32, s16
    s_and_b32 s33, s17, 0xffff
    s_mov_b32 s34, 819200
    s_mov_b32 s35, 0x20000
    s_mov_b32 s52, s18
    s_and_b32 s53, s19, 0xffff
    s_mov_b32 s54, 819200
    s_mov_b32 s55, 0x20000
    s_add_u32 s30, s51, 0
    buffer_load_dwordx4 v[32:35], v128, s[32:35], s30 offen
    buffer_load_dwordx4 v[36:39], v128, s[52:55], s30 offen
    s_add_u32 s30, s51, 20480
    buffer_load_dwordx4 v[40:43], v128, s[32:35], s30 offen
    buffer_load_dwordx4 v[44:47], v128, s[52:55], s30 offen
    s_add_u32 s30, s51, 40960
    buffer_load_dwordx4 v[48:51], v128, s[32:35], s30 offen
    buffer_load_dwordx4 v[52:55], v128, s[52:55], s30 offen
    s_add_u32 s30, s51, 61440
    buffer_load_dwordx4 v[56:59], v128, s[32:35], s30 offen
    buffer_load_dwordx4 v[60:63], v128, s[52:55], s30 offen
    s_add_u32 s30, s51, 81920
    buffer_load_dwordx4 v[64:67], v128, s[32:35], s30 offen
    buffer_load_dwordx4 v[68:71], v128, s[52:55], s30 offen
    s_mov_b32 s72, s20
    s_and_b32 s73, s21, 0xffff
    s_mov_b32 s74, 1280
    s_mov_b32 s75, 0x20000
    s_mov_b32 s76, s22
    s_and_b32 s77, s23, 0xffff
    s_mov_b32 s78, 1280
    s_mov_b32 s79, 0x20000
    s_mov_b32 s68, s24
    s_and_b32 s69, s25, 0xffff
    s_mov_b32 s70, 1280
    s_mov_b32 s71, 0x20000
    buffer_load_ushort v125, v124, s[72:75], 0 offen
    buffer_load_ushort v126, v124, s[76:79], 0 offen
    buffer_load_ushort v127, v124, s[68:71], 0 offen
    s_waitcnt vmcnt(23)
    s_barrier
    s_waitcnt vmcnt(13)
    s_barrier
    s_branch gated_mix__ssm_conv_s5__linear_kernel_hedgehog__prompt_kernel_pend13
gated_mix__ssm_conv_s5__linear_kernel_hedgehog__prompt_kernel_sw7:
    s_cmp_ge_u32 s29, 480
    s_cbranch_scc1 gated_mix__ssm_conv_s5__linear_kernel_hedgehog__prompt_kernel_p4012
    s_mov_b32 s95, 2
    s_load_dwordx2 s[16:17], s[0:1], 96
    s_sub_u32 s29, s29, 320
    s_mul_i32 s30, s29, 3277
    s_lshr_b32 s30, s30, 16
    s_mul_i32 s60, s30, 20
    s_sub_u32 s60, s29, s60
    s_mul_i32 s61, s30, 5
    s_lshr_b32 s30, s60, 1
    s_mul_i32 s30, s30, 80
    s_and_b32 s51, s60, 1
    s_lshl_b32 s51, s51, 3
    s_add_u32 s30, s30, s51
    s_sub_u32 s51, s60, 16
    s_mul_i32 s51, s51, 160
    s_add_u32 s51, s51, 16
    s_cmp_lt_u32 s60, 16
    s_cselect_b32 s30, s30, s51
    s_cselect_b32 s82, 4, 80
    v_mul_u32_u24 v128, 25600, v122
    v_lshl_add_u32 v128, v121, 1, v128
    s_mul_i32 s30, s30, 1280
    s_lshl_b32 s51, s61, 5
    s_add_u32 s30, s30, s51
    s_mul_i32 s82, s82, 1280
    s_waitcnt lgkmcnt(0)
    s_mov_b32 s32, s16
    s_and_b32 s33, s17, 0xffff
    s_mov_b32 s34, 819200
    s_mov_b32 s35, 0x20000
    s_add_u32 s51, s30, 0
    buffer_load_ushort v32, v128, s[32:35], s51 offen
    s_add_u32 s51, s30, 1280
    buffer_load_ushort v33, v128, s[32:35], s51 offen
    s_add_u32 s51, s30, 2560
    buffer_load_ushort v34, v128, s[32:35], s51 offen
    s_add_u32 s51, s30, 3840
    buffer_load_ushort v35, v128, s[32:35], s51 offen
    s_add_u32 s51, s30, s82
    s_add_u32 s51, s51, 0
    buffer_load_ushort v36, v128, s[32:35], s51 offen
    s_add_u32 s51, s30, s82
    s_add_u32 s51, s51, 1280
    buffer_load_ushort v37, v128, s[32:35], s51 offen
    s_add_u32 s51, s30, s82
    s_add_u32 s51, s51, 2560
    buffer_load_ushort v38, v128, s[32:35], s51 offen
    s_add_u32 s51, s30, s82
    s_add_u32 s51, s51, 3840
    buffer_load_ushort v39, v128, s[32:35], s51 offen
    s_add_u32 s51, s30, 32
    buffer_load_ushort v40, v128, s[32:35], s51 offen
    s_add_u32 s51, s30, 1312
    buffer_load_ushort v41, v128, s[32:35], s51 offen
    s_add_u32 s51, s30, 2592
    buffer_load_ushort v42, v128, s[32:35], s51 offen
    s_add_u32 s51, s30, 3872
    buffer_load_ushort v43, v128, s[32:35], s51 offen
    s_add_u32 s51, s30, s82
    s_add_u32 s51, s51, 32
    buffer_load_ushort v44, v128, s[32:35], s51 offen
    s_add_u32 s51, s30, s82
    s_add_u32 s51, s51, 1312
    buffer_load_ushort v45, v128, s[32:35], s51 offen
    s_add_u32 s51, s30, s82
    s_add_u32 s51, s51, 2592
    buffer_load_ushort v46, v128, s[32:35], s51 offen
    s_add_u32 s51, s30, s82
    s_add_u32 s51, s51, 3872
    buffer_load_ushort v47, v128, s[32:35], s51 offen
    s_add_u32 s51, s30, 64
    buffer_load_ushort v48, v128, s[32:35], s51 offen
    s_add_u32 s51, s30, 1344
    buffer_load_ushort v49, v128, s[32:35], s51 offen
    s_add_u32 s51, s30, 2624
    buffer_load_ushort v50, v128, s[32:35], s51 offen
    s_add_u32 s51, s30, 3904
    buffer_load_ushort v51, v128, s[32:35], s51 offen
    s_add_u32 s51, s30, s82
    s_add_u32 s51, s51, 64
    buffer_load_ushort v52, v128, s[32:35], s51 offen
    s_add_u32 s51, s30, s82
    s_add_u32 s51, s51, 1344
    buffer_load_ushort v53, v128, s[32:35], s51 offen
    s_add_u32 s51, s30, s82
    s_add_u32 s51, s51, 2624
    buffer_load_ushort v54, v128, s[32:35], s51 offen
    s_add_u32 s51, s30, s82
    s_add_u32 s51, s51, 3904
    buffer_load_ushort v55, v128, s[32:35], s51 offen
    s_add_u32 s51, s30, 96
    buffer_load_ushort v56, v128, s[32:35], s51 offen
    s_add_u32 s51, s30, 1376
    buffer_load_ushort v57, v128, s[32:35], s51 offen
    s_add_u32 s51, s30, 2656
    buffer_load_ushort v58, v128, s[32:35], s51 offen
    s_add_u32 s51, s30, 3936
    buffer_load_ushort v59, v128, s[32:35], s51 offen
    s_add_u32 s51, s30, s82
    s_add_u32 s51, s51, 96
    buffer_load_ushort v60, v128, s[32:35], s51 offen
    s_add_u32 s51, s30, s82
    s_add_u32 s51, s51, 1376
    buffer_load_ushort v61, v128, s[32:35], s51 offen
    s_add_u32 s51, s30, s82
    s_add_u32 s51, s51, 2656
    buffer_load_ushort v62, v128, s[32:35], s51 offen
    s_add_u32 s51, s30, s82
    s_add_u32 s51, s51, 3936
    buffer_load_ushort v63, v128, s[32:35], s51 offen
    s_add_u32 s51, s30, 128
    buffer_load_ushort v64, v128, s[32:35], s51 offen
    s_add_u32 s51, s30, 1408
    buffer_load_ushort v65, v128, s[32:35], s51 offen
    s_add_u32 s51, s30, 2688
    buffer_load_ushort v66, v128, s[32:35], s51 offen
    s_add_u32 s51, s30, 3968
    buffer_load_ushort v67, v128, s[32:35], s51 offen
    s_add_u32 s51, s30, s82
    s_add_u32 s51, s51, 128
    buffer_load_ushort v68, v128, s[32:35], s51 offen
    s_add_u32 s51, s30, s82
    s_add_u32 s51, s51, 1408
    buffer_load_ushort v69, v128, s[32:35], s51 offen
    s_add_u32 s51, s30, s82
    s_add_u32 s51, s51, 2688
    buffer_load_ushort v70, v128, s[32:35], s51 offen
    s_add_u32 s51, s30, s82
    s_add_u32 s51, s51, 3968
    buffer_load_ushort v71, v128, s[32:35], s51 offen
    s_waitcnt vmcnt(50)
    s_barrier
    s_waitcnt vmcnt(40)
    s_barrier
    s_branch gated_mix__ssm_conv_s5__linear_kernel_hedgehog__prompt_kernel_pend13
gated_mix__ssm_conv_s5__linear_kernel_hedgehog__prompt_kernel_sg8:
    s_mov_b32 s95, 3
    s_load_dwordx2 s[16:17], s[0:1], 0
    s_load_dwordx2 s[18:19], s[0:1], 104
    s_lshl_b32 s29, s26, 4
    s_add_u32 s29, s29, s28
    s_mul_i32 s30, s29, 10240
    v_lshrrev_b32 v124, 3, v120
    v_and_b32 v125, 7, v120
    v_lshlrev_b32 v129, 4, v125
    v_mul_u32_u24 v128, 1280, v124
    v_add_u32 v128, v128, v129
    s_waitcnt lgkmcnt(0)
    s_mov_b32 s32, s16
    s_and_b32 s33, s17, 0xffff
    s_mov_b32 s34, 2621440
    s_mov_b32 s35, 0x20000
    s_mov_b32 s52, s18
    s_and_b32 s53, s19, 0xffff
    s_mov_b32 s54, 1280
    s_mov_b32 s55, 0x20000
    buffer_load_dwordx4 v[32:35], v128, s[32:35], s30 offen offset:0
    buffer_load_dwordx4 v[72:75], v129, s[52:55], 0 offen offset:0
    buffer_load_dwordx4 v[36:39], v128, s[32:35], s30 offen offset:128
    buffer_load_dwordx4 v[76:79], v129, s[52:55], 0 offen offset:128
    buffer_load_dwordx4 v[40:43], v128, s[32:35], s30 offen offset:256
    buffer_load_dwordx4 v[80:83], v129, s[52:55], 0 offen offset:256
    buffer_load_dwordx4 v[44:47], v128, s[32:35], s30 offen offset:384
    buffer_load_dwordx4 v[84:87], v129, s[52:55], 0 offen offset:384
    buffer_load_dwordx4 v[48:51], v128, s[32:35], s30 offen offset:512
    buffer_load_dwordx4 v[88:91], v129, s[52:55], 0 offen offset:512
    buffer_load_dwordx4 v[52:55], v128, s[32:35], s30 offen offset:640
    buffer_load_dwordx4 v[92:95], v129, s[52:55], 0 offen offset:640
    buffer_load_dwordx4 v[56:59], v128, s[32:35], s30 offen offset:768
    buffer_load_dwordx4 v[96:99], v129, s[52:55], 0 offen offset:768
    buffer_load_dwordx4 v[60:63], v128, s[32:35], s30 offen offset:896
    buffer_load_dwordx4 v[100:103], v129, s[52:55], 0 offen offset:896
    buffer_load_dwordx4 v[64:67], v128, s[32:35], s30 offen offset:1024
    buffer_load_dwordx4 v[104:107], v129, s[52:55], 0 offen offset:1024
    buffer_load_dwordx4 v[68:71], v128, s[32:35], s30 offen offset:1152
    buffer_load_dwordx4 v[108:111], v129, s[52:55], 0 offen offset:1152
    s_waitcnt vmcnt(30)
    s_barrier
    s_waitcnt vmcnt(20)
    s_barrier
    s_branch gated_mix__ssm_conv_s5__linear_kernel_hedgehog__prompt_kernel_pend13
gated_mix__ssm_conv_s5__linear_kernel_hedgehog__prompt_kernel_p4012:
    s_waitcnt vmcnt(10)
    s_barrier
    s_waitcnt vmcnt(0)
    s_barrier
gated_mix__ssm_conv_s5__linear_kernel_hedgehog__prompt_kernel_pend13:
    s_load_dwordx2 s[16:17], s[0:1], 128
    s_waitcnt vmcnt(0) lgkmcnt(0)
    s_mov_b32 s8, s16
    s_and_b32 s9, s17, 0xffff
    s_mov_b32 s10, 20971520
    s_mov_b32 s11, 0x20000
    s_cmp_eq_u32 s95, 2
    s_cbranch_scc1 gated_mix__ssm_conv_s5__linear_kernel_hedgehog__prompt_kernel_fw14
    s_cmp_eq_u32 s95, 3
    s_cbranch_scc1 gated_mix__ssm_conv_s5__linear_kernel_hedgehog__prompt_kernel_fg15
    s_cmp_eq_u32 s95, 0
    s_cbranch_scc1 gated_mix__ssm_conv_s5__linear_kernel_hedgehog__prompt_kernel_fn16
    v_lshlrev_b32 v125, 16, v125
    v_lshlrev_b32 v126, 16, v126
    v_lshlrev_b32 v127, 16, v127
    v_mul_f32 v132, 0x3fb8aa3b, v127
    v_exp_f32 v132, v132
    s_nop 0
    v_cvt_pk_bf16_f32 v132, v132, v132
    v_lshlrev_b32 v132, 16, v132
    v_mul_f32 v133, v132, v126
    v_mul_f32 v132, v132, v125
    v_mul_f32 v132, 0x3fb8aa3b, v132
    v_exp_f32 v132, v132
    v_mul_f32 v133, 0x3e22f983, v133
    v_rndne_f32 v130, v133
    v_sub_f32 v133, v133, v130
    v_cos_f32 v130, v133
    v_sin_f32 v131, v133
    v_mul_f32 v130, v130, v132
    v_mul_f32 v131, v131, v132
    v_add_f32 v130, -1.0, v130
    v_mul_f32 v132, v125, v125
    v_fmac_f32 v132, v126, v126
    v_rcp_f32 v132, v132
    v_mul_f32 v134, v130, v125
    v_fmac_f32 v134, v131, v126
    v_mul_f32 v135, v131, v125
    v_fma_f32 v135, -v130, v126, v135
    v_add_f32 v132, v132, v132
    v_mul_f32 v134, v134, v132
    v_mul_f32 v135, v135, v132
    s_sub_u32 s30, s3, 5
    s_lshl_b32 s30, s30, 7
    s_add_u32 s30, s30, 152576
    v_lshl_add_u32 v136, v121, 3, s30
    ds_write_b64 v136, v[134:135]
    v_lshl_add_u32 v136, v129, 6, s30
    s_waitcnt lgkmcnt(0)
    ds_read_b128 v[80:83], v136 offset:0
    ds_read_b128 v[84:87], v136 offset:16
    ds_read_b128 v[88:91], v136 offset:32
    ds_read_b128 v[92:95], v136 offset:48
    v_cmp_gt_u32 vcc, 2, v122
    s_waitcnt lgkmcnt(0)
    v_sub_f32 v130, 0, v81
    v_sub_f32 v131, 0, v80
    v_cndmask_b32 v80, v130, v80, vcc
    v_cndmask_b32 v81, v131, v130, vcc
    v_sub_f32 v130, 0, v83
    v_sub_f32 v131, 0, v82
    v_cndmask_b32 v82, v130, v82, vcc
    v_cndmask_b32 v83, v131, v130, vcc
    v_sub_f32 v130, 0, v85
    v_sub_f32 v131, 0, v84
    v_cndmask_b32 v84, v130, v84, vcc
    v_cndmask_b32 v85, v131, v130, vcc
    v_sub_f32 v130, 0, v87
    v_sub_f32 v131, 0, v86
    v_cndmask_b32 v86, v130, v86, vcc
    v_cndmask_b32 v87, v131, v130, vcc
    v_sub_f32 v130, 0, v89
    v_sub_f32 v131, 0, v88
    v_cndmask_b32 v88, v130, v88, vcc
    v_cndmask_b32 v89, v131, v130, vcc
    v_sub_f32 v130, 0, v91
    v_sub_f32 v131, 0, v90
    v_cndmask_b32 v90, v130, v90, vcc
    v_cndmask_b32 v91, v131, v130, vcc
    v_sub_f32 v130, 0, v93
    v_sub_f32 v131, 0, v92
    v_cndmask_b32 v92, v130, v92, vcc
    v_cndmask_b32 v93, v131, v130, vcc
    v_sub_f32 v130, 0, v95
    v_sub_f32 v131, 0, v94
    v_cndmask_b32 v94, v130, v94, vcc
    v_cndmask_b32 v95, v131, v130, vcc
    s_mul_i32 s30, s61, 40
    s_add_u32 s30, s30, s60
    s_lshl_b32 s30, s30, 10
    s_add_u32 s30, s30, 10485760
    v_lshlrev_b32 v130, 16, v32
    v_lshlrev_b32 v131, 16, v36
    v_mul_f32 v100, v80, v130
    v_fmac_f32 v100, v81, v131
    v_and_b32 v130, 0xffff0000, v32
    v_and_b32 v131, 0xffff0000, v36
    v_mul_f32 v101, v82, v130
    v_fmac_f32 v101, v83, v131
    v_lshlrev_b32 v130, 16, v33
    v_lshlrev_b32 v131, 16, v37
    v_mul_f32 v102, v84, v130
    v_fmac_f32 v102, v85, v131
    v_and_b32 v130, 0xffff0000, v33
    v_and_b32 v131, 0xffff0000, v37
    v_mul_f32 v103, v86, v130
    v_fmac_f32 v103, v87, v131
    v_lshlrev_b32 v130, 16, v34
    v_lshlrev_b32 v131, 16, v38
    v_mul_f32 v104, v88, v130
    v_fmac_f32 v104, v89, v131
    v_and_b32 v130, 0xffff0000, v34
    v_and_b32 v131, 0xffff0000, v38
    v_mul_f32 v105, v90, v130
    v_fmac_f32 v105, v91, v131
    v_lshlrev_b32 v130, 16, v35
    v_lshlrev_b32 v131, 16, v39
    v_mul_f32 v106, v92, v130
    v_fmac_f32 v106, v93, v131
    v_and_b32 v130, 0xffff0000, v35
    v_and_b32 v131, 0xffff0000, v39
    v_mul_f32 v107, v94, v130
    v_fmac_f32 v107, v95, v131
    v_cvt_pk_bf16_f32 v108, v100, v101
    v_cvt_pk_bf16_f32 v109, v102, v103
    v_cvt_pk_bf16_f32 v110, v104, v105
    v_cvt_pk_bf16_f32 v111, v106, v107
    s_add_u32 s51, s30, 0
    buffer_store_dwordx4 v[108:111], v123, s[8:11], s51 offen sc1
    v_lshlrev_b32 v130, 16, v40
    v_lshlrev_b32 v131, 16, v44
    v_mul_f32 v100, v80, v130
    v_fmac_f32 v100, v81, v131
    v_and_b32 v130, 0xffff0000, v40
    v_and_b32 v131, 0xffff0000, v44
    v_mul_f32 v101, v82, v130
    v_fmac_f32 v101, v83, v131
    v_lshlrev_b32 v130, 16, v41
    v_lshlrev_b32 v131, 16, v45
    v_mul_f32 v102, v84, v130
    v_fmac_f32 v102, v85, v131
    v_and_b32 v130, 0xffff0000, v41
    v_and_b32 v131, 0xffff0000, v45
    v_mul_f32 v103, v86, v130
    v_fmac_f32 v103, v87, v131
    v_lshlrev_b32 v130, 16, v42
    v_lshlrev_b32 v131, 16, v46
    v_mul_f32 v104, v88, v130
    v_fmac_f32 v104, v89, v131
    v_and_b32 v130, 0xffff0000, v42
    v_and_b32 v131, 0xffff0000, v46
    v_mul_f32 v105, v90, v130
    v_fmac_f32 v105, v91, v131
    v_lshlrev_b32 v130, 16, v43
    v_lshlrev_b32 v131, 16, v47
    v_mul_f32 v106, v92, v130
    v_fmac_f32 v106, v93, v131
    v_and_b32 v130, 0xffff0000, v43
    v_and_b32 v131, 0xffff0000, v47
    v_mul_f32 v107, v94, v130
    v_fmac_f32 v107, v95, v131
    v_cvt_pk_bf16_f32 v112, v100, v101
    v_cvt_pk_bf16_f32 v113, v102, v103
    v_cvt_pk_bf16_f32 v114, v104, v105
    v_cvt_pk_bf16_f32 v115, v106, v107
    s_add_u32 s51, s30, 40960
    buffer_store_dwordx4 v[112:115], v123, s[8:11], s51 offen sc1
    v_lshlrev_b32 v130, 16, v48
    v_lshlrev_b32 v131, 16, v52
    v_mul_f32 v100, v80, v130
    v_fmac_f32 v100, v81, v131
    v_and_b32 v130, 0xffff0000, v48
    v_and_b32 v131, 0xffff0000, v52
    v_mul_f32 v101, v82, v130
    v_fmac_f32 v101, v83, v131
    v_lshlrev_b32 v130, 16, v49
    v_lshlrev_b32 v131, 16, v53
    v_mul_f32 v102, v84, v130
    v_fmac_f32 v102, v85, v131
    v_and_b32 v130, 0xffff0000, v49
    v_and_b32 v131, 0xffff0000, v53
    v_mul_f32 v103, v86, v130
    v_fmac_f32 v103, v87, v131
    v_lshlrev_b32 v130, 16, v50
    v_lshlrev_b32 v131, 16, v54
    v_mul_f32 v104, v88, v130
    v_fmac_f32 v104, v89, v131
    v_and_b32 v130, 0xffff0000, v50
    v_and_b32 v131, 0xffff0000, v54
    v_mul_f32 v105, v90, v130
    v_fmac_f32 v105, v91, v131
    v_lshlrev_b32 v130, 16, v51
    v_lshlrev_b32 v131, 16, v55
    v_mul_f32 v106, v92, v130
    v_fmac_f32 v106, v93, v131
    v_and_b32 v130, 0xffff0000, v51
    v_and_b32 v131, 0xffff0000, v55
    v_mul_f32 v107, v94, v130
    v_fmac_f32 v107, v95, v131
    v_cvt_pk_bf16_f32 v108, v100, v101
    v_cvt_pk_bf16_f32 v109, v102, v103
    v_cvt_pk_bf16_f32 v110, v104, v105
    v_cvt_pk_bf16_f32 v111, v106, v107
    s_add_u32 s51, s30, 81920
    buffer_store_dwordx4 v[108:111], v123, s[8:11], s51 offen sc1
    v_lshlrev_b32 v130, 16, v56
    v_lshlrev_b32 v131, 16, v60
    v_mul_f32 v100, v80, v130
    v_fmac_f32 v100, v81, v131
    v_and_b32 v130, 0xffff0000, v56
    v_and_b32 v131, 0xffff0000, v60
    v_mul_f32 v101, v82, v130
    v_fmac_f32 v101, v83, v131
    v_lshlrev_b32 v130, 16, v57
    v_lshlrev_b32 v131, 16, v61
    v_mul_f32 v102, v84, v130
    v_fmac_f32 v102, v85, v131
    v_and_b32 v130, 0xffff0000, v57
    v_and_b32 v131, 0xffff0000, v61
    v_mul_f32 v103, v86, v130
    v_fmac_f32 v103, v87, v131
    v_lshlrev_b32 v130, 16, v58
    v_lshlrev_b32 v131, 16, v62
    v_mul_f32 v104, v88, v130
    v_fmac_f32 v104, v89, v131
    v_and_b32 v130, 0xffff0000, v58
    v_and_b32 v131, 0xffff0000, v62
    v_mul_f32 v105, v90, v130
    v_fmac_f32 v105, v91, v131
    v_lshlrev_b32 v130, 16, v59
    v_lshlrev_b32 v131, 16, v63
    v_mul_f32 v106, v92, v130
    v_fmac_f32 v106, v93, v131
    v_and_b32 v130, 0xffff0000, v59
    v_and_b32 v131, 0xffff0000, v63
    v_mul_f32 v107, v94, v130
    v_fmac_f32 v107, v95, v131
    v_cvt_pk_bf16_f32 v112, v100, v101
    v_cvt_pk_bf16_f32 v113, v102, v103
    v_cvt_pk_bf16_f32 v114, v104, v105
    v_cvt_pk_bf16_f32 v115, v106, v107
    s_add_u32 s51, s30, 122880
    buffer_store_dwordx4 v[112:115], v123, s[8:11], s51 offen sc1
    v_lshlrev_b32 v130, 16, v64
    v_lshlrev_b32 v131, 16, v68
    v_mul_f32 v100, v80, v130
    v_fmac_f32 v100, v81, v131
    v_and_b32 v130, 0xffff0000, v64
    v_and_b32 v131, 0xffff0000, v68
    v_mul_f32 v101, v82, v130
    v_fmac_f32 v101, v83, v131
    v_lshlrev_b32 v130, 16, v65
    v_lshlrev_b32 v131, 16, v69
    v_mul_f32 v102, v84, v130
    v_fmac_f32 v102, v85, v131
    v_and_b32 v130, 0xffff0000, v65
    v_and_b32 v131, 0xffff0000, v69
    v_mul_f32 v103, v86, v130
    v_fmac_f32 v103, v87, v131
    v_lshlrev_b32 v130, 16, v66
    v_lshlrev_b32 v131, 16, v70
    v_mul_f32 v104, v88, v130
    v_fmac_f32 v104, v89, v131
    v_and_b32 v130, 0xffff0000, v66
    v_and_b32 v131, 0xffff0000, v70
    v_mul_f32 v105, v90, v130
    v_fmac_f32 v105, v91, v131
    v_lshlrev_b32 v130, 16, v67
    v_lshlrev_b32 v131, 16, v71
    v_mul_f32 v106, v92, v130
    v_fmac_f32 v106, v93, v131
    v_and_b32 v130, 0xffff0000, v67
    v_and_b32 v131, 0xffff0000, v71
    v_mul_f32 v107, v94, v130
    v_fmac_f32 v107, v95, v131
    v_cvt_pk_bf16_f32 v108, v100, v101
    v_cvt_pk_bf16_f32 v109, v102, v103
    v_cvt_pk_bf16_f32 v110, v104, v105
    v_cvt_pk_bf16_f32 v111, v106, v107
    s_add_u32 s51, s30, 163840
    buffer_store_dwordx4 v[108:111], v123, s[8:11], s51 offen sc1
    s_branch gated_mix__ssm_conv_s5__linear_kernel_hedgehog__prompt_kernel_sdone17
gated_mix__ssm_conv_s5__linear_kernel_hedgehog__prompt_kernel_fw14:
    s_mul_i32 s30, s61, 20
    s_add_u32 s30, s30, s60
    s_lshl_b32 s30, s30, 10
    s_add_u32 s30, s30, 12582912
    v_lshl_or_b32 v80, v33, 16, v32
    v_lshl_or_b32 v81, v35, 16, v34
    v_lshl_or_b32 v82, v37, 16, v36
    v_lshl_or_b32 v83, v39, 16, v38
    s_add_u32 s51, s30, 0
    buffer_store_dwordx4 v[80:83], v123, s[8:11], s51 offen sc1
    v_lshl_or_b32 v84, v41, 16, v40
    v_lshl_or_b32 v85, v43, 16, v42
    v_lshl_or_b32 v86, v45, 16, v44
    v_lshl_or_b32 v87, v47, 16, v46
    s_add_u32 s51, s30, 20480
    buffer_store_dwordx4 v[84:87], v123, s[8:11], s51 offen sc1
    v_lshl_or_b32 v88, v49, 16, v48
    v_lshl_or_b32 v89, v51, 16, v50
    v_lshl_or_b32 v90, v53, 16, v52
    v_lshl_or_b32 v91, v55, 16, v54
    s_add_u32 s51, s30, 40960
    buffer_store_dwordx4 v[88:91], v123, s[8:11], s51 offen sc1
    v_lshl_or_b32 v92, v57, 16, v56
    v_lshl_or_b32 v93, v59, 16, v58
    v_lshl_or_b32 v94, v61, 16, v60
    v_lshl_or_b32 v95, v63, 16, v62
    s_add_u32 s51, s30, 61440
    buffer_store_dwordx4 v[92:95], v123, s[8:11], s51 offen sc1
    v_lshl_or_b32 v96, v65, 16, v64
    v_lshl_or_b32 v97, v67, 16, v66
    v_lshl_or_b32 v98, v69, 16, v68
    v_lshl_or_b32 v99, v71, 16, v70
    s_add_u32 s51, s30, 81920
    buffer_store_dwordx4 v[96:99], v123, s[8:11], s51 offen sc1
    s_branch gated_mix__ssm_conv_s5__linear_kernel_hedgehog__prompt_kernel_sdone17
gated_mix__ssm_conv_s5__linear_kernel_hedgehog__prompt_kernel_fg15:
    v_mov_b32 v130, 0
    v_mov_b32 v131, 0
    v_dot2c_f32_bf16 v130, v32, v72
    v_dot2c_f32_bf16 v131, v33, v73
    v_dot2c_f32_bf16 v130, v34, v74
    v_dot2c_f32_bf16 v131, v35, v75
    v_dot2c_f32_bf16 v130, v36, v76
    v_dot2c_f32_bf16 v131, v37, v77
    v_dot2c_f32_bf16 v130, v38, v78
    v_dot2c_f32_bf16 v131, v39, v79
    v_dot2c_f32_bf16 v130, v40, v80
    v_dot2c_f32_bf16 v131, v41, v81
    v_dot2c_f32_bf16 v130, v42, v82
    v_dot2c_f32_bf16 v131, v43, v83
    v_dot2c_f32_bf16 v130, v44, v84
    v_dot2c_f32_bf16 v131, v45, v85
    v_dot2c_f32_bf16 v130, v46, v86
    v_dot2c_f32_bf16 v131, v47, v87
    v_dot2c_f32_bf16 v130, v48, v88
    v_dot2c_f32_bf16 v131, v49, v89
    v_dot2c_f32_bf16 v130, v50, v90
    v_dot2c_f32_bf16 v131, v51, v91
    v_dot2c_f32_bf16 v130, v52, v92
    v_dot2c_f32_bf16 v131, v53, v93
    v_dot2c_f32_bf16 v130, v54, v94
    v_dot2c_f32_bf16 v131, v55, v95
    v_dot2c_f32_bf16 v130, v56, v96
    v_dot2c_f32_bf16 v131, v57, v97
    v_dot2c_f32_bf16 v130, v58, v98
    v_dot2c_f32_bf16 v131, v59, v99
    v_dot2c_f32_bf16 v130, v60, v100
    v_dot2c_f32_bf16 v131, v61, v101
    v_dot2c_f32_bf16 v130, v62, v102
    v_dot2c_f32_bf16 v131, v63, v103
    v_dot2c_f32_bf16 v130, v64, v104
    v_dot2c_f32_bf16 v131, v65, v105
    v_dot2c_f32_bf16 v130, v66, v106
    v_dot2c_f32_bf16 v131, v67, v107
    v_dot2c_f32_bf16 v130, v68, v108
    v_dot2c_f32_bf16 v131, v69, v109
    v_dot2c_f32_bf16 v130, v70, v110
    v_dot2c_f32_bf16 v131, v71, v111
    s_nop 3
    v_add_f32 v130, v130, v131
    s_nop 1
    v_add_f32_dpp v130, v130, v130 quad_perm:[1,0,3,2] row_mask:0xf bank_mask:0xf
    s_nop 1
    v_add_f32_dpp v130, v130, v130 quad_perm:[2,3,0,1] row_mask:0xf bank_mask:0xf
    s_nop 1
    v_add_f32_dpp v130, v130, v130 row_half_mirror row_mask:0xf bank_mask:0xf
    v_mul_f32 v130, 0x3fb8aa3b, v130
    v_exp_f32 v130, -v130
    s_nop 0
    v_add_f32 v130, 1.0, v130
    v_rcp_f32 v130, v130
    s_lshl_b32 s30, s29, 7
    s_add_u32 s30, s30, 17825792
    v_lshlrev_b32 v131, 2, v124
    v_mov_b32 v132, 0x7fffffff
    v_cmp_eq_u32 vcc, 0, v125
    s_nop 1
    v_cndmask_b32 v131, v132, v131, vcc
    buffer_store_dword v130, v131, s[8:11], s30 offen sc1
gated_mix__ssm_conv_s5__linear_kernel_hedgehog__prompt_kernel_fn16:
gated_mix__ssm_conv_s5__linear_kernel_hedgehog__prompt_kernel_sdone17:
    s_branch gated_mix__ssm_conv_s5__linear_kernel_hedgehog__prompt_kernel_sidedone
gated_mix__ssm_conv_s5__linear_kernel_hedgehog__prompt_kernel_helper6:
    s_setprio 3
    s_load_dwordx2 s[36:37], s[0:1], 128
    s_load_dwordx2 s[24:25], s[0:1], 120
    s_waitcnt lgkmcnt(0)
    s_mov_b32 s20, s36
    s_and_b32 s21, s37, 0xffff
    s_mov_b32 s22, 20971520
    s_mov_b32 s23, 0x20000
    v_mov_b32 v104, 128
    global_load_dwordx2 v[106:107], v104, s[24:25] sc1
    s_waitcnt vmcnt(11)
    s_barrier
    v_and_b32 v20, 15, v0
    s_mul_i32 s4, s27, 80
    s_add_u32 s4, s4, 0
    v_add_u32 v21, s4, v20
    v_lshlrev_b32 v30, 3, v20
    v_add_u32 v31, 161792, v30
    ds_read_b64 v[26:27], v31
    v_add_u32 v31, 144256, v30
    v_add_u32 v62, 153088, v30
    v_add_u32 v30, 136064, v30
    v_mov_b32 v66, 1.0
    v_mov_b32 v67, 0
    v_mov_b32 v60, 0
    v_mov_b32 v61, 0
    s_waitcnt lgkmcnt(0)
    v_mov_b32 v28, v26
    v_mov_b32 v29, v27
    v_mul_f32 v59, v29, v29
    v_mul_f32 v29, v28, v29
    v_fma_f32 v28, v28, v28, -v59
    v_add_f32 v29, v29, v29
    v_mov_b32 v32, v28
    v_mov_b32 v33, v29
    v_mul_f32 v59, v29, v29
    v_mul_f32 v29, v28, v29
    v_fma_f32 v28, v28, v28, -v59
    v_add_f32 v29, v29, v29
    v_mov_b32 v34, v28
    v_mov_b32 v35, v29
    v_mul_f32 v59, v29, v29
    v_mul_f32 v29, v28, v29
    v_fma_f32 v28, v28, v28, -v59
    v_add_f32 v29, v29, v29
    v_mov_b32 v36, v28
    v_mov_b32 v37, v29
    v_mul_f32 v59, v29, v29
    v_mul_f32 v29, v28, v29
    v_fma_f32 v28, v28, v28, -v59
    v_add_f32 v29, v29, v29
    ds_write_b64 v31, v[66:67] offset:9344
    v_pk_mul_f32 v[64:65], v[26:27], v[66:67] op_sel_hi:[0,1]
    v_pk_fma_f32 v[66:67], v[26:27], v[66:67], v[64:65] op_sel:[1,1,0] op_sel_hi:[1,0,1] neg_lo:[1,0,0]
    ds_write_b64 v31, v[66:67] offset:9856
    v_pk_mul_f32 v[64:65], v[26:27], v[66:67] op_sel_hi:[0,1]
    v_pk_fma_f32 v[66:67], v[26:27], v[66:67], v[64:65] op_sel:[1,1,0] op_sel_hi:[1,0,1] neg_lo:[1,0,0]
    ds_write_b64 v31, v[66:67] offset:10368
    v_pk_mul_f32 v[64:65], v[26:27], v[66:67] op_sel_hi:[0,1]
    v_pk_fma_f32 v[66:67], v[26:27], v[66:67], v[64:65] op_sel:[1,1,0] op_sel_hi:[1,0,1] neg_lo:[1,0,0]
    ds_write_b64 v31, v[66:67] offset:10880
    v_pk_mul_f32 v[64:65], v[26:27], v[66:67] op_sel_hi:[0,1]
    v_pk_fma_f32 v[66:67], v[26:27], v[66:67], v[64:65] op_sel:[1,1,0] op_sel_hi:[1,0,1] neg_lo:[1,0,0]
    ds_write_b64 v31, v[66:67] offset:11392
    v_pk_mul_f32 v[64:65], v[26:27], v[66:67] op_sel_hi:[0,1]
    v_pk_fma_f32 v[66:67], v[26:27], v[66:67], v[64:65] op_sel:[1,1,0] op_sel_hi:[1,0,1] neg_lo:[1,0,0]
    ds_write_b64 v31, v[66:67] offset:11904
    v_pk_mul_f32 v[64:65], v[26:27], v[66:67] op_sel_hi:[0,1]
    v_pk_fma_f32 v[66:67], v[26:27], v[66:67], v[64:65] op_sel:[1,1,0] op_sel_hi:[1,0,1] neg_lo:[1,0,0]
    ds_write_b64 v31, v[66:67] offset:12416
    v_pk_mul_f32 v[64:65], v[26:27], v[66:67] op_sel_hi:[0,1]
    v_pk_fma_f32 v[66:67], v[26:27], v[66:67], v[64:65] op_sel:[1,1,0] op_sel_hi:[1,0,1] neg_lo:[1,0,0]
    ds_write_b64 v31, v[66:67] offset:12928
    v_pk_mul_f32 v[64:65], v[26:27], v[66:67] op_sel_hi:[0,1]
    v_pk_fma_f32 v[66:67], v[26:27], v[66:67], v[64:65] op_sel:[1,1,0] op_sel_hi:[1,0,1] neg_lo:[1,0,0]
    ds_write_b64 v31, v[66:67] offset:13440
    v_pk_mul_f32 v[64:65], v[26:27], v[66:67] op_sel_hi:[0,1]
    v_pk_fma_f32 v[66:67], v[26:27], v[66:67], v[64:65] op_sel:[1,1,0] op_sel_hi:[1,0,1] neg_lo:[1,0,0]
    ds_write_b64 v31, v[66:67] offset:13952
    v_pk_mul_f32 v[64:65], v[26:27], v[66:67] op_sel_hi:[0,1]
    v_pk_fma_f32 v[66:67], v[26:27], v[66:67], v[64:65] op_sel:[1,1,0] op_sel_hi:[1,0,1] neg_lo:[1,0,0]
    ds_write_b64 v31, v[66:67] offset:14464
    v_pk_mul_f32 v[64:65], v[26:27], v[66:67] op_sel_hi:[0,1]
    v_pk_fma_f32 v[66:67], v[26:27], v[66:67], v[64:65] op_sel:[1,1,0] op_sel_hi:[1,0,1] neg_lo:[1,0,0]
    ds_write_b64 v31, v[66:67] offset:14976
    v_pk_mul_f32 v[64:65], v[26:27], v[66:67] op_sel_hi:[0,1]
    v_pk_fma_f32 v[66:67], v[26:27], v[66:67], v[64:65] op_sel:[1,1,0] op_sel_hi:[1,0,1] neg_lo:[1,0,0]
    ds_write_b64 v31, v[66:67] offset:15488
    v_pk_mul_f32 v[64:65], v[26:27], v[66:67] op_sel_hi:[0,1]
    v_pk_fma_f32 v[66:67], v[26:27], v[66:67], v[64:65] op_sel:[1,1,0] op_sel_hi:[1,0,1] neg_lo:[1,0,0]
    ds_write_b64 v31, v[66:67] offset:16000
    v_pk_mul_f32 v[64:65], v[26:27], v[66:67] op_sel_hi:[0,1]
    v_pk_fma_f32 v[66:67], v[26:27], v[66:67], v[64:65] op_sel:[1,1,0] op_sel_hi:[1,0,1] neg_lo:[1,0,0]
    ds_write_b64 v31, v[66:67] offset:16512
    v_pk_mul_f32 v[64:65], v[26:27], v[66:67] op_sel_hi:[0,1]
    v_pk_fma_f32 v[66:67], v[26:27], v[66:67], v[64:65] op_sel:[1,1,0] op_sel_hi:[1,0,1] neg_lo:[1,0,0]
    ds_write_b64 v31, v[66:67] offset:17024
    ds_write_b64 v31, v[60:61]
    s_waitcnt vmcnt(1)
    s_barrier
    s_waitcnt vmcnt(0)
    s_waitcnt vmcnt(0)
    s_mov_b32 s7, 0
gated_mix__ssm_conv_s5__linear_kernel_hedgehog__prompt_kernel_nn18:
    v_readfirstlane_b32 s34, v106
    v_readfirstlane_b32 s35, v107
    s_nop 2
    s_cmp_lg_u32 s34, 0
    s_cbranch_scc1 gated_mix__ssm_conv_s5__linear_kernel_hedgehog__prompt_kernel_nnd19
    s_add_u32 s7, s7, 1
    s_cmp_ge_u32 s7, 400000
    s_cbranch_scc1 gated_mix__ssm_conv_s5__linear_kernel_hedgehog__prompt_kernel_nnd19
    global_load_dwordx2 v[106:107], v104, s[24:25] sc1
    s_waitcnt vmcnt(0)
    s_branch gated_mix__ssm_conv_s5__linear_kernel_hedgehog__prompt_kernel_nn18
gated_mix__ssm_conv_s5__linear_kernel_hedgehog__prompt_kernel_nnd19:
    v_mov_b32 v108, s34
    v_mov_b32 v109, s35
    v_mov_b32 v110, 152496
    ds_write_b64 v110, v[108:109]
    v_mov_b32 v58, 152448
    v_mov_b32 v70, s34
    v_mov_b32 v71, s35
    v_lshlrev_b32 v66, 4, v21
    s_mul_i32 s5, s26, 10240
    s_add_u32 s5, s5, 17891328
    v_and_b32 v67, 63, v0
    v_cmp_gt_u32 vcc, 16, v67
    v_mov_b32 v67, 0x7fffffff
    s_nop 0
    v_cndmask_b32 v67, v67, v66, vcc
gated_mix__ssm_conv_s5__linear_kernel_hedgehog__prompt_kernel_spin20:
    ds_read_b32 v59, v58
    s_waitcnt lgkmcnt(0)
    v_readfirstlane_b32 s4, v59
    s_nop 3
    s_cmp_ge_u32 s4, 4
    s_cbranch_scc1 gated_mix__ssm_conv_s5__linear_kernel_hedgehog__prompt_kernel_spun21
    s_branch gated_mix__ssm_conv_s5__linear_kernel_hedgehog__prompt_kernel_spin20
gated_mix__ssm_conv_s5__linear_kernel_hedgehog__prompt_kernel_spun21:
    ds_read_b64 v[72:73], v30 offset:0
    ds_read_b64 v[74:75], v30 offset:512
    ds_read_b64 v[76:77], v30 offset:1024
    ds_read_b64 v[78:79], v30 offset:1536
    ds_read_b64 v[80:81], v30 offset:2048
    ds_read_b64 v[82:83], v30 offset:2560
    ds_read_b64 v[84:85], v30 offset:3072
    ds_read_b64 v[86:87], v30 offset:3584
    ds_read_b64 v[88:89], v30 offset:4096
    ds_read_b64 v[90:91], v30 offset:4608
    ds_read_b64 v[92:93], v30 offset:5120
    ds_read_b64 v[94:95], v30 offset:5632
    ds_read_b64 v[96:97], v30 offset:6144
    ds_read_b64 v[98:99], v30 offset:6656
    ds_read_b64 v[100:101], v30 offset:7168
    ds_read_b64 v[102:103], v30 offset:7680
    s_waitcnt lgkmcnt(14)
    v_pk_fma_f32 v[104:105], v[26:27], v[72:73], v[74:75] op_sel_hi:[0,1,1]
    s_waitcnt lgkmcnt(12)
    v_pk_fma_f32 v[106:107], v[26:27], v[76:77], v[78:79] op_sel_hi:[0,1,1]
    v_pk_fma_f32 v[104:105], v[26:27], v[72:73], v[104:105] op_sel:[1,1,0] op_sel_hi:[1,0,1] neg_lo:[1,0,0]
    s_waitcnt lgkmcnt(10)
    v_pk_fma_f32 v[108:109], v[26:27], v[80:81], v[82:83] op_sel_hi:[0,1,1]
    v_pk_fma_f32 v[106:107], v[26:27], v[76:77], v[106:107] op_sel:[1,1,0] op_sel_hi:[1,0,1] neg_lo:[1,0,0]
    s_waitcnt lgkmcnt(8)
    v_pk_fma_f32 v[110:111], v[26:27], v[84:85], v[86:87] op_sel_hi:[0,1,1]
    v_pk_fma_f32 v[108:109], v[26:27], v[80:81], v[108:109] op_sel:[1,1,0] op_sel_hi:[1,0,1] neg_lo:[1,0,0]
    s_waitcnt lgkmcnt(6)
    v_pk_fma_f32 v[112:113], v[26:27], v[88:89], v[90:91] op_sel_hi:[0,1,1]
    v_pk_fma_f32 v[110:111], v[26:27], v[84:85], v[110:111] op_sel:[1,1,0] op_sel_hi:[1,0,1] neg_lo:[1,0,0]
    s_waitcnt lgkmcnt(4)
    v_pk_fma_f32 v[114:115], v[26:27], v[92:93], v[94:95] op_sel_hi:[0,1,1]
    v_pk_fma_f32 v[112:113], v[26:27], v[88:89], v[112:113] op_sel:[1,1,0] op_sel_hi:[1,0,1] neg_lo:[1,0,0]
    s_waitcnt lgkmcnt(2)
    v_pk_fma_f32 v[116:117], v[26:27], v[96:97], v[98:99] op_sel_hi:[0,1,1]
    v_pk_fma_f32 v[114:115], v[26:27], v[92:93], v[114:115] op_sel:[1,1,0] op_sel_hi:[1,0,1] neg_lo:[1,0,0]
    s_waitcnt lgkmcnt(0)
    v_pk_fma_f32 v[118:119], v[26:27], v[100:101], v[102:103] op_sel_hi:[0,1,1]
    v_pk_fma_f32 v[116:117], v[26:27], v[96:97], v[116:117] op_sel:[1,1,0] op_sel_hi:[1,0,1] neg_lo:[1,0,0]
    v_pk_fma_f32 v[118:119], v[26:27], v[100:101], v[118:119] op_sel:[1,1,0] op_sel_hi:[1,0,1] neg_lo:[1,0,0]
    v_pk_fma_f32 v[120:121], v[32:33], v[104:105], v[106:107] op_sel_hi:[0,1,1]
    v_pk_fma_f32 v[122:123], v[32:33], v[108:109], v[110:111] op_sel_hi:[0,1,1]
    v_pk_fma_f32 v[124:125], v[32:33], v[112:113], v[114:115] op_sel_hi:[0,1,1]
    v_pk_fma_f32 v[126:127], v[32:33], v[116:117], v[118:119] op_sel_hi:[0,1,1]
    v_pk_fma_f32 v[120:121], v[32:33], v[104:105], v[120:121] op_sel:[1,1,0] op_sel_hi:[1,0,1] neg_lo:[1,0,0]
    v_pk_fma_f32 v[122:123], v[32:33], v[108:109], v[122:123] op_sel:[1,1,0] op_sel_hi:[1,0,1] neg_lo:[1,0,0]
    v_pk_fma_f32 v[124:125], v[32:33], v[112:113], v[124:125] op_sel:[1,1,0] op_sel_hi:[1,0,1] neg_lo:[1,0,0]
    v_pk_fma_f32 v[126:127], v[32:33], v[116:117], v[126:127] op_sel:[1,1,0] op_sel_hi:[1,0,1] neg_lo:[1,0,0]
    v_pk_fma_f32 v[136:137], v[34:35], v[120:121], v[122:123] op_sel_hi:[0,1,1]
    v_pk_fma_f32 v[138:139], v[34:35], v[124:125], v[126:127] op_sel_hi:[0,1,1]
    v_pk_fma_f32 v[136:137], v[34:35], v[120:121], v[136:137] op_sel:[1,1,0] op_sel_hi:[1,0,1] neg_lo:[1,0,0]
    v_pk_fma_f32 v[138:139], v[34:35], v[124:125], v[138:139] op_sel:[1,1,0] op_sel_hi:[1,0,1] neg_lo:[1,0,0]
    v_pk_fma_f32 v[68:69], v[36:37], v[136:137], v[138:139] op_sel_hi:[0,1,1]
    v_pk_fma_f32 v[68:69], v[36:37], v[136:137], v[68:69] op_sel:[1,1,0] op_sel_hi:[1,0,1] neg_lo:[1,0,0]
    buffer_store_dwordx4 v[68:71], v67, s[20:23], s5 offen sc1
    v_mov_b32 v56, 0
    v_mov_b32 v57, 0
    s_mov_b32 s5, 0
    s_mov_b32 s6, 0
    s_mov_b32 s63, 0
    s_lshl_b32 s7, 1, s26
    s_sub_u32 s7, s7, 1
gated_mix__ssm_conv_s5__linear_kernel_hedgehog__prompt_kernel_poll22:
    s_cmp_le_u32 s26, 0
    s_cbranch_scc1 gated_mix__ssm_conv_s5__linear_kernel_hedgehog__prompt_kernel_chk23
    s_bitcmp1_b32 s6, 0
    s_cbranch_scc1 gated_mix__ssm_conv_s5__linear_kernel_hedgehog__prompt_kernel_have25
    s_mov_b32 s4, 17891328
    buffer_load_dwordx4 v[104:107], v66, s[20:23], s4 offen sc1
gated_mix__ssm_conv_s5__linear_kernel_hedgehog__prompt_kernel_have25:
    s_cmp_le_u32 s26, 1
    s_cbranch_scc1 gated_mix__ssm_conv_s5__linear_kernel_hedgehog__prompt_kernel_chk23
    s_bitcmp1_b32 s6, 1
    s_cbranch_scc1 gated_mix__ssm_conv_s5__linear_kernel_hedgehog__prompt_kernel_have26
    s_mov_b32 s4, 17901568
    buffer_load_dwordx4 v[108:111], v66, s[20:23], s4 offen sc1
gated_mix__ssm_conv_s5__linear_kernel_hedgehog__prompt_kernel_have26:
    s_cmp_le_u32 s26, 2
    s_cbranch_scc1 gated_mix__ssm_conv_s5__linear_kernel_hedgehog__prompt_kernel_chk23
    s_bitcmp1_b32 s6, 2
    s_cbranch_scc1 gated_mix__ssm_conv_s5__linear_kernel_hedgehog__prompt_kernel_have27
    s_mov_b32 s4, 17911808
    buffer_load_dwordx4 v[112:115], v66, s[20:23], s4 offen sc1
gated_mix__ssm_conv_s5__linear_kernel_hedgehog__prompt_kernel_have27:
    s_cmp_le_u32 s26, 3
    s_cbranch_scc1 gated_mix__ssm_conv_s5__linear_kernel_hedgehog__prompt_kernel_chk23
    s_bitcmp1_b32 s6, 3
    s_cbranch_scc1 gated_mix__ssm_conv_s5__linear_kernel_hedgehog__prompt_kernel_have28
    s_mov_b32 s4, 17922048
    buffer_load_dwordx4 v[116:119], v66, s[20:23], s4 offen sc1
gated_mix__ssm_conv_s5__linear_kernel_hedgehog__prompt_kernel_have28:
    s_cmp_le_u32 s26, 4
    s_cbranch_scc1 gated_mix__ssm_conv_s5__linear_kernel_hedgehog__prompt_kernel_chk23
    s_bitcmp1_b32 s6, 4
    s_cbranch_scc1 gated_mix__ssm_conv_s5__linear_kernel_hedgehog__prompt_kernel_have29
    s_mov_b32 s4, 17932288
    buffer_load_dwordx4 v[120:123], v66, s[20:23], s4 offen sc1
gated_mix__ssm_conv_s5__linear_kernel_hedgehog__prompt_kernel_have29:
    s_cmp_le_u32 s26, 5
    s_cbranch_scc1 gated_mix__ssm_conv_s5__linear_kernel_hedgehog__prompt_kernel_chk23
    s_bitcmp1_b32 s6, 5
    s_cbranch_scc1 gated_mix__ssm_conv_s5__linear_kernel_hedgehog__prompt_kernel_have30
    s_mov_b32 s4, 17942528
    buffer_load_dwordx4 v[124:127], v66, s[20:23], s4 offen sc1
gated_mix__ssm_conv_s5__linear_kernel_hedgehog__prompt_kernel_have30:
    s_cmp_le_u32 s26, 6
    s_cbranch_scc1 gated_mix__ssm_conv_s5__linear_kernel_hedgehog__prompt_kernel_chk23
    s_bitcmp1_b32 s6, 6
    s_cbranch_scc1 gated_mix__ssm_conv_s5__linear_kernel_hedgehog__prompt_kernel_have31
    s_mov_b32 s4, 17952768
    buffer_load_dwordx4 v[128:131], v66, s[20:23], s4 offen sc1
gated_mix__ssm_conv_s5__linear_kernel_hedgehog__prompt_kernel_have31:
    s_cmp_le_u32 s26, 7
    s_cbranch_scc1 gated_mix__ssm_conv_s5__linear_kernel_hedgehog__prompt_kernel_chk23
    s_bitcmp1_b32 s6, 7
    s_cbranch_scc1 gated_mix__ssm_conv_s5__linear_kernel_hedgehog__prompt_kernel_have32
    s_mov_b32 s4, 17963008
    buffer_load_dwordx4 v[132:135], v66, s[20:23], s4 offen sc1
gated_mix__ssm_conv_s5__linear_kernel_hedgehog__prompt_kernel_have32:
    s_cmp_le_u32 s26, 8
    s_cbranch_scc1 gated_mix__ssm_conv_s5__linear_kernel_hedgehog__prompt_kernel_chk23
    s_bitcmp1_b32 s6, 8
    s_cbranch_scc1 gated_mix__ssm_conv_s5__linear_kernel_hedgehog__prompt_kernel_have33
    s_mov_b32 s4, 17973248
    buffer_load_dwordx4 v[136:139], v66, s[20:23], s4 offen sc1
gated_mix__ssm_conv_s5__linear_kernel_hedgehog__prompt_kernel_have33:
    s_cmp_le_u32 s26, 9
    s_cbranch_scc1 gated_mix__ssm_conv_s5__linear_kernel_hedgehog__prompt_kernel_chk23
    s_bitcmp1_b32 s6, 9
    s_cbranch_scc1 gated_mix__ssm_conv_s5__linear_kernel_hedgehog__prompt_kernel_have34
    s_mov_b32 s4, 17983488
    buffer_load_dwordx4 v[140:143], v66, s[20:23], s4 offen sc1
gated_mix__ssm_conv_s5__linear_kernel_hedgehog__prompt_kernel_have34:
    s_cmp_le_u32 s26, 10
    s_cbranch_scc1 gated_mix__ssm_conv_s5__linear_kernel_hedgehog__prompt_kernel_chk23
    s_bitcmp1_b32 s6, 10
    s_cbranch_scc1 gated_mix__ssm_conv_s5__linear_kernel_hedgehog__prompt_kernel_have35
    s_mov_b32 s4, 17993728
    buffer_load_dwordx4 v[144:147], v66, s[20:23], s4 offen sc1
gated_mix__ssm_conv_s5__linear_kernel_hedgehog__prompt_kernel_have35:
    s_cmp_le_u32 s26, 11
    s_cbranch_scc1 gated_mix__ssm_conv_s5__linear_kernel_hedgehog__prompt_kernel_chk23
    s_bitcmp1_b32 s6, 11
    s_cbranch_scc1 gated_mix__ssm_conv_s5__linear_kernel_hedgehog__prompt_kernel_have36
    s_mov_b32 s4, 18003968
    buffer_load_dwordx4 v[148:151], v66, s[20:23], s4 offen sc1
gated_mix__ssm_conv_s5__linear_kernel_hedgehog__prompt_kernel_have36:
    s_cmp_le_u32 s26, 12
    s_cbranch_scc1 gated_mix__ssm_conv_s5__linear_kernel_hedgehog__prompt_kernel_chk23
    s_bitcmp1_b32 s6, 12
    s_cbranch_scc1 gated_mix__ssm_conv_s5__linear_kernel_hedgehog__prompt_kernel_have37
    s_mov_b32 s4, 18014208
    buffer_load_dwordx4 v[152:155], v66, s[20:23], s4 offen sc1
gated_mix__ssm_conv_s5__linear_kernel_hedgehog__prompt_kernel_have37:
    s_cmp_le_u32 s26, 13
    s_cbranch_scc1 gated_mix__ssm_conv_s5__linear_kernel_hedgehog__prompt_kernel_chk23
    s_bitcmp1_b32 s6, 13
    s_cbranch_scc1 gated_mix__ssm_conv_s5__linear_kernel_hedgehog__prompt_kernel_have38
    s_mov_b32 s4, 18024448
    buffer_load_dwordx4 v[156:159], v66, s[20:23], s4 offen sc1
gated_mix__ssm_conv_s5__linear_kernel_hedgehog__prompt_kernel_have38:
    s_cmp_le_u32 s26, 14
    s_cbranch_scc1 gated_mix__ssm_conv_s5__linear_kernel_hedgehog__prompt_kernel_chk23
    s_bitcmp1_b32 s6, 14
    s_cbranch_scc1 gated_mix__ssm_conv_s5__linear_kernel_hedgehog__prompt_kernel_have39
    s_mov_b32 s4, 18034688
    buffer_load_dwordx4 v[160:163], v66, s[20:23], s4 offen sc1
gated_mix__ssm_conv_s5__linear_kernel_hedgehog__prompt_kernel_have39:
gated_mix__ssm_conv_s5__linear_kernel_hedgehog__prompt_kernel_chk23:
    s_cmp_lg_u32 s5, 0
    s_cbranch_scc1 gated_mix__ssm_conv_s5__linear_kernel_hedgehog__prompt_kernel_pdone40
    s_mov_b32 s5, 1
    ds_write_b64 v31, v[72:73] offset:512
    v_pk_fma_f32 v[64:65], v[26:27], v[72:73], v[74:75] op_sel_hi:[0,1,1]
    v_pk_fma_f32 v[74:75], v[26:27], v[72:73], v[64:65] op_sel:[1,1,0] op_sel_hi:[1,0,1] neg_lo:[1,0,0]
    ds_write_b64 v31, v[74:75] offset:1024
    v_pk_fma_f32 v[64:65], v[26:27], v[74:75], v[76:77] op_sel_hi:[0,1,1]
    v_pk_fma_f32 v[76:77], v[26:27], v[74:75], v[64:65] op_sel:[1,1,0] op_sel_hi:[1,0,1] neg_lo:[1,0,0]
    ds_write_b64 v31, v[76:77] offset:1536
    v_pk_fma_f32 v[64:65], v[26:27], v[76:77], v[78:79] op_sel_hi:[0,1,1]
    v_pk_fma_f32 v[78:79], v[26:27], v[76:77], v[64:65] op_sel:[1,1,0] op_sel_hi:[1,0,1] neg_lo:[1,0,0]
    ds_write_b64 v31, v[78:79] offset:2048
    v_pk_fma_f32 v[64:65], v[26:27], v[78:79], v[80:81] op_sel_hi:[0,1,1]
    v_pk_fma_f32 v[80:81], v[26:27], v[78:79], v[64:65] op_sel:[1,1,0] op_sel_hi:[1,0,1] neg_lo:[1,0,0]
    ds_write_b64 v31, v[80:81] offset:2560
    v_pk_fma_f32 v[64:65], v[26:27], v[80:81], v[82:83] op_sel_hi:[0,1,1]
    v_pk_fma_f32 v[82:83], v[26:27], v[80:81], v[64:65] op_sel:[1,1,0] op_sel_hi:[1,0,1] neg_lo:[1,0,0]
    ds_write_b64 v31, v[82:83] offset:3072
    v_pk_fma_f32 v[64:65], v[26:27], v[82:83], v[84:85] op_sel_hi:[0,1,1]
    v_pk_fma_f32 v[84:85], v[26:27], v[82:83], v[64:65] op_sel:[1,1,0] op_sel_hi:[1,0,1] neg_lo:[1,0,0]
    ds_write_b64 v31, v[84:85] offset:3584
    v_pk_fma_f32 v[64:65], v[26:27], v[84:85], v[86:87] op_sel_hi:[0,1,1]
    v_pk_fma_f32 v[86:87], v[26:27], v[84:85], v[64:65] op_sel:[1,1,0] op_sel_hi:[1,0,1] neg_lo:[1,0,0]
    ds_write_b64 v31, v[86:87] offset:4096
    v_pk_fma_f32 v[64:65], v[26:27], v[86:87], v[88:89] op_sel_hi:[0,1,1]
    v_pk_fma_f32 v[88:89], v[26:27], v[86:87], v[64:65] op_sel:[1,1,0] op_sel_hi:[1,0,1] neg_lo:[1,0,0]
    ds_write_b64 v31, v[88:89] offset:4608
    v_pk_fma_f32 v[64:65], v[26:27], v[88:89], v[90:91] op_sel_hi:[0,1,1]
    v_pk_fma_f32 v[90:91], v[26:27], v[88:89], v[64:65] op_sel:[1,1,0] op_sel_hi:[1,0,1] neg_lo:[1,0,0]
    ds_write_b64 v31, v[90:91] offset:5120
    v_pk_fma_f32 v[64:65], v[26:27], v[90:91], v[92:93] op_sel_hi:[0,1,1]
    v_pk_fma_f32 v[92:93], v[26:27], v[90:91], v[64:65] op_sel:[1,1,0] op_sel_hi:[1,0,1] neg_lo:[1,0,0]
    ds_write_b64 v31, v[92:93] offset:5632
    v_pk_fma_f32 v[64:65], v[26:27], v[92:93], v[94:95] op_sel_hi:[0,1,1]
    v_pk_fma_f32 v[94:95], v[26:27], v[92:93], v[64:65] op_sel:[1,1,0] op_sel_hi:[1,0,1] neg_lo:[1,0,0]
    ds_write_b64 v31, v[94:95] offset:6144
    v_pk_fma_f32 v[64:65], v[26:27], v[94:95], v[96:97] op_sel_hi:[0,1,1]
    v_pk_fma_f32 v[96:97], v[26:27], v[94:95], v[64:65] op_sel:[1,1,0] op_sel_hi:[1,0,1] neg_lo:[1,0,0]
    ds_write_b64 v31, v[96:97] offset:6656
    v_pk_fma_f32 v[64:65], v[26:27], v[96:97], v[98:99] op_sel_hi:[0,1,1]
    v_pk_fma_f32 v[98:99], v[26:27], v[96:97], v[64:65] op_sel:[1,1,0] op_sel_hi:[1,0,1] neg_lo:[1,0,0]
    ds_write_b64 v31, v[98:99] offset:7168
    v_pk_fma_f32 v[64:65], v[26:27], v[98:99], v[100:101] op_sel_hi:[0,1,1]
    v_pk_fma_f32 v[100:101], v[26:27], v[98:99], v[64:65] op_sel:[1,1,0] op_sel_hi:[1,0,1] neg_lo:[1,0,0]
    ds_write_b64 v31, v[100:101] offset:7680
gated_mix__ssm_conv_s5__linear_kernel_hedgehog__prompt_kernel_pdone40:
    s_cmp_eq_u32 s7, 0
    s_cbranch_scc1 gated_mix__ssm_conv_s5__linear_kernel_hedgehog__prompt_kernel_ok41
    s_waitcnt vmcnt(0)
    s_cmp_le_u32 s26, 0
    s_cbranch_scc1 gated_mix__ssm_conv_s5__linear_kernel_hedgehog__prompt_kernel_chkd42
    v_cmp_ne_u64 vcc, s[34:35], v[106:107]
    s_nop 3
    s_cmp_eq_u64 vcc, 0
    s_cselect_b32 s4, 1, 0
    s_or_b32 s6, s6, s4
    s_cmp_le_u32 s26, 1
    s_cbranch_scc1 gated_mix__ssm_conv_s5__linear_kernel_hedgehog__prompt_kernel_chkd42
    v_cmp_ne_u64 vcc, s[34:35], v[110:111]
    s_nop 3
    s_cmp_eq_u64 vcc, 0
    s_cselect_b32 s4, 2, 0
    s_or_b32 s6, s6, s4
    s_cmp_le_u32 s26, 2
    s_cbranch_scc1 gated_mix__ssm_conv_s5__linear_kernel_hedgehog__prompt_kernel_chkd42
    v_cmp_ne_u64 vcc, s[34:35], v[114:115]
    s_nop 3
    s_cmp_eq_u64 vcc, 0
    s_cselect_b32 s4, 4, 0
    s_or_b32 s6, s6, s4
    s_cmp_le_u32 s26, 3
    s_cbranch_scc1 gated_mix__ssm_conv_s5__linear_kernel_hedgehog__prompt_kernel_chkd42
    v_cmp_ne_u64 vcc, s[34:35], v[118:119]
    s_nop 3
    s_cmp_eq_u64 vcc, 0
    s_cselect_b32 s4, 8, 0
    s_or_b32 s6, s6, s4
    s_cmp_le_u32 s26, 4
    s_cbranch_scc1 gated_mix__ssm_conv_s5__linear_kernel_hedgehog__prompt_kernel_chkd42
    v_cmp_ne_u64 vcc, s[34:35], v[122:123]
    s_nop 3
    s_cmp_eq_u64 vcc, 0
    s_cselect_b32 s4, 16, 0
    s_or_b32 s6, s6, s4
    s_cmp_le_u32 s26, 5
    s_cbranch_scc1 gated_mix__ssm_conv_s5__linear_kernel_hedgehog__prompt_kernel_chkd42
    v_cmp_ne_u64 vcc, s[34:35], v[126:127]
    s_nop 3
    s_cmp_eq_u64 vcc, 0
    s_cselect_b32 s4, 32, 0
    s_or_b32 s6, s6, s4
    s_cmp_le_u32 s26, 6
    s_cbranch_scc1 gated_mix__ssm_conv_s5__linear_kernel_hedgehog__prompt_kernel_chkd42
    v_cmp_ne_u64 vcc, s[34:35], v[130:131]
    s_nop 3
    s_cmp_eq_u64 vcc, 0
    s_cselect_b32 s4, 64, 0
    s_or_b32 s6, s6, s4
    s_cmp_le_u32 s26, 7
    s_cbranch_scc1 gated_mix__ssm_conv_s5__linear_kernel_hedgehog__prompt_kernel_chkd42
    v_cmp_ne_u64 vcc, s[34:35], v[134:135]
    s_nop 3
    s_cmp_eq_u64 vcc, 0
    s_cselect_b32 s4, 128, 0
    s_or_b32 s6, s6, s4
    s_cmp_le_u32 s26, 8
    s_cbranch_scc1 gated_mix__ssm_conv_s5__linear_kernel_hedgehog__prompt_kernel_chkd42
    v_cmp_ne_u64 vcc, s[34:35], v[138:139]
    s_nop 3
    s_cmp_eq_u64 vcc, 0
    s_cselect_b32 s4, 256, 0
    s_or_b32 s6, s6, s4
    s_cmp_le_u32 s26, 9
    s_cbranch_scc1 gated_mix__ssm_conv_s5__linear_kernel_hedgehog__prompt_kernel_chkd42
    v_cmp_ne_u64 vcc, s[34:35], v[142:143]
    s_nop 3
    s_cmp_eq_u64 vcc, 0
    s_cselect_b32 s4, 512, 0
    s_or_b32 s6, s6, s4
    s_cmp_le_u32 s26, 10
    s_cbranch_scc1 gated_mix__ssm_conv_s5__linear_kernel_hedgehog__prompt_kernel_chkd42
    v_cmp_ne_u64 vcc, s[34:35], v[146:147]
    s_nop 3
    s_cmp_eq_u64 vcc, 0
    s_cselect_b32 s4, 1024, 0
    s_or_b32 s6, s6, s4
    s_cmp_le_u32 s26, 11
    s_cbranch_scc1 gated_mix__ssm_conv_s5__linear_kernel_hedgehog__prompt_kernel_chkd42
    v_cmp_ne_u64 vcc, s[34:35], v[150:151]
    s_nop 3
    s_cmp_eq_u64 vcc, 0
    s_cselect_b32 s4, 2048, 0
    s_or_b32 s6, s6, s4
    s_cmp_le_u32 s26, 12
    s_cbranch_scc1 gated_mix__ssm_conv_s5__linear_kernel_hedgehog__prompt_kernel_chkd42
    v_cmp_ne_u64 vcc, s[34:35], v[154:155]
    s_nop 3
    s_cmp_eq_u64 vcc, 0
    s_cselect_b32 s4, 4096, 0
    s_or_b32 s6, s6, s4
    s_cmp_le_u32 s26, 13
    s_cbranch_scc1 gated_mix__ssm_conv_s5__linear_kernel_hedgehog__prompt_kernel_chkd42
    v_cmp_ne_u64 vcc, s[34:35], v[158:159]
    s_nop 3
    s_cmp_eq_u64 vcc, 0
    s_cselect_b32 s4, 8192, 0
    s_or_b32 s6, s6, s4
    s_cmp_le_u32 s26, 14
    s_cbranch_scc1 gated_mix__ssm_conv_s5__linear_kernel_hedgehog__prompt_kernel_chkd42
    v_cmp_ne_u64 vcc, s[34:35], v[162:163]
    s_nop 3
    s_cmp_eq_u64 vcc, 0
    s_cselect_b32 s4, 16384, 0
    s_or_b32 s6, s6, s4
gated_mix__ssm_conv_s5__linear_kernel_hedgehog__prompt_kernel_chkd42:
    s_add_u32 s63, s63, 1
    s_cmp_ge_u32 s63, 400000
    s_cbranch_scc1 gated_mix__ssm_conv_s5__linear_kernel_hedgehog__prompt_kernel_ok41
    s_cmp_eq_u32 s6, s7
    s_cbranch_scc0 gated_mix__ssm_conv_s5__linear_kernel_hedgehog__prompt_kernel_poll22
gated_mix__ssm_conv_s5__linear_kernel_hedgehog__prompt_kernel_ok41:
    s_cmp_le_u32 s26, 0
    s_cbranch_scc1 gated_mix__ssm_conv_s5__linear_kernel_hedgehog__prompt_kernel_lbdone24
    v_pk_fma_f32 v[64:65], v[28:29], v[56:57], v[104:105] op_sel_hi:[0,1,1]
    v_pk_fma_f32 v[56:57], v[28:29], v[56:57], v[64:65] op_sel:[1,1,0] op_sel_hi:[1,0,1] neg_lo:[1,0,0]
    s_cmp_le_u32 s26, 1
    s_cbranch_scc1 gated_mix__ssm_conv_s5__linear_kernel_hedgehog__prompt_kernel_lbdone24
    v_pk_fma_f32 v[64:65], v[28:29], v[56:57], v[108:109] op_sel_hi:[0,1,1]
    v_pk_fma_f32 v[56:57], v[28:29], v[56:57], v[64:65] op_sel:[1,1,0] op_sel_hi:[1,0,1] neg_lo:[1,0,0]
    s_cmp_le_u32 s26, 2
    s_cbranch_scc1 gated_mix__ssm_conv_s5__linear_kernel_hedgehog__prompt_kernel_lbdone24
    v_pk_fma_f32 v[64:65], v[28:29], v[56:57], v[112:113] op_sel_hi:[0,1,1]
    v_pk_fma_f32 v[56:57], v[28:29], v[56:57], v[64:65] op_sel:[1,1,0] op_sel_hi:[1,0,1] neg_lo:[1,0,0]
    s_cmp_le_u32 s26, 3
    s_cbranch_scc1 gated_mix__ssm_conv_s5__linear_kernel_hedgehog__prompt_kernel_lbdone24
    v_pk_fma_f32 v[64:65], v[28:29], v[56:57], v[116:117] op_sel_hi:[0,1,1]
    v_pk_fma_f32 v[56:57], v[28:29], v[56:57], v[64:65] op_sel:[1,1,0] op_sel_hi:[1,0,1] neg_lo:[1,0,0]
    s_cmp_le_u32 s26, 4
    s_cbranch_scc1 gated_mix__ssm_conv_s5__linear_kernel_hedgehog__prompt_kernel_lbdone24
    v_pk_fma_f32 v[64:65], v[28:29], v[56:57], v[120:121] op_sel_hi:[0,1,1]
    v_pk_fma_f32 v[56:57], v[28:29], v[56:57], v[64:65] op_sel:[1,1,0] op_sel_hi:[1,0,1] neg_lo:[1,0,0]
    s_cmp_le_u32 s26, 5
    s_cbranch_scc1 gated_mix__ssm_conv_s5__linear_kernel_hedgehog__prompt_kernel_lbdone24
    v_pk_fma_f32 v[64:65], v[28:29], v[56:57], v[124:125] op_sel_hi:[0,1,1]
    v_pk_fma_f32 v[56:57], v[28:29], v[56:57], v[64:65] op_sel:[1,1,0] op_sel_hi:[1,0,1] neg_lo:[1,0,0]
    s_cmp_le_u32 s26, 6
    s_cbranch_scc1 gated_mix__ssm_conv_s5__linear_kernel_hedgehog__prompt_kernel_lbdone24
    v_pk_fma_f32 v[64:65], v[28:29], v[56:57], v[128:129] op_sel_hi:[0,1,1]
    v_pk_fma_f32 v[56:57], v[28:29], v[56:57], v[64:65] op_sel:[1,1,0] op_sel_hi:[1,0,1] neg_lo:[1,0,0]
    s_cmp_le_u32 s26, 7
    s_cbranch_scc1 gated_mix__ssm_conv_s5__linear_kernel_hedgehog__prompt_kernel_lbdone24
    v_pk_fma_f32 v[64:65], v[28:29], v[56:57], v[132:133] op_sel_hi:[0,1,1]
    v_pk_fma_f32 v[56:57], v[28:29], v[56:57], v[64:65] op_sel:[1,1,0] op_sel_hi:[1,0,1] neg_lo:[1,0,0]
    s_cmp_le_u32 s26, 8
    s_cbranch_scc1 gated_mix__ssm_conv_s5__linear_kernel_hedgehog__prompt_kernel_lbdone24
    v_pk_fma_f32 v[64:65], v[28:29], v[56:57], v[136:137] op_sel_hi:[0,1,1]
    v_pk_fma_f32 v[56:57], v[28:29], v[56:57], v[64:65] op_sel:[1,1,0] op_sel_hi:[1,0,1] neg_lo:[1,0,0]
    s_cmp_le_u32 s26, 9
    s_cbranch_scc1 gated_mix__ssm_conv_s5__linear_kernel_hedgehog__prompt_kernel_lbdone24
    v_pk_fma_f32 v[64:65], v[28:29], v[56:57], v[140:141] op_sel_hi:[0,1,1]
    v_pk_fma_f32 v[56:57], v[28:29], v[56:57], v[64:65] op_sel:[1,1,0] op_sel_hi:[1,0,1] neg_lo:[1,0,0]
    s_cmp_le_u32 s26, 10
    s_cbranch_scc1 gated_mix__ssm_conv_s5__linear_kernel_hedgehog__prompt_kernel_lbdone24
    v_pk_fma_f32 v[64:65], v[28:29], v[56:57], v[144:145] op_sel_hi:[0,1,1]
    v_pk_fma_f32 v[56:57], v[28:29], v[56:57], v[64:65] op_sel:[1,1,0] op_sel_hi:[1,0,1] neg_lo:[1,0,0]
    s_cmp_le_u32 s26, 11
    s_cbranch_scc1 gated_mix__ssm_conv_s5__linear_kernel_hedgehog__prompt_kernel_lbdone24
    v_pk_fma_f32 v[64:65], v[28:29], v[56:57], v[148:149] op_sel_hi:[0,1,1]
    v_pk_fma_f32 v[56:57], v[28:29], v[56:57], v[64:65] op_sel:[1,1,0] op_sel_hi:[1,0,1] neg_lo:[1,0,0]
    s_cmp_le_u32 s26, 12
    s_cbranch_scc1 gated_mix__ssm_conv_s5__linear_kernel_hedgehog__prompt_kernel_lbdone24
    v_pk_fma_f32 v[64:65], v[28:29], v[56:57], v[152:153] op_sel_hi:[0,1,1]
    v_pk_fma_f32 v[56:57], v[28:29], v[56:57], v[64:65] op_sel:[1,1,0] op_sel_hi:[1,0,1] neg_lo:[1,0,0]
    s_cmp_le_u32 s26, 13
    s_cbranch_scc1 gated_mix__ssm_conv_s5__linear_kernel_hedgehog__prompt_kernel_lbdone24
    v_pk_fma_f32 v[64:65], v[28:29], v[56:57], v[156:157] op_sel_hi:[0,1,1]
    v_pk_fma_f32 v[56:57], v[28:29], v[56:57], v[64:65] op_sel:[1,1,0] op_sel_hi:[1,0,1] neg_lo:[1,0,0]
    s_cmp_le_u32 s26, 14
    s_cbranch_scc1 gated_mix__ssm_conv_s5__linear_kernel_hedgehog__prompt_kernel_lbdone24
    v_pk_fma_f32 v[64:65], v[28:29], v[56:57], v[160:161] op_sel_hi:[0,1,1]
    v_pk_fma_f32 v[56:57], v[28:29], v[56:57], v[64:65] op_sel:[1,1,0] op_sel_hi:[1,0,1] neg_lo:[1,0,0]
gated_mix__ssm_conv_s5__linear_kernel_hedgehog__prompt_kernel_lbdone24:
    ds_write_b64 v62, v[56:57]
    v_mov_b32 v58, 152456
    v_mov_b32 v59, 1
    s_waitcnt lgkmcnt(0)
    s_mov_b64 s[60:61], exec
    s_mov_b64 exec, 1
    ds_add_u32 v58, v59
    s_mov_b64 exec, s[60:61]
    s_branch gated_mix__ssm_conv_s5__linear_kernel_hedgehog__prompt_kernel_gemm
gated_mix__ssm_conv_s5__linear_kernel_hedgehog__prompt_kernel_ldB:
    s_cmp_lg_u32 s3, 4
    s_cbranch_scc1 gated_mix__ssm_conv_s5__linear_kernel_hedgehog__prompt_kernel_noelect43
    s_cmp_ge_u32 s2, 8
    s_cbranch_scc1 gated_mix__ssm_conv_s5__linear_kernel_hedgehog__prompt_kernel_noelect43
    s_load_dwordx2 s[40:41], s[0:1], 120
    s_memrealtime s[42:43]
    s_waitcnt lgkmcnt(0)
    s_or_b32 s42, s42, 1
    v_mov_b32 v100, s42
    v_mov_b32 v101, s43
    v_mov_b32 v102, 0
    v_mov_b32 v103, 0
    v_mov_b32 v104, 128
    s_mov_b64 s[60:61], exec
    s_mov_b64 exec, 1
    global_atomic_cmpswap_x2 v104, v[100:103], s[40:41] sc1
    s_mov_b64 exec, s[60:61]
gated_mix__ssm_conv_s5__linear_kernel_hedgehog__prompt_kernel_noelect43:
    s_sub_u32 s31, s3, 4
    v_and_b32 v2, 63, v0
    v_lshrrev_b32 v12, 3, v2
    v_and_b32 v13, 3, v12
    v_and_b32 v14, 1, v13
    v_lshlrev_b32 v14, 2, v14
    v_lshrrev_b32 v15, 1, v13
    v_add_u32 v14, v14, v15
    v_lshrrev_b32 v15, 5, v2
    v_lshl_add_u32 v14, v15, 3, v14
    s_and_b32 s62, s31, 1
    s_lshl_b32 s63, s62, 4
    s_and_b32 s4, s31, 2
    s_add_u32 s63, s63, s4
    v_add_u32 v14, s63, v14
    v_mul_u32_u24 v14, 1280, v14
    s_lshl_b32 s63, s62, 2
    v_lshrrev_b32 v15, 4, v2
    v_add_u32 v15, s63, v15
    v_and_b32 v16, 7, v2
    v_xor_b32 v15, v15, v16
    v_lshlrev_b32 v15, 4, v15
    v_add_u32 v3, v14, v15
    s_mul_i32 s4, s26, 163840
    s_lshl_b32 s5, s31, 10
    s_add_u32 s40, s4, 0
    s_add_u32 s84, s5, 0
    s_add_u32 s41, s4, 40960
    s_add_u32 s85, s5, 4096
    s_add_u32 s42, s4, 81920
    s_add_u32 s86, s5, 8192
    s_add_u32 s43, s4, 122880
    s_add_u32 s87, s5, 12288
    s_lshl_b32 s56, s30, 7
    s_mul_i32 s57, s30, 245760
    s_mov_b32 s58, 0
    s_waitcnt lgkmcnt(0)
    s_mov_b32 s8, s24
    s_and_b32 s9, s25, 0xffff
    s_mov_b32 s10, 2621440
    s_mov_b32 s11, 0x20000
    s_add_u32 s62, s40, s56
    s_add_u32 m0, s84, s58
    s_nop 0
    buffer_load_dwordx4 v3, s[8:11], s62 offen lds
    s_add_u32 s62, s41, s56
    s_add_u32 m0, s85, s58
    s_nop 0
    buffer_load_dwordx4 v3, s[8:11], s62 offen lds
    s_add_u32 s62, s42, s56
    s_add_u32 m0, s86, s58
    s_nop 0
    buffer_load_dwordx4 v3, s[8:11], s62 offen lds
    s_add_u32 s62, s43, s56
    s_add_u32 m0, s87, s58
    s_nop 0
    buffer_load_dwordx4 v3, s[8:11], s62 offen lds
    s_and_b32 s62, s31, 1
    s_lshl_b32 s63, s62, 3
    v_add_u32 v14, s63, v12
    v_mul_u32_u24 v14, 1280, v14
    v_add_u32 v4, v14, v15
    s_cmp_ge_u32 s31, 2
    s_cselect_b32 s36, s22, s20
    s_cselect_b32 s37, s23, s21
    s_and_b32 s37, s37, 0xffff
    s_mov_b32 s38, 819200
    s_mov_b32 s39, 0x20000
    s_mul_i32 s4, s27, 102400
    s_add_u32 s44, s4, 20480
    s_add_u32 s88, s5, 27648
    s_add_u32 s45, s4, 40960
    s_add_u32 s89, s5, 31744
    s_add_u32 s46, s4, 61440
    s_add_u32 s90, s5, 35840
    s_add_u32 s47, s4, 81920
    s_add_u32 s91, s5, 39936
    s_add_u32 s62, s44, s56
    s_add_u32 m0, s88, s58
    s_nop 0
    buffer_load_dwordx4 v4, s[36:39], s62 offen lds
    s_add_u32 s62, s45, s56
    s_add_u32 m0, s89, s58
    s_nop 0
    buffer_load_dwordx4 v4, s[36:39], s62 offen lds
    s_add_u32 s62, s46, s56
    s_add_u32 m0, s90, s58
    s_nop 0
    buffer_load_dwordx4 v4, s[36:39], s62 offen lds
    s_add_u32 s62, s47, s56
    s_add_u32 m0, s91, s58
    s_nop 0
    buffer_load_dwordx4 v4, s[36:39], s62 offen lds
    s_mov_b32 s12, s18
    s_and_b32 s13, s19, 0xffff
    s_mov_b32 s14, 2457600
    s_mov_b32 s15, 0x20000
    s_add_u32 s62, s31, 0
    s_mov_b32 s48, 0
    s_mov_b32 s92, 16384
    s_lshl_b32 s63, s62, 10
    s_add_u32 s92, s92, s63
    s_mul_i32 s63, s27, 160
    s_add_u32 s48, s48, s63
    s_lshl_b32 s62, s62, 6
    v_add_u32 v12, s62, v2
    v_mul_u32_u24 v13, 745, v12
    v_lshrrev_b32 v13, 16, v13
    v_mul_u32_u24 v14, 88, v13
    v_sub_u32 v14, v12, v14
    v_mul_u32_u24 v15, 205, v14
    v_lshrrev_b32 v15, 11, v15
    v_mul_u32_u24 v16, 10, v15
    v_sub_u32 v16, v14, v16
    v_lshl_add_u32 v15, v13, 3, v15
    v_mul_u32_u24 v15, 3840, v15
    v_lshl_add_u32 v15, v16, 4, v15
    v_cmp_gt_u32 vcc, 80, v14
    v_mov_b32 v16, 0x7fffffff
    s_nop 0
    v_cndmask_b32 v6, v16, v15, vcc
    s_add_u32 s62, s48, s57
    s_add_u32 m0, s92, s58
    s_nop 0
    buffer_load_dwordx4 v6, s[12:15], s62 offen lds
    s_add_u32 s62, s31, 4
    s_mov_b32 s49, 0
    s_mov_b32 s93, 16384
    s_lshl_b32 s63, s62, 10
    s_add_u32 s93, s93, s63
    s_mul_i32 s63, s27, 160
    s_add_u32 s49, s49, s63
    s_lshl_b32 s62, s62, 6
    v_add_u32 v12, s62, v2
    v_mul_u32_u24 v13, 745, v12
    v_lshrrev_b32 v13, 16, v13
    v_mul_u32_u24 v14, 88, v13
    v_sub_u32 v14, v12, v14
    v_mul_u32_u24 v15, 205, v14
    v_lshrrev_b32 v15, 11, v15
    v_mul_u32_u24 v16, 10, v15
    v_sub_u32 v16, v14, v16
    v_lshl_add_u32 v15, v13, 3, v15
    v_mul_u32_u24 v15, 3840, v15
    v_lshl_add_u32 v15, v16, 4, v15
    v_cmp_gt_u32 vcc, 80, v14
    v_mov_b32 v16, 0x7fffffff
    s_nop 0
    v_cndmask_b32 v7, v16, v15, vcc
    s_add_u32 s62, s49, s57
    s_add_u32 m0, s93, s58
    s_nop 0
    buffer_load_dwordx4 v7, s[12:15], s62 offen lds
    s_add_u32 s62, s31, 8
    s_mov_b32 s50, 0
    s_mov_b32 s94, 16384
    s_lshl_b32 s63, s62, 10
    s_add_u32 s94, s94, s63
    s_mul_i32 s63, s27, 160
    s_add_u32 s50, s50, s63
    s_lshl_b32 s62, s62, 6
    v_add_u32 v12, s62, v2
    v_mul_u32_u24 v13, 745, v12
    v_lshrrev_b32 v13, 16, v13
    v_mul_u32_u24 v14, 88, v13
    v_sub_u32 v14, v12, v14
    v_mul_u32_u24 v15, 205, v14
    v_lshrrev_b32 v15, 11, v15
    v_mul_u32_u24 v16, 10, v15
    v_sub_u32 v16, v14, v16
    v_lshl_add_u32 v15, v13, 3, v15
    v_mul_u32_u24 v15, 3840, v15
    v_lshl_add_u32 v15, v16, 4, v15
    v_cmp_gt_u32 vcc, 80, v14
    v_mov_b32 v16, 0x7fffffff
    s_nop 0
    v_cndmask_b32 v8, v16, v15, vcc
    s_cmp_ge_u32 s31, 3
    s_cbranch_scc1 gated_mix__ssm_conv_s5__linear_kernel_hedgehog__prompt_kernel_skipdma44
    s_add_u32 s62, s50, s57
    s_add_u32 m0, s94, s58
    s_nop 0
    buffer_load_dwordx4 v8, s[12:15], s62 offen lds
gated_mix__ssm_conv_s5__linear_kernel_hedgehog__prompt_kernel_skipdma44:
    s_add_u32 s56, s56, 128
    s_add_u32 s57, s57, 245760
    s_cmp_ge_u32 s56, 1280
    s_cselect_b32 s56, 0, s56
    s_cselect_b32 s57, 0, s57
    s_add_u32 s58, s58, 44032
    s_cmp_ge_u32 s58, 132096
    s_cselect_b32 s58, 0, s58
    s_mov_b32 s59, -2
    s_mov_b32 s83, 7
gated_mix__ssm_conv_s5__linear_kernel_hedgehog__prompt_kernel_ldloop45:
    s_cmp_eq_u32 s59, -2
    s_cbranch_scc1 gated_mix__ssm_conv_s5__linear_kernel_hedgehog__prompt_kernel_ldb046
    s_waitcnt vmcnt(10)
    s_barrier
gated_mix__ssm_conv_s5__linear_kernel_hedgehog__prompt_kernel_ldb046:
    s_add_u32 s62, s40, s56
    s_add_u32 m0, s84, s58
    s_nop 0
    buffer_load_dwordx4 v3, s[8:11], s62 offen lds
    s_add_u32 s62, s41, s56
    s_add_u32 m0, s85, s58
    s_nop 0
    buffer_load_dwordx4 v3, s[8:11], s62 offen lds
    s_add_u32 s62, s42, s56
    s_add_u32 m0, s86, s58
    s_nop 0
    buffer_load_dwordx4 v3, s[8:11], s62 offen lds
    s_add_u32 s62, s43, s56
    s_add_u32 m0, s87, s58
    s_nop 0
    buffer_load_dwordx4 v3, s[8:11], s62 offen lds
    s_add_u32 s62, s44, s56
    s_add_u32 m0, s88, s58
    s_nop 0
    buffer_load_dwordx4 v4, s[36:39], s62 offen lds
    s_add_u32 s62, s45, s56
    s_add_u32 m0, s89, s58
    s_nop 0
    buffer_load_dwordx4 v4, s[36:39], s62 offen lds
    s_add_u32 s62, s46, s56
    s_add_u32 m0, s90, s58
    s_nop 0
    buffer_load_dwordx4 v4, s[36:39], s62 offen lds
    s_add_u32 s62, s47, s56
    s_add_u32 m0, s91, s58
    s_nop 0
    buffer_load_dwordx4 v4, s[36:39], s62 offen lds
    s_add_u32 s62, s48, s57
    s_add_u32 m0, s92, s58
    s_nop 0
    buffer_load_dwordx4 v6, s[12:15], s62 offen lds
    s_add_u32 s62, s49, s57
    s_add_u32 m0, s93, s58
    s_nop 0
    buffer_load_dwordx4 v7, s[12:15], s62 offen lds
    s_cmp_ge_u32 s31, 3
    s_cbranch_scc1 gated_mix__ssm_conv_s5__linear_kernel_hedgehog__prompt_kernel_skipdma47
    s_add_u32 s62, s50, s57
    s_add_u32 m0, s94, s58
    s_nop 0
    buffer_load_dwordx4 v8, s[12:15], s62 offen lds
gated_mix__ssm_conv_s5__linear_kernel_hedgehog__prompt_kernel_skipdma47:
    s_add_u32 s56, s56, 128
    s_add_u32 s57, s57, 245760
    s_cmp_ge_u32 s56, 1280
    s_cselect_b32 s56, 0, s56
    s_cselect_b32 s57, 0, s57
    s_add_u32 s58, s58, 44032
    s_cmp_ge_u32 s58, 132096
    s_cselect_b32 s58, 0, s58
    s_add_u32 s59, s59, 1
    s_cmp_lg_u32 s59, s83
    s_cbranch_scc1 gated_mix__ssm_conv_s5__linear_kernel_hedgehog__prompt_kernel_ldloop45
    s_cmp_eq_u32 s3, 4
    s_cbranch_scc1 gated_mix__ssm_conv_s5__linear_kernel_hedgehog__prompt_kernel_helper48
    v_and_b32 v120, 63, v0
    v_and_b32 v121, 15, v0
    v_bfe_u32 v122, v0, 4, 2
    v_lshlrev_b32 v123, 4, v120
    v_mov_b32 v139, 0x7fffffff
    s_and_b32 s98, s2, 7
    s_lshr_b32 s99, s2, 3
    s_and_b32 s100, s99, 7
    s_lshr_b32 s99, s99, 3
    s_lshl_b32 s98, s98, 2
    s_add_u32 s98, s98, s99
    s_sub_u32 s99, s3, 5
    s_lshl_b32 s99, s99, 5
    s_add_u32 s98, s98, s99
    s_mul_i32 s99, s100, 40
    s_add_u32 s99, s99, s98
    s_mul_i32 s100, s100, 20
    s_add_u32 s100, s100, s98
    s_add_u32 s100, s100, 280
    s_cmp_lt_u32 s98, 40
    s_cselect_b32 s29, s99, s100
    s_cmp_ge_u32 s98, 60
    s_cselect_b32 s29, 999, s29
    s_mov_b32 s95, 0
    s_cmp_eq_u32 s3, 7
    s_cbranch_scc1 gated_mix__ssm_conv_s5__linear_kernel_hedgehog__prompt_kernel_sg50
    s_cmp_ge_u32 s29, 320
    s_cbranch_scc1 gated_mix__ssm_conv_s5__linear_kernel_hedgehog__prompt_kernel_sw49
    s_mov_b32 s95, 1
    s_load_dwordx4 s[16:19], s[0:1], 40
    s_load_dwordx4 s[20:23], s[0:1], 8
    s_load_dwordx2 s[24:25], s[0:1], 56
    s_mul_i32 s30, s29, 1639
    s_lshr_b32 s30, s30, 16
    s_mul_i32 s60, s30, 40
    s_sub_u32 s60, s29, s60
    s_mul_i32 s61, s30, 5
    v_mul_u32_u24 v128, 1280, v121
    v_and_b32 v129, 1, v122
    v_lshl_add_u32 v128, v129, 4, v128
    s_lshl_b32 s30, s60, 5
    v_lshl_add_u32 v124, v121, 1, s30
    s_mul_i32 s51, s61, 20480
    s_add_u32 s51, s51, s30
    s_waitcnt lgkmcnt(0)
    s_mov_b32 s32, s16
    s_and_b32 s33, s17, 0xffff
    s_mov_b32 s34, 819200
    s_mov_b32 s35, 0x20000
    s_mov_b32 s52, s18
    s_and_b32 s53, s19, 0xffff
    s_mov_b32 s54, 819200
    s_mov_b32 s55, 0x20000
    s_add_u32 s30, s51, 0
    buffer_load_dwordx4 v[32:35], v128, s[32:35], s30 offen
    buffer_load_dwordx4 v[36:39], v128, s[52:55], s30 offen
    s_add_u32 s30, s51, 20480
    buffer_load_dwordx4 v[40:43], v128, s[32:35], s30 offen
    buffer_load_dwordx4 v[44:47], v128, s[52:55], s30 offen
    s_add_u32 s30, s51, 40960
    buffer_load_dwordx4 v[48:51], v128, s[32:35], s30 offen
    buffer_load_dwordx4 v[52:55], v128, s[52:55], s30 offen
    s_add_u32 s30, s51, 61440
    buffer_load_dwordx4 v[56:59], v128, s[32:35], s30 offen
    buffer_load_dwordx4 v[60:63], v128, s[52:55], s30 offen
    s_add_u32 s30, s51, 81920
    buffer_load_dwordx4 v[64:67], v128, s[32:35], s30 offen
    buffer_load_dwordx4 v[68:71], v128, s[52:55], s30 offen
    s_mov_b32 s72, s20
    s_and_b32 s73, s21, 0xffff
    s_mov_b32 s74, 1280
    s_mov_b32 s75, 0x20000
    s_mov_b32 s76, s22
    s_and_b32 s77, s23, 0xffff
    s_mov_b32 s78, 1280
    s_mov_b32 s79, 0x20000
    s_mov_b32 s68, s24
    s_and_b32 s69, s25, 0xffff
    s_mov_b32 s70, 1280
    s_mov_b32 s71, 0x20000
    buffer_load_ushort v125, v124, s[72:75], 0 offen
    buffer_load_ushort v126, v124, s[76:79], 0 offen
    buffer_load_ushort v127, v124, s[68:71], 0 offen
    s_waitcnt vmcnt(23)
    s_barrier
    s_waitcnt vmcnt(13)
    s_barrier
    s_branch gated_mix__ssm_conv_s5__linear_kernel_hedgehog__prompt_kernel_pend55
gated_mix__ssm_conv_s5__linear_kernel_hedgehog__prompt_kernel_sw49:
    s_cmp_ge_u32 s29, 480
    s_cbranch_scc1 gated_mix__ssm_conv_s5__linear_kernel_hedgehog__prompt_kernel_p4054
    s_mov_b32 s95, 2
    s_load_dwordx2 s[16:17], s[0:1], 96
    s_sub_u32 s29, s29, 320
    s_mul_i32 s30, s29, 3277
    s_lshr_b32 s30, s30, 16
    s_mul_i32 s60, s30, 20
    s_sub_u32 s60, s29, s60
    s_mul_i32 s61, s30, 5
    s_lshr_b32 s30, s60, 1
    s_mul_i32 s30, s30, 80
    s_and_b32 s51, s60, 1
    s_lshl_b32 s51, s51, 3
    s_add_u32 s30, s30, s51
    s_sub_u32 s51, s60, 16
    s_mul_i32 s51, s51, 160
    s_add_u32 s51, s51, 16
    s_cmp_lt_u32 s60, 16
    s_cselect_b32 s30, s30, s51
    s_cselect_b32 s82, 4, 80
    v_mul_u32_u24 v128, 25600, v122
    v_lshl_add_u32 v128, v121, 1, v128
    s_mul_i32 s30, s30, 1280
    s_lshl_b32 s51, s61, 5
    s_add_u32 s30, s30, s51
    s_mul_i32 s82, s82, 1280
    s_waitcnt lgkmcnt(0)
    s_mov_b32 s32, s16
    s_and_b32 s33, s17, 0xffff
    s_mov_b32 s34, 819200
    s_mov_b32 s35, 0x20000
    s_add_u32 s51, s30, 0
    buffer_load_ushort v32, v128, s[32:35], s51 offen
    s_add_u32 s51, s30, 1280
    buffer_load_ushort v33, v128, s[32:35], s51 offen
    s_add_u32 s51, s30, 2560
    buffer_load_ushort v34, v128, s[32:35], s51 offen
    s_add_u32 s51, s30, 3840
    buffer_load_ushort v35, v128, s[32:35], s51 offen
    s_add_u32 s51, s30, s82
    s_add_u32 s51, s51, 0
    buffer_load_ushort v36, v128, s[32:35], s51 offen
    s_add_u32 s51, s30, s82
    s_add_u32 s51, s51, 1280
    buffer_load_ushort v37, v128, s[32:35], s51 offen
    s_add_u32 s51, s30, s82
    s_add_u32 s51, s51, 2560
    buffer_load_ushort v38, v128, s[32:35], s51 offen
    s_add_u32 s51, s30, s82
    s_add_u32 s51, s51, 3840
    buffer_load_ushort v39, v128, s[32:35], s51 offen
    s_add_u32 s51, s30, 32
    buffer_load_ushort v40, v128, s[32:35], s51 offen
    s_add_u32 s51, s30, 1312
    buffer_load_ushort v41, v128, s[32:35], s51 offen
    s_add_u32 s51, s30, 2592
    buffer_load_ushort v42, v128, s[32:35], s51 offen
    s_add_u32 s51, s30, 3872
    buffer_load_ushort v43, v128, s[32:35], s51 offen
    s_add_u32 s51, s30, s82
    s_add_u32 s51, s51, 32
    buffer_load_ushort v44, v128, s[32:35], s51 offen
    s_add_u32 s51, s30, s82
    s_add_u32 s51, s51, 1312
    buffer_load_ushort v45, v128, s[32:35], s51 offen
    s_add_u32 s51, s30, s82
    s_add_u32 s51, s51, 2592
    buffer_load_ushort v46, v128, s[32:35], s51 offen
    s_add_u32 s51, s30, s82
    s_add_u32 s51, s51, 3872
    buffer_load_ushort v47, v128, s[32:35], s51 offen
    s_add_u32 s51, s30, 64
    buffer_load_ushort v48, v128, s[32:35], s51 offen
    s_add_u32 s51, s30, 1344
    buffer_load_ushort v49, v128, s[32:35], s51 offen
    s_add_u32 s51, s30, 2624
    buffer_load_ushort v50, v128, s[32:35], s51 offen
    s_add_u32 s51, s30, 3904
    buffer_load_ushort v51, v128, s[32:35], s51 offen
    s_add_u32 s51, s30, s82
    s_add_u32 s51, s51, 64
    buffer_load_ushort v52, v128, s[32:35], s51 offen
    s_add_u32 s51, s30, s82
    s_add_u32 s51, s51, 1344
    buffer_load_ushort v53, v128, s[32:35], s51 offen
    s_add_u32 s51, s30, s82
    s_add_u32 s51, s51, 2624
    buffer_load_ushort v54, v128, s[32:35], s51 offen
    s_add_u32 s51, s30, s82
    s_add_u32 s51, s51, 3904
    buffer_load_ushort v55, v128, s[32:35], s51 offen
    s_add_u32 s51, s30, 96
    buffer_load_ushort v56, v128, s[32:35], s51 offen
    s_add_u32 s51, s30, 1376
    buffer_load_ushort v57, v128, s[32:35], s51 offen
    s_add_u32 s51, s30, 2656
    buffer_load_ushort v58, v128, s[32:35], s51 offen
    s_add_u32 s51, s30, 3936
    buffer_load_ushort v59, v128, s[32:35], s51 offen
    s_add_u32 s51, s30, s82
    s_add_u32 s51, s51, 96
    buffer_load_ushort v60, v128, s[32:35], s51 offen
    s_add_u32 s51, s30, s82
    s_add_u32 s51, s51, 1376
    buffer_load_ushort v61, v128, s[32:35], s51 offen
    s_add_u32 s51, s30, s82
    s_add_u32 s51, s51, 2656
    buffer_load_ushort v62, v128, s[32:35], s51 offen
    s_add_u32 s51, s30, s82
    s_add_u32 s51, s51, 3936
    buffer_load_ushort v63, v128, s[32:35], s51 offen
    s_add_u32 s51, s30, 128
    buffer_load_ushort v64, v128, s[32:35], s51 offen
    s_add_u32 s51, s30, 1408
    buffer_load_ushort v65, v128, s[32:35], s51 offen
    s_add_u32 s51, s30, 2688
    buffer_load_ushort v66, v128, s[32:35], s51 offen
    s_add_u32 s51, s30, 3968
    buffer_load_ushort v67, v128, s[32:35], s51 offen
    s_add_u32 s51, s30, s82
    s_add_u32 s51, s51, 128
    buffer_load_ushort v68, v128, s[32:35], s51 offen
    s_add_u32 s51, s30, s82
    s_add_u32 s51, s51, 1408
    buffer_load_ushort v69, v128, s[32:35], s51 offen
    s_add_u32 s51, s30, s82
    s_add_u32 s51, s51, 2688
    buffer_load_ushort v70, v128, s[32:35], s51 offen
    s_add_u32 s51, s30, s82
    s_add_u32 s51, s51, 3968
    buffer_load_ushort v71, v128, s[32:35], s51 offen
    s_waitcnt vmcnt(50)
    s_barrier
    s_waitcnt vmcnt(40)
    s_barrier
    s_branch gated_mix__ssm_conv_s5__linear_kernel_hedgehog__prompt_kernel_pend55
gated_mix__ssm_conv_s5__linear_kernel_hedgehog__prompt_kernel_sg50:
    s_mov_b32 s95, 3
    s_load_dwordx2 s[16:17], s[0:1], 0
    s_load_dwordx2 s[18:19], s[0:1], 104
    s_lshl_b32 s29, s26, 4
    s_add_u32 s29, s29, s28
    s_mul_i32 s30, s29, 10240
    v_lshrrev_b32 v124, 3, v120
    v_and_b32 v125, 7, v120
    v_lshlrev_b32 v129, 4, v125
    v_mul_u32_u24 v128, 1280, v124
    v_add_u32 v128, v128, v129
    s_waitcnt lgkmcnt(0)
    s_mov_b32 s32, s16
    s_and_b32 s33, s17, 0xffff
    s_mov_b32 s34, 2621440
    s_mov_b32 s35, 0x20000
    s_mov_b32 s52, s18
    s_and_b32 s53, s19, 0xffff
    s_mov_b32 s54, 1280
    s_mov_b32 s55, 0x20000
    buffer_load_dwordx4 v[32:35], v128, s[32:35], s30 offen offset:0
    buffer_load_dwordx4 v[72:75], v129, s[52:55], 0 offen offset:0
    buffer_load_dwordx4 v[36:39], v128, s[32:35], s30 offen offset:128
    buffer_load_dwordx4 v[76:79], v129, s[52:55], 0 offen offset:128
    buffer_load_dwordx4 v[40:43], v128, s[32:35], s30 offen offset:256
    buffer_load_dwordx4 v[80:83], v129, s[52:55], 0 offen offset:256
    buffer_load_dwordx4 v[44:47], v128, s[32:35], s30 offen offset:384
    buffer_load_dwordx4 v[84:87], v129, s[52:55], 0 offen offset:384
    buffer_load_dwordx4 v[48:51], v128, s[32:35], s30 offen offset:512
    buffer_load_dwordx4 v[88:91], v129, s[52:55], 0 offen offset:512
    buffer_load_dwordx4 v[52:55], v128, s[32:35], s30 offen offset:640
    buffer_load_dwordx4 v[92:95], v129, s[52:55], 0 offen offset:640
    buffer_load_dwordx4 v[56:59], v128, s[32:35], s30 offen offset:768
    buffer_load_dwordx4 v[96:99], v129, s[52:55], 0 offen offset:768
    buffer_load_dwordx4 v[60:63], v128, s[32:35], s30 offen offset:896
    buffer_load_dwordx4 v[100:103], v129, s[52:55], 0 offen offset:896
    buffer_load_dwordx4 v[64:67], v128, s[32:35], s30 offen offset:1024
    buffer_load_dwordx4 v[104:107], v129, s[52:55], 0 offen offset:1024
    buffer_load_dwordx4 v[68:71], v128, s[32:35], s30 offen offset:1152
    buffer_load_dwordx4 v[108:111], v129, s[52:55], 0 offen offset:1152
    s_waitcnt vmcnt(30)
    s_barrier
    s_waitcnt vmcnt(20)
    s_barrier
    s_branch gated_mix__ssm_conv_s5__linear_kernel_hedgehog__prompt_kernel_pend55
gated_mix__ssm_conv_s5__linear_kernel_hedgehog__prompt_kernel_p4054:
    s_waitcnt vmcnt(10)
    s_barrier
    s_waitcnt vmcnt(0)
    s_barrier
gated_mix__ssm_conv_s5__linear_kernel_hedgehog__prompt_kernel_pend55:
    s_load_dwordx2 s[16:17], s[0:1], 128
    s_waitcnt vmcnt(0) lgkmcnt(0)
    s_mov_b32 s8, s16
    s_and_b32 s9, s17, 0xffff
    s_mov_b32 s10, 20971520
    s_mov_b32 s11, 0x20000
    s_cmp_eq_u32 s95, 2
    s_cbranch_scc1 gated_mix__ssm_conv_s5__linear_kernel_hedgehog__prompt_kernel_fw56
    s_cmp_eq_u32 s95, 3
    s_cbranch_scc1 gated_mix__ssm_conv_s5__linear_kernel_hedgehog__prompt_kernel_fg57
    s_cmp_eq_u32 s95, 0
    s_cbranch_scc1 gated_mix__ssm_conv_s5__linear_kernel_hedgehog__prompt_kernel_fn58
    v_lshlrev_b32 v125, 16, v125
    v_lshlrev_b32 v126, 16, v126
    v_lshlrev_b32 v127, 16, v127
    v_mul_f32 v132, 0x3fb8aa3b, v127
    v_exp_f32 v132, v132
    s_nop 0
    v_cvt_pk_bf16_f32 v132, v132, v132
    v_lshlrev_b32 v132, 16, v132
    v_mul_f32 v133, v132, v126
    v_mul_f32 v132, v132, v125
    v_mul_f32 v132, 0x3fb8aa3b, v132
    v_exp_f32 v132, v132
    v_mul_f32 v133, 0x3e22f983, v133
    v_rndne_f32 v130, v133
    v_sub_f32 v133, v133, v130
    v_cos_f32 v130, v133
    v_sin_f32 v131, v133
    v_mul_f32 v130, v130, v132
    v_mul_f32 v131, v131, v132
    v_add_f32 v130, -1.0, v130
    v_mul_f32 v132, v125, v125
    v_fmac_f32 v132, v126, v126
    v_rcp_f32 v132, v132
    v_mul_f32 v134, v130, v125
    v_fmac_f32 v134, v131, v126
    v_mul_f32 v135, v131, v125
    v_fma_f32 v135, -v130, v126, v135
    v_add_f32 v132, v132, v132
    v_mul_f32 v134, v134, v132
    v_mul_f32 v135, v135, v132
    s_sub_u32 s30, s3, 5
    s_lshl_b32 s30, s30, 7
    s_add_u32 s30, s30, 152576
    v_lshl_add_u32 v136, v121, 3, s30
    ds_write_b64 v136, v[134:135]
    v_lshl_add_u32 v136, v129, 6, s30
    s_waitcnt lgkmcnt(0)
    ds_read_b128 v[80:83], v136 offset:0
    ds_read_b128 v[84:87], v136 offset:16
    ds_read_b128 v[88:91], v136 offset:32
    ds_read_b128 v[92:95], v136 offset:48
    v_cmp_gt_u32 vcc, 2, v122
    s_waitcnt lgkmcnt(0)
    v_sub_f32 v130, 0, v81
    v_sub_f32 v131, 0, v80
    v_cndmask_b32 v80, v130, v80, vcc
    v_cndmask_b32 v81, v131, v130, vcc
    v_sub_f32 v130, 0, v83
    v_sub_f32 v131, 0, v82
    v_cndmask_b32 v82, v130, v82, vcc
    v_cndmask_b32 v83, v131, v130, vcc
    v_sub_f32 v130, 0, v85
    v_sub_f32 v131, 0, v84
    v_cndmask_b32 v84, v130, v84, vcc
    v_cndmask_b32 v85, v131, v130, vcc
    v_sub_f32 v130, 0, v87
    v_sub_f32 v131, 0, v86
    v_cndmask_b32 v86, v130, v86, vcc
    v_cndmask_b32 v87, v131, v130, vcc
    v_sub_f32 v130, 0, v89
    v_sub_f32 v131, 0, v88
    v_cndmask_b32 v88, v130, v88, vcc
    v_cndmask_b32 v89, v131, v130, vcc
    v_sub_f32 v130, 0, v91
    v_sub_f32 v131, 0, v90
    v_cndmask_b32 v90, v130, v90, vcc
    v_cndmask_b32 v91, v131, v130, vcc
    v_sub_f32 v130, 0, v93
    v_sub_f32 v131, 0, v92
    v_cndmask_b32 v92, v130, v92, vcc
    v_cndmask_b32 v93, v131, v130, vcc
    v_sub_f32 v130, 0, v95
    v_sub_f32 v131, 0, v94
    v_cndmask_b32 v94, v130, v94, vcc
    v_cndmask_b32 v95, v131, v130, vcc
    s_mul_i32 s30, s61, 40
    s_add_u32 s30, s30, s60
    s_lshl_b32 s30, s30, 10
    s_add_u32 s30, s30, 10485760
    v_lshlrev_b32 v130, 16, v32
    v_lshlrev_b32 v131, 16, v36
    v_mul_f32 v100, v80, v130
    v_fmac_f32 v100, v81, v131
    v_and_b32 v130, 0xffff0000, v32
    v_and_b32 v131, 0xffff0000, v36
    v_mul_f32 v101, v82, v130
    v_fmac_f32 v101, v83, v131
    v_lshlrev_b32 v130, 16, v33
    v_lshlrev_b32 v131, 16, v37
    v_mul_f32 v102, v84, v130
    v_fmac_f32 v102, v85, v131
    v_and_b32 v130, 0xffff0000, v33
    v_and_b32 v131, 0xffff0000, v37
    v_mul_f32 v103, v86, v130
    v_fmac_f32 v103, v87, v131
    v_lshlrev_b32 v130, 16, v34
    v_lshlrev_b32 v131, 16, v38
    v_mul_f32 v104, v88, v130
    v_fmac_f32 v104, v89, v131
    v_and_b32 v130, 0xffff0000, v34
    v_and_b32 v131, 0xffff0000, v38
    v_mul_f32 v105, v90, v130
    v_fmac_f32 v105, v91, v131
    v_lshlrev_b32 v130, 16, v35
    v_lshlrev_b32 v131, 16, v39
    v_mul_f32 v106, v92, v130
    v_fmac_f32 v106, v93, v131
    v_and_b32 v130, 0xffff0000, v35
    v_and_b32 v131, 0xffff0000, v39
    v_mul_f32 v107, v94, v130
    v_fmac_f32 v107, v95, v131
    v_cvt_pk_bf16_f32 v108, v100, v101
    v_cvt_pk_bf16_f32 v109, v102, v103
    v_cvt_pk_bf16_f32 v110, v104, v105
    v_cvt_pk_bf16_f32 v111, v106, v107
    s_add_u32 s51, s30, 0
    buffer_store_dwordx4 v[108:111], v123, s[8:11], s51 offen sc1
    v_lshlrev_b32 v130, 16, v40
    v_lshlrev_b32 v131, 16, v44
    v_mul_f32 v100, v80, v130
    v_fmac_f32 v100, v81, v131
    v_and_b32 v130, 0xffff0000, v40
    v_and_b32 v131, 0xffff0000, v44
    v_mul_f32 v101, v82, v130
    v_fmac_f32 v101, v83, v131
    v_lshlrev_b32 v130, 16, v41
    v_lshlrev_b32 v131, 16, v45
    v_mul_f32 v102, v84, v130
    v_fmac_f32 v102, v85, v131
    v_and_b32 v130, 0xffff0000, v41
    v_and_b32 v131, 0xffff0000, v45
    v_mul_f32 v103, v86, v130
    v_fmac_f32 v103, v87, v131
    v_lshlrev_b32 v130, 16, v42
    v_lshlrev_b32 v131, 16, v46
    v_mul_f32 v104, v88, v130
    v_fmac_f32 v104, v89, v131
    v_and_b32 v130, 0xffff0000, v42
    v_and_b32 v131, 0xffff0000, v46
    v_mul_f32 v105, v90, v130
    v_fmac_f32 v105, v91, v131
    v_lshlrev_b32 v130, 16, v43
    v_lshlrev_b32 v131, 16, v47
    v_mul_f32 v106, v92, v130
    v_fmac_f32 v106, v93, v131
    v_and_b32 v130, 0xffff0000, v43
    v_and_b32 v131, 0xffff0000, v47
    v_mul_f32 v107, v94, v130
    v_fmac_f32 v107, v95, v131
    v_cvt_pk_bf16_f32 v112, v100, v101
    v_cvt_pk_bf16_f32 v113, v102, v103
    v_cvt_pk_bf16_f32 v114, v104, v105
    v_cvt_pk_bf16_f32 v115, v106, v107
    s_add_u32 s51, s30, 40960
    buffer_store_dwordx4 v[112:115], v123, s[8:11], s51 offen sc1
    v_lshlrev_b32 v130, 16, v48
    v_lshlrev_b32 v131, 16, v52
    v_mul_f32 v100, v80, v130
    v_fmac_f32 v100, v81, v131
    v_and_b32 v130, 0xffff0000, v48
    v_and_b32 v131, 0xffff0000, v52
    v_mul_f32 v101, v82, v130
    v_fmac_f32 v101, v83, v131
    v_lshlrev_b32 v130, 16, v49
    v_lshlrev_b32 v131, 16, v53
    v_mul_f32 v102, v84, v130
    v_fmac_f32 v102, v85, v131
    v_and_b32 v130, 0xffff0000, v49
    v_and_b32 v131, 0xffff0000, v53
    v_mul_f32 v103, v86, v130
    v_fmac_f32 v103, v87, v131
    v_lshlrev_b32 v130, 16, v50
    v_lshlrev_b32 v131, 16, v54
    v_mul_f32 v104, v88, v130
    v_fmac_f32 v104, v89, v131
    v_and_b32 v130, 0xffff0000, v50
    v_and_b32 v131, 0xffff0000, v54
    v_mul_f32 v105, v90, v130
    v_fmac_f32 v105, v91, v131
    v_lshlrev_b32 v130, 16, v51
    v_lshlrev_b32 v131, 16, v55
    v_mul_f32 v106, v92, v130
    v_fmac_f32 v106, v93, v131
    v_and_b32 v130, 0xffff0000, v51
    v_and_b32 v131, 0xffff0000, v55
    v_mul_f32 v107, v94, v130
    v_fmac_f32 v107, v95, v131
    v_cvt_pk_bf16_f32 v108, v100, v101
    v_cvt_pk_bf16_f32 v109, v102, v103
    v_cvt_pk_bf16_f32 v110, v104, v105
    v_cvt_pk_bf16_f32 v111, v106, v107
    s_add_u32 s51, s30, 81920
    buffer_store_dwordx4 v[108:111], v123, s[8:11], s51 offen sc1
    v_lshlrev_b32 v130, 16, v56
    v_lshlrev_b32 v131, 16, v60
    v_mul_f32 v100, v80, v130
    v_fmac_f32 v100, v81, v131
    v_and_b32 v130, 0xffff0000, v56
    v_and_b32 v131, 0xffff0000, v60
    v_mul_f32 v101, v82, v130
    v_fmac_f32 v101, v83, v131
    v_lshlrev_b32 v130, 16, v57
    v_lshlrev_b32 v131, 16, v61
    v_mul_f32 v102, v84, v130
    v_fmac_f32 v102, v85, v131
    v_and_b32 v130, 0xffff0000, v57
    v_and_b32 v131, 0xffff0000, v61
    v_mul_f32 v103, v86, v130
    v_fmac_f32 v103, v87, v131
    v_lshlrev_b32 v130, 16, v58
    v_lshlrev_b32 v131, 16, v62
    v_mul_f32 v104, v88, v130
    v_fmac_f32 v104, v89, v131
    v_and_b32 v130, 0xffff0000, v58
    v_and_b32 v131, 0xffff0000, v62
    v_mul_f32 v105, v90, v130
    v_fmac_f32 v105, v91, v131
    v_lshlrev_b32 v130, 16, v59
    v_lshlrev_b32 v131, 16, v63
    v_mul_f32 v106, v92, v130
    v_fmac_f32 v106, v93, v131
    v_and_b32 v130, 0xffff0000, v59
    v_and_b32 v131, 0xffff0000, v63
    v_mul_f32 v107, v94, v130
    v_fmac_f32 v107, v95, v131
    v_cvt_pk_bf16_f32 v112, v100, v101
    v_cvt_pk_bf16_f32 v113, v102, v103
    v_cvt_pk_bf16_f32 v114, v104, v105
    v_cvt_pk_bf16_f32 v115, v106, v107
    s_add_u32 s51, s30, 122880
    buffer_store_dwordx4 v[112:115], v123, s[8:11], s51 offen sc1
    v_lshlrev_b32 v130, 16, v64
    v_lshlrev_b32 v131, 16, v68
    v_mul_f32 v100, v80, v130
    v_fmac_f32 v100, v81, v131
    v_and_b32 v130, 0xffff0000, v64
    v_and_b32 v131, 0xffff0000, v68
    v_mul_f32 v101, v82, v130
    v_fmac_f32 v101, v83, v131
    v_lshlrev_b32 v130, 16, v65
    v_lshlrev_b32 v131, 16, v69
    v_mul_f32 v102, v84, v130
    v_fmac_f32 v102, v85, v131
    v_and_b32 v130, 0xffff0000, v65
    v_and_b32 v131, 0xffff0000, v69
    v_mul_f32 v103, v86, v130
    v_fmac_f32 v103, v87, v131
    v_lshlrev_b32 v130, 16, v66
    v_lshlrev_b32 v131, 16, v70
    v_mul_f32 v104, v88, v130
    v_fmac_f32 v104, v89, v131
    v_and_b32 v130, 0xffff0000, v66
    v_and_b32 v131, 0xffff0000, v70
    v_mul_f32 v105, v90, v130
    v_fmac_f32 v105, v91, v131
    v_lshlrev_b32 v130, 16, v67
    v_lshlrev_b32 v131, 16, v71
    v_mul_f32 v106, v92, v130
    v_fmac_f32 v106, v93, v131
    v_and_b32 v130, 0xffff0000, v67
    v_and_b32 v131, 0xffff0000, v71
    v_mul_f32 v107, v94, v130
    v_fmac_f32 v107, v95, v131
    v_cvt_pk_bf16_f32 v108, v100, v101
    v_cvt_pk_bf16_f32 v109, v102, v103
    v_cvt_pk_bf16_f32 v110, v104, v105
    v_cvt_pk_bf16_f32 v111, v106, v107
    s_add_u32 s51, s30, 163840
    buffer_store_dwordx4 v[108:111], v123, s[8:11], s51 offen sc1
    s_branch gated_mix__ssm_conv_s5__linear_kernel_hedgehog__prompt_kernel_sdone59
gated_mix__ssm_conv_s5__linear_kernel_hedgehog__prompt_kernel_fw56:
    s_mul_i32 s30, s61, 20
    s_add_u32 s30, s30, s60
    s_lshl_b32 s30, s30, 10
    s_add_u32 s30, s30, 12582912
    v_lshl_or_b32 v80, v33, 16, v32
    v_lshl_or_b32 v81, v35, 16, v34
    v_lshl_or_b32 v82, v37, 16, v36
    v_lshl_or_b32 v83, v39, 16, v38
    s_add_u32 s51, s30, 0
    buffer_store_dwordx4 v[80:83], v123, s[8:11], s51 offen sc1
    v_lshl_or_b32 v84, v41, 16, v40
    v_lshl_or_b32 v85, v43, 16, v42
    v_lshl_or_b32 v86, v45, 16, v44
    v_lshl_or_b32 v87, v47, 16, v46
    s_add_u32 s51, s30, 20480
    buffer_store_dwordx4 v[84:87], v123, s[8:11], s51 offen sc1
    v_lshl_or_b32 v88, v49, 16, v48
    v_lshl_or_b32 v89, v51, 16, v50
    v_lshl_or_b32 v90, v53, 16, v52
    v_lshl_or_b32 v91, v55, 16, v54
    s_add_u32 s51, s30, 40960
    buffer_store_dwordx4 v[88:91], v123, s[8:11], s51 offen sc1
    v_lshl_or_b32 v92, v57, 16, v56
    v_lshl_or_b32 v93, v59, 16, v58
    v_lshl_or_b32 v94, v61, 16, v60
    v_lshl_or_b32 v95, v63, 16, v62
    s_add_u32 s51, s30, 61440
    buffer_store_dwordx4 v[92:95], v123, s[8:11], s51 offen sc1
    v_lshl_or_b32 v96, v65, 16, v64
    v_lshl_or_b32 v97, v67, 16, v66
    v_lshl_or_b32 v98, v69, 16, v68
    v_lshl_or_b32 v99, v71, 16, v70
    s_add_u32 s51, s30, 81920
    buffer_store_dwordx4 v[96:99], v123, s[8:11], s51 offen sc1
    s_branch gated_mix__ssm_conv_s5__linear_kernel_hedgehog__prompt_kernel_sdone59
gated_mix__ssm_conv_s5__linear_kernel_hedgehog__prompt_kernel_fg57:
    v_mov_b32 v130, 0
    v_mov_b32 v131, 0
    v_dot2c_f32_bf16 v130, v32, v72
    v_dot2c_f32_bf16 v131, v33, v73
    v_dot2c_f32_bf16 v130, v34, v74
    v_dot2c_f32_bf16 v131, v35, v75
    v_dot2c_f32_bf16 v130, v36, v76
    v_dot2c_f32_bf16 v131, v37, v77
    v_dot2c_f32_bf16 v130, v38, v78
    v_dot2c_f32_bf16 v131, v39, v79
    v_dot2c_f32_bf16 v130, v40, v80
    v_dot2c_f32_bf16 v131, v41, v81
    v_dot2c_f32_bf16 v130, v42, v82
    v_dot2c_f32_bf16 v131, v43, v83
    v_dot2c_f32_bf16 v130, v44, v84
    v_dot2c_f32_bf16 v131, v45, v85
    v_dot2c_f32_bf16 v130, v46, v86
    v_dot2c_f32_bf16 v131, v47, v87
    v_dot2c_f32_bf16 v130, v48, v88
    v_dot2c_f32_bf16 v131, v49, v89
    v_dot2c_f32_bf16 v130, v50, v90
    v_dot2c_f32_bf16 v131, v51, v91
    v_dot2c_f32_bf16 v130, v52, v92
    v_dot2c_f32_bf16 v131, v53, v93
    v_dot2c_f32_bf16 v130, v54, v94
    v_dot2c_f32_bf16 v131, v55, v95
    v_dot2c_f32_bf16 v130, v56, v96
    v_dot2c_f32_bf16 v131, v57, v97
    v_dot2c_f32_bf16 v130, v58, v98
    v_dot2c_f32_bf16 v131, v59, v99
    v_dot2c_f32_bf16 v130, v60, v100
    v_dot2c_f32_bf16 v131, v61, v101
    v_dot2c_f32_bf16 v130, v62, v102
    v_dot2c_f32_bf16 v131, v63, v103
    v_dot2c_f32_bf16 v130, v64, v104
    v_dot2c_f32_bf16 v131, v65, v105
    v_dot2c_f32_bf16 v130, v66, v106
    v_dot2c_f32_bf16 v131, v67, v107
    v_dot2c_f32_bf16 v130, v68, v108
    v_dot2c_f32_bf16 v131, v69, v109
    v_dot2c_f32_bf16 v130, v70, v110
    v_dot2c_f32_bf16 v131, v71, v111
    s_nop 3
    v_add_f32 v130, v130, v131
    s_nop 1
    v_add_f32_dpp v130, v130, v130 quad_perm:[1,0,3,2] row_mask:0xf bank_mask:0xf
    s_nop 1
    v_add_f32_dpp v130, v130, v130 quad_perm:[2,3,0,1] row_mask:0xf bank_mask:0xf
    s_nop 1
    v_add_f32_dpp v130, v130, v130 row_half_mirror row_mask:0xf bank_mask:0xf
    v_mul_f32 v130, 0x3fb8aa3b, v130
    v_exp_f32 v130, -v130
    s_nop 0
    v_add_f32 v130, 1.0, v130
    v_rcp_f32 v130, v130
    s_lshl_b32 s30, s29, 7
    s_add_u32 s30, s30, 17825792
    v_lshlrev_b32 v131, 2, v124
    v_mov_b32 v132, 0x7fffffff
    v_cmp_eq_u32 vcc, 0, v125
    s_nop 1
    v_cndmask_b32 v131, v132, v131, vcc
    buffer_store_dword v130, v131, s[8:11], s30 offen sc1
gated_mix__ssm_conv_s5__linear_kernel_hedgehog__prompt_kernel_fn58:
gated_mix__ssm_conv_s5__linear_kernel_hedgehog__prompt_kernel_sdone59:
    s_branch gated_mix__ssm_conv_s5__linear_kernel_hedgehog__prompt_kernel_sidedone
gated_mix__ssm_conv_s5__linear_kernel_hedgehog__prompt_kernel_helper48:
    s_setprio 3
    s_load_dwordx2 s[36:37], s[0:1], 128
    s_load_dwordx2 s[24:25], s[0:1], 120
    s_waitcnt lgkmcnt(0)
    s_mov_b32 s20, s36
    s_and_b32 s21, s37, 0xffff
    s_mov_b32 s22, 20971520
    s_mov_b32 s23, 0x20000
    v_mov_b32 v104, 128
    global_load_dwordx2 v[106:107], v104, s[24:25] sc1
    s_waitcnt vmcnt(11)
    s_barrier
    v_and_b32 v20, 63, v0
    s_mul_i32 s4, s27, 80
    s_add_u32 s4, s4, 16
    v_add_u32 v21, s4, v20
    v_lshlrev_b32 v30, 3, v20
    v_add_u32 v31, 161792, v30
    ds_read_b64 v[26:27], v31
    v_add_u32 v31, 144256, v30
    v_add_u32 v62, 153088, v30
    v_add_u32 v30, 136064, v30
    v_mov_b32 v66, 1.0
    v_mov_b32 v67, 0
    v_mov_b32 v60, 0
    v_mov_b32 v61, 0
    s_waitcnt lgkmcnt(0)
    v_mov_b32 v28, v26
    v_mov_b32 v29, v27
    v_mul_f32 v59, v29, v29
    v_mul_f32 v29, v28, v29
    v_fma_f32 v28, v28, v28, -v59
    v_add_f32 v29, v29, v29
    v_mov_b32 v32, v28
    v_mov_b32 v33, v29
    v_mul_f32 v59, v29, v29
    v_mul_f32 v29, v28, v29
    v_fma_f32 v28, v28, v28, -v59
    v_add_f32 v29, v29, v29
    v_mov_b32 v34, v28
    v_mov_b32 v35, v29
    v_mul_f32 v59, v29, v29
    v_mul_f32 v29, v28, v29
    v_fma_f32 v28, v28, v28, -v59
    v_add_f32 v29, v29, v29
    v_mov_b32 v36, v28
    v_mov_b32 v37, v29
    v_mul_f32 v59, v29, v29
    v_mul_f32 v29, v28, v29
    v_fma_f32 v28, v28, v28, -v59
    v_add_f32 v29, v29, v29
    ds_write_b64 v31, v[66:67] offset:9344
    v_pk_mul_f32 v[64:65], v[26:27], v[66:67] op_sel_hi:[0,1]
    v_pk_fma_f32 v[66:67], v[26:27], v[66:67], v[64:65] op_sel:[1,1,0] op_sel_hi:[1,0,1] neg_lo:[1,0,0]
    ds_write_b64 v31, v[66:67] offset:9856
    v_pk_mul_f32 v[64:65], v[26:27], v[66:67] op_sel_hi:[0,1]
    v_pk_fma_f32 v[66:67], v[26:27], v[66:67], v[64:65] op_sel:[1,1,0] op_sel_hi:[1,0,1] neg_lo:[1,0,0]
    ds_write_b64 v31, v[66:67] offset:10368
    v_pk_mul_f32 v[64:65], v[26:27], v[66:67] op_sel_hi:[0,1]
    v_pk_fma_f32 v[66:67], v[26:27], v[66:67], v[64:65] op_sel:[1,1,0] op_sel_hi:[1,0,1] neg_lo:[1,0,0]
    ds_write_b64 v31, v[66:67] offset:10880
    v_pk_mul_f32 v[64:65], v[26:27], v[66:67] op_sel_hi:[0,1]
    v_pk_fma_f32 v[66:67], v[26:27], v[66:67], v[64:65] op_sel:[1,1,0] op_sel_hi:[1,0,1] neg_lo:[1,0,0]
    ds_write_b64 v31, v[66:67] offset:11392
    v_pk_mul_f32 v[64:65], v[26:27], v[66:67] op_sel_hi:[0,1]
    v_pk_fma_f32 v[66:67], v[26:27], v[66:67], v[64:65] op_sel:[1,1,0] op_sel_hi:[1,0,1] neg_lo:[1,0,0]
    ds_write_b64 v31, v[66:67] offset:11904
    v_pk_mul_f32 v[64:65], v[26:27], v[66:67] op_sel_hi:[0,1]
    v_pk_fma_f32 v[66:67], v[26:27], v[66:67], v[64:65] op_sel:[1,1,0] op_sel_hi:[1,0,1] neg_lo:[1,0,0]
    ds_write_b64 v31, v[66:67] offset:12416
    v_pk_mul_f32 v[64:65], v[26:27], v[66:67] op_sel_hi:[0,1]
    v_pk_fma_f32 v[66:67], v[26:27], v[66:67], v[64:65] op_sel:[1,1,0] op_sel_hi:[1,0,1] neg_lo:[1,0,0]
    ds_write_b64 v31, v[66:67] offset:12928
    v_pk_mul_f32 v[64:65], v[26:27], v[66:67] op_sel_hi:[0,1]
    v_pk_fma_f32 v[66:67], v[26:27], v[66:67], v[64:65] op_sel:[1,1,0] op_sel_hi:[1,0,1] neg_lo:[1,0,0]
    ds_write_b64 v31, v[66:67] offset:13440
    v_pk_mul_f32 v[64:65], v[26:27], v[66:67] op_sel_hi:[0,1]
    v_pk_fma_f32 v[66:67], v[26:27], v[66:67], v[64:65] op_sel:[1,1,0] op_sel_hi:[1,0,1] neg_lo:[1,0,0]
    ds_write_b64 v31, v[66:67] offset:13952
    v_pk_mul_f32 v[64:65], v[26:27], v[66:67] op_sel_hi:[0,1]
    v_pk_fma_f32 v[66:67], v[26:27], v[66:67], v[64:65] op_sel:[1,1,0] op_sel_hi:[1,0,1] neg_lo:[1,0,0]
    ds_write_b64 v31, v[66:67] offset:14464
    v_pk_mul_f32 v[64:65], v[26:27], v[66:67] op_sel_hi:[0,1]
    v_pk_fma_f32 v[66:67], v[26:27], v[66:67], v[64:65] op_sel:[1,1,0] op_sel_hi:[1,0,1] neg_lo:[1,0,0]
    ds_write_b64 v31, v[66:67] offset:14976
    v_pk_mul_f32 v[64:65], v[26:27], v[66:67] op_sel_hi:[0,1]
    v_pk_fma_f32 v[66:67], v[26:27], v[66:67], v[64:65] op_sel:[1,1,0] op_sel_hi:[1,0,1] neg_lo:[1,0,0]
    ds_write_b64 v31, v[66:67] offset:15488
    v_pk_mul_f32 v[64:65], v[26:27], v[66:67] op_sel_hi:[0,1]
    v_pk_fma_f32 v[66:67], v[26:27], v[66:67], v[64:65] op_sel:[1,1,0] op_sel_hi:[1,0,1] neg_lo:[1,0,0]
    ds_write_b64 v31, v[66:67] offset:16000
    v_pk_mul_f32 v[64:65], v[26:27], v[66:67] op_sel_hi:[0,1]
    v_pk_fma_f32 v[66:67], v[26:27], v[66:67], v[64:65] op_sel:[1,1,0] op_sel_hi:[1,0,1] neg_lo:[1,0,0]
    ds_write_b64 v31, v[66:67] offset:16512
    v_pk_mul_f32 v[64:65], v[26:27], v[66:67] op_sel_hi:[0,1]
    v_pk_fma_f32 v[66:67], v[26:27], v[66:67], v[64:65] op_sel:[1,1,0] op_sel_hi:[1,0,1] neg_lo:[1,0,0]
    ds_write_b64 v31, v[66:67] offset:17024
    ds_write_b64 v31, v[60:61]
    s_waitcnt vmcnt(1)
    s_barrier
    s_waitcnt vmcnt(0)
    s_waitcnt vmcnt(0)
    s_mov_b32 s7, 0
gated_mix__ssm_conv_s5__linear_kernel_hedgehog__prompt_kernel_nn60:
    v_readfirstlane_b32 s34, v106
    v_readfirstlane_b32 s35, v107
    s_nop 2
    s_cmp_lg_u32 s34, 0
    s_cbranch_scc1 gated_mix__ssm_conv_s5__linear_kernel_hedgehog__prompt_kernel_nnd61
    s_add_u32 s7, s7, 1
    s_cmp_ge_u32 s7, 400000
    s_cbranch_scc1 gated_mix__ssm_conv_s5__linear_kernel_hedgehog__prompt_kernel_nnd61
    global_load_dwordx2 v[106:107], v104, s[24:25] sc1
    s_waitcnt vmcnt(0)
    s_branch gated_mix__ssm_conv_s5__linear_kernel_hedgehog__prompt_kernel_nn60
gated_mix__ssm_conv_s5__linear_kernel_hedgehog__prompt_kernel_nnd61:
    v_mov_b32 v108, s34
    v_mov_b32 v109, s35
    v_mov_b32 v110, 152496
    ds_write_b64 v110, v[108:109]
    v_mov_b32 v58, 152448
    v_mov_b32 v70, s34
    v_mov_b32 v71, s35
    v_lshlrev_b32 v66, 4, v21
    s_mul_i32 s5, s26, 10240
    s_add_u32 s5, s5, 17891328
    v_mov_b32 v67, v66
gated_mix__ssm_conv_s5__linear_kernel_hedgehog__prompt_kernel_spin62:
    ds_read_b32 v59, v58
    s_waitcnt lgkmcnt(0)
    v_readfirstlane_b32 s4, v59
    s_nop 3
    s_cmp_ge_u32 s4, 4
    s_cbranch_scc1 gated_mix__ssm_conv_s5__linear_kernel_hedgehog__prompt_kernel_spun63
    s_branch gated_mix__ssm_conv_s5__linear_kernel_hedgehog__prompt_kernel_spin62
gated_mix__ssm_conv_s5__linear_kernel_hedgehog__prompt_kernel_spun63:
    ds_read_b64 v[72:73], v30 offset:0
    ds_read_b64 v[74:75], v30 offset:512
    ds_read_b64 v[76:77], v30 offset:1024
    ds_read_b64 v[78:79], v30 offset:1536
    ds_read_b64 v[80:81], v30 offset:2048
    ds_read_b64 v[82:83], v30 offset:2560
    ds_read_b64 v[84:85], v30 offset:3072
    ds_read_b64 v[86:87], v30 offset:3584
    ds_read_b64 v[88:89], v30 offset:4096
    ds_read_b64 v[90:91], v30 offset:4608
    ds_read_b64 v[92:93], v30 offset:5120
    ds_read_b64 v[94:95], v30 offset:5632
    ds_read_b64 v[96:97], v30 offset:6144
    ds_read_b64 v[98:99], v30 offset:6656
    ds_read_b64 v[100:101], v30 offset:7168
    ds_read_b64 v[102:103], v30 offset:7680
    s_waitcnt lgkmcnt(14)
    v_pk_fma_f32 v[104:105], v[26:27], v[72:73], v[74:75] op_sel_hi:[0,1,1]
    s_waitcnt lgkmcnt(12)
    v_pk_fma_f32 v[106:107], v[26:27], v[76:77], v[78:79] op_sel_hi:[0,1,1]
    v_pk_fma_f32 v[104:105], v[26:27], v[72:73], v[104:105] op_sel:[1,1,0] op_sel_hi:[1,0,1] neg_lo:[1,0,0]
    s_waitcnt lgkmcnt(10)
    v_pk_fma_f32 v[108:109], v[26:27], v[80:81], v[82:83] op_sel_hi:[0,1,1]
    v_pk_fma_f32 v[106:107], v[26:27], v[76:77], v[106:107] op_sel:[1,1,0] op_sel_hi:[1,0,1] neg_lo:[1,0,0]
    s_waitcnt lgkmcnt(8)
    v_pk_fma_f32 v[110:111], v[26:27], v[84:85], v[86:87] op_sel_hi:[0,1,1]
    v_pk_fma_f32 v[108:109], v[26:27], v[80:81], v[108:109] op_sel:[1,1,0] op_sel_hi:[1,0,1] neg_lo:[1,0,0]
    s_waitcnt lgkmcnt(6)
    v_pk_fma_f32 v[112:113], v[26:27], v[88:89], v[90:91] op_sel_hi:[0,1,1]
    v_pk_fma_f32 v[110:111], v[26:27], v[84:85], v[110:111] op_sel:[1,1,0] op_sel_hi:[1,0,1] neg_lo:[1,0,0]
    s_waitcnt lgkmcnt(4)
    v_pk_fma_f32 v[114:115], v[26:27], v[92:93], v[94:95] op_sel_hi:[0,1,1]
    v_pk_fma_f32 v[112:113], v[26:27], v[88:89], v[112:113] op_sel:[1,1,0] op_sel_hi:[1,0,1] neg_lo:[1,0,0]
    s_waitcnt lgkmcnt(2)
    v_pk_fma_f32 v[116:117], v[26:27], v[96:97], v[98:99] op_sel_hi:[0,1,1]
    v_pk_fma_f32 v[114:115], v[26:27], v[92:93], v[114:115] op_sel:[1,1,0] op_sel_hi:[1,0,1] neg_lo:[1,0,0]
    s_waitcnt lgkmcnt(0)
    v_pk_fma_f32 v[118:119], v[26:27], v[100:101], v[102:103] op_sel_hi:[0,1,1]
    v_pk_fma_f32 v[116:117], v[26:27], v[96:97], v[116:117] op_sel:[1,1,0] op_sel_hi:[1,0,1] neg_lo:[1,0,0]
    v_pk_fma_f32 v[118:119], v[26:27], v[100:101], v[118:119] op_sel:[1,1,0] op_sel_hi:[1,0,1] neg_lo:[1,0,0]
    v_pk_fma_f32 v[120:121], v[32:33], v[104:105], v[106:107] op_sel_hi:[0,1,1]
    v_pk_fma_f32 v[122:123], v[32:33], v[108:109], v[110:111] op_sel_hi:[0,1,1]
    v_pk_fma_f32 v[124:125], v[32:33], v[112:113], v[114:115] op_sel_hi:[0,1,1]
    v_pk_fma_f32 v[126:127], v[32:33], v[116:117], v[118:119] op_sel_hi:[0,1,1]
    v_pk_fma_f32 v[120:121], v[32:33], v[104:105], v[120:121] op_sel:[1,1,0] op_sel_hi:[1,0,1] neg_lo:[1,0,0]
    v_pk_fma_f32 v[122:123], v[32:33], v[108:109], v[122:123] op_sel:[1,1,0] op_sel_hi:[1,0,1] neg_lo:[1,0,0]
    v_pk_fma_f32 v[124:125], v[32:33], v[112:113], v[124:125] op_sel:[1,1,0] op_sel_hi:[1,0,1] neg_lo:[1,0,0]
    v_pk_fma_f32 v[126:127], v[32:33], v[116:117], v[126:127] op_sel:[1,1,0] op_sel_hi:[1,0,1] neg_lo:[1,0,0]
    v_pk_fma_f32 v[136:137], v[34:35], v[120:121], v[122:123] op_sel_hi:[0,1,1]
    v_pk_fma_f32 v[138:139], v[34:35], v[124:125], v[126:127] op_sel_hi:[0,1,1]
    v_pk_fma_f32 v[136:137], v[34:35], v[120:121], v[136:137] op_sel:[1,1,0] op_sel_hi:[1,0,1] neg_lo:[1,0,0]
    v_pk_fma_f32 v[138:139], v[34:35], v[124:125], v[138:139] op_sel:[1,1,0] op_sel_hi:[1,0,1] neg_lo:[1,0,0]
    v_pk_fma_f32 v[68:69], v[36:37], v[136:137], v[138:139] op_sel_hi:[0,1,1]
    v_pk_fma_f32 v[68:69], v[36:37], v[136:137], v[68:69] op_sel:[1,1,0] op_sel_hi:[1,0,1] neg_lo:[1,0,0]
    buffer_store_dwordx4 v[68:71], v67, s[20:23], s5 offen sc1
    v_mov_b32 v56, 0
    v_mov_b32 v57, 0
    s_mov_b32 s5, 0
    s_mov_b32 s6, 0
    s_mov_b32 s63, 0
    s_lshl_b32 s7, 1, s26
    s_sub_u32 s7, s7, 1
gated_mix__ssm_conv_s5__linear_kernel_hedgehog__prompt_kernel_poll64:
    s_cmp_le_u32 s26, 0
    s_cbranch_scc1 gated_mix__ssm_conv_s5__linear_kernel_hedgehog__prompt_kernel_chk65
    s_bitcmp1_b32 s6, 0
    s_cbranch_scc1 gated_mix__ssm_conv_s5__linear_kernel_hedgehog__prompt_kernel_have67
    s_mov_b32 s4, 17891328
    buffer_load_dwordx4 v[104:107], v66, s[20:23], s4 offen sc1
gated_mix__ssm_conv_s5__linear_kernel_hedgehog__prompt_kernel_have67:
    s_cmp_le_u32 s26, 1
    s_cbranch_scc1 gated_mix__ssm_conv_s5__linear_kernel_hedgehog__prompt_kernel_chk65
    s_bitcmp1_b32 s6, 1
    s_cbranch_scc1 gated_mix__ssm_conv_s5__linear_kernel_hedgehog__prompt_kernel_have68
    s_mov_b32 s4, 17901568
    buffer_load_dwordx4 v[108:111], v66, s[20:23], s4 offen sc1
gated_mix__ssm_conv_s5__linear_kernel_hedgehog__prompt_kernel_have68:
    s_cmp_le_u32 s26, 2
    s_cbranch_scc1 gated_mix__ssm_conv_s5__linear_kernel_hedgehog__prompt_kernel_chk65
    s_bitcmp1_b32 s6, 2
    s_cbranch_scc1 gated_mix__ssm_conv_s5__linear_kernel_hedgehog__prompt_kernel_have69
    s_mov_b32 s4, 17911808
    buffer_load_dwordx4 v[112:115], v66, s[20:23], s4 offen sc1
gated_mix__ssm_conv_s5__linear_kernel_hedgehog__prompt_kernel_have69:
    s_cmp_le_u32 s26, 3
    s_cbranch_scc1 gated_mix__ssm_conv_s5__linear_kernel_hedgehog__prompt_kernel_chk65
    s_bitcmp1_b32 s6, 3
    s_cbranch_scc1 gated_mix__ssm_conv_s5__linear_kernel_hedgehog__prompt_kernel_have70
    s_mov_b32 s4, 17922048
    buffer_load_dwordx4 v[116:119], v66, s[20:23], s4 offen sc1
gated_mix__ssm_conv_s5__linear_kernel_hedgehog__prompt_kernel_have70:
    s_cmp_le_u32 s26, 4
    s_cbranch_scc1 gated_mix__ssm_conv_s5__linear_kernel_hedgehog__prompt_kernel_chk65
    s_bitcmp1_b32 s6, 4
    s_cbranch_scc1 gated_mix__ssm_conv_s5__linear_kernel_hedgehog__prompt_kernel_have71
    s_mov_b32 s4, 17932288
    buffer_load_dwordx4 v[120:123], v66, s[20:23], s4 offen sc1
gated_mix__ssm_conv_s5__linear_kernel_hedgehog__prompt_kernel_have71:
    s_cmp_le_u32 s26, 5
    s_cbranch_scc1 gated_mix__ssm_conv_s5__linear_kernel_hedgehog__prompt_kernel_chk65
    s_bitcmp1_b32 s6, 5
    s_cbranch_scc1 gated_mix__ssm_conv_s5__linear_kernel_hedgehog__prompt_kernel_have72
    s_mov_b32 s4, 17942528
    buffer_load_dwordx4 v[124:127], v66, s[20:23], s4 offen sc1
gated_mix__ssm_conv_s5__linear_kernel_hedgehog__prompt_kernel_have72:
    s_cmp_le_u32 s26, 6
    s_cbranch_scc1 gated_mix__ssm_conv_s5__linear_kernel_hedgehog__prompt_kernel_chk65
    s_bitcmp1_b32 s6, 6
    s_cbranch_scc1 gated_mix__ssm_conv_s5__linear_kernel_hedgehog__prompt_kernel_have73
    s_mov_b32 s4, 17952768
    buffer_load_dwordx4 v[128:131], v66, s[20:23], s4 offen sc1
gated_mix__ssm_conv_s5__linear_kernel_hedgehog__prompt_kernel_have73:
    s_cmp_le_u32 s26, 7
    s_cbranch_scc1 gated_mix__ssm_conv_s5__linear_kernel_hedgehog__prompt_kernel_chk65
    s_bitcmp1_b32 s6, 7
    s_cbranch_scc1 gated_mix__ssm_conv_s5__linear_kernel_hedgehog__prompt_kernel_have74
    s_mov_b32 s4, 17963008
    buffer_load_dwordx4 v[132:135], v66, s[20:23], s4 offen sc1
gated_mix__ssm_conv_s5__linear_kernel_hedgehog__prompt_kernel_have74:
    s_cmp_le_u32 s26, 8
    s_cbranch_scc1 gated_mix__ssm_conv_s5__linear_kernel_hedgehog__prompt_kernel_chk65
    s_bitcmp1_b32 s6, 8
    s_cbranch_scc1 gated_mix__ssm_conv_s5__linear_kernel_hedgehog__prompt_kernel_have75
    s_mov_b32 s4, 17973248
    buffer_load_dwordx4 v[136:139], v66, s[20:23], s4 offen sc1
gated_mix__ssm_conv_s5__linear_kernel_hedgehog__prompt_kernel_have75:
    s_cmp_le_u32 s26, 9
    s_cbranch_scc1 gated_mix__ssm_conv_s5__linear_kernel_hedgehog__prompt_kernel_chk65
    s_bitcmp1_b32 s6, 9
    s_cbranch_scc1 gated_mix__ssm_conv_s5__linear_kernel_hedgehog__prompt_kernel_have76
    s_mov_b32 s4, 17983488
    buffer_load_dwordx4 v[140:143], v66, s[20:23], s4 offen sc1
gated_mix__ssm_conv_s5__linear_kernel_hedgehog__prompt_kernel_have76:
    s_cmp_le_u32 s26, 10
    s_cbranch_scc1 gated_mix__ssm_conv_s5__linear_kernel_hedgehog__prompt_kernel_chk65
    s_bitcmp1_b32 s6, 10
    s_cbranch_scc1 gated_mix__ssm_conv_s5__linear_kernel_hedgehog__prompt_kernel_have77
    s_mov_b32 s4, 17993728
    buffer_load_dwordx4 v[144:147], v66, s[20:23], s4 offen sc1
gated_mix__ssm_conv_s5__linear_kernel_hedgehog__prompt_kernel_have77:
    s_cmp_le_u32 s26, 11
    s_cbranch_scc1 gated_mix__ssm_conv_s5__linear_kernel_hedgehog__prompt_kernel_chk65
    s_bitcmp1_b32 s6, 11
    s_cbranch_scc1 gated_mix__ssm_conv_s5__linear_kernel_hedgehog__prompt_kernel_have78
    s_mov_b32 s4, 18003968
    buffer_load_dwordx4 v[148:151], v66, s[20:23], s4 offen sc1
gated_mix__ssm_conv_s5__linear_kernel_hedgehog__prompt_kernel_have78:
    s_cmp_le_u32 s26, 12
    s_cbranch_scc1 gated_mix__ssm_conv_s5__linear_kernel_hedgehog__prompt_kernel_chk65
    s_bitcmp1_b32 s6, 12
    s_cbranch_scc1 gated_mix__ssm_conv_s5__linear_kernel_hedgehog__prompt_kernel_have79
    s_mov_b32 s4, 18014208
    buffer_load_dwordx4 v[152:155], v66, s[20:23], s4 offen sc1
gated_mix__ssm_conv_s5__linear_kernel_hedgehog__prompt_kernel_have79:
    s_cmp_le_u32 s26, 13
    s_cbranch_scc1 gated_mix__ssm_conv_s5__linear_kernel_hedgehog__prompt_kernel_chk65
    s_bitcmp1_b32 s6, 13
    s_cbranch_scc1 gated_mix__ssm_conv_s5__linear_kernel_hedgehog__prompt_kernel_have80
    s_mov_b32 s4, 18024448
    buffer_load_dwordx4 v[156:159], v66, s[20:23], s4 offen sc1
gated_mix__ssm_conv_s5__linear_kernel_hedgehog__prompt_kernel_have80:
    s_cmp_le_u32 s26, 14
    s_cbranch_scc1 gated_mix__ssm_conv_s5__linear_kernel_hedgehog__prompt_kernel_chk65
    s_bitcmp1_b32 s6, 14
    s_cbranch_scc1 gated_mix__ssm_conv_s5__linear_kernel_hedgehog__prompt_kernel_have81
    s_mov_b32 s4, 18034688
    buffer_load_dwordx4 v[160:163], v66, s[20:23], s4 offen sc1
gated_mix__ssm_conv_s5__linear_kernel_hedgehog__prompt_kernel_have81:
gated_mix__ssm_conv_s5__linear_kernel_hedgehog__prompt_kernel_chk65:
    s_cmp_lg_u32 s5, 0
    s_cbranch_scc1 gated_mix__ssm_conv_s5__linear_kernel_hedgehog__prompt_kernel_pdone82
    s_mov_b32 s5, 1
    ds_write_b64 v31, v[72:73] offset:512
    v_pk_fma_f32 v[64:65], v[26:27], v[72:73], v[74:75] op_sel_hi:[0,1,1]
    v_pk_fma_f32 v[74:75], v[26:27], v[72:73], v[64:65] op_sel:[1,1,0] op_sel_hi:[1,0,1] neg_lo:[1,0,0]
    ds_write_b64 v31, v[74:75] offset:1024
    v_pk_fma_f32 v[64:65], v[26:27], v[74:75], v[76:77] op_sel_hi:[0,1,1]
    v_pk_fma_f32 v[76:77], v[26:27], v[74:75], v[64:65] op_sel:[1,1,0] op_sel_hi:[1,0,1] neg_lo:[1,0,0]
    ds_write_b64 v31, v[76:77] offset:1536
    v_pk_fma_f32 v[64:65], v[26:27], v[76:77], v[78:79] op_sel_hi:[0,1,1]
    v_pk_fma_f32 v[78:79], v[26:27], v[76:77], v[64:65] op_sel:[1,1,0] op_sel_hi:[1,0,1] neg_lo:[1,0,0]
    ds_write_b64 v31, v[78:79] offset:2048
    v_pk_fma_f32 v[64:65], v[26:27], v[78:79], v[80:81] op_sel_hi:[0,1,1]
    v_pk_fma_f32 v[80:81], v[26:27], v[78:79], v[64:65] op_sel:[1,1,0] op_sel_hi:[1,0,1] neg_lo:[1,0,0]
    ds_write_b64 v31, v[80:81] offset:2560
    v_pk_fma_f32 v[64:65], v[26:27], v[80:81], v[82:83] op_sel_hi:[0,1,1]
    v_pk_fma_f32 v[82:83], v[26:27], v[80:81], v[64:65] op_sel:[1,1,0] op_sel_hi:[1,0,1] neg_lo:[1,0,0]
    ds_write_b64 v31, v[82:83] offset:3072
    v_pk_fma_f32 v[64:65], v[26:27], v[82:83], v[84:85] op_sel_hi:[0,1,1]
    v_pk_fma_f32 v[84:85], v[26:27], v[82:83], v[64:65] op_sel:[1,1,0] op_sel_hi:[1,0,1] neg_lo:[1,0,0]
    ds_write_b64 v31, v[84:85] offset:3584
    v_pk_fma_f32 v[64:65], v[26:27], v[84:85], v[86:87] op_sel_hi:[0,1,1]
    v_pk_fma_f32 v[86:87], v[26:27], v[84:85], v[64:65] op_sel:[1,1,0] op_sel_hi:[1,0,1] neg_lo:[1,0,0]
    ds_write_b64 v31, v[86:87] offset:4096
    v_pk_fma_f32 v[64:65], v[26:27], v[86:87], v[88:89] op_sel_hi:[0,1,1]
    v_pk_fma_f32 v[88:89], v[26:27], v[86:87], v[64:65] op_sel:[1,1,0] op_sel_hi:[1,0,1] neg_lo:[1,0,0]
    ds_write_b64 v31, v[88:89] offset:4608
    v_pk_fma_f32 v[64:65], v[26:27], v[88:89], v[90:91] op_sel_hi:[0,1,1]
    v_pk_fma_f32 v[90:91], v[26:27], v[88:89], v[64:65] op_sel:[1,1,0] op_sel_hi:[1,0,1] neg_lo:[1,0,0]
    ds_write_b64 v31, v[90:91] offset:5120
    v_pk_fma_f32 v[64:65], v[26:27], v[90:91], v[92:93] op_sel_hi:[0,1,1]
    v_pk_fma_f32 v[92:93], v[26:27], v[90:91], v[64:65] op_sel:[1,1,0] op_sel_hi:[1,0,1] neg_lo:[1,0,0]
    ds_write_b64 v31, v[92:93] offset:5632
    v_pk_fma_f32 v[64:65], v[26:27], v[92:93], v[94:95] op_sel_hi:[0,1,1]
    v_pk_fma_f32 v[94:95], v[26:27], v[92:93], v[64:65] op_sel:[1,1,0] op_sel_hi:[1,0,1] neg_lo:[1,0,0]
    ds_write_b64 v31, v[94:95] offset:6144
    v_pk_fma_f32 v[64:65], v[26:27], v[94:95], v[96:97] op_sel_hi:[0,1,1]
    v_pk_fma_f32 v[96:97], v[26:27], v[94:95], v[64:65] op_sel:[1,1,0] op_sel_hi:[1,0,1] neg_lo:[1,0,0]
    ds_write_b64 v31, v[96:97] offset:6656
    v_pk_fma_f32 v[64:65], v[26:27], v[96:97], v[98:99] op_sel_hi:[0,1,1]
    v_pk_fma_f32 v[98:99], v[26:27], v[96:97], v[64:65] op_sel:[1,1,0] op_sel_hi:[1,0,1] neg_lo:[1,0,0]
    ds_write_b64 v31, v[98:99] offset:7168
    v_pk_fma_f32 v[64:65], v[26:27], v[98:99], v[100:101] op_sel_hi:[0,1,1]
    v_pk_fma_f32 v[100:101], v[26:27], v[98:99], v[64:65] op_sel:[1,1,0] op_sel_hi:[1,0,1] neg_lo:[1,0,0]
    ds_write_b64 v31, v[100:101] offset:7680
gated_mix__ssm_conv_s5__linear_kernel_hedgehog__prompt_kernel_pdone82:
    s_cmp_eq_u32 s7, 0
    s_cbranch_scc1 gated_mix__ssm_conv_s5__linear_kernel_hedgehog__prompt_kernel_ok83
    s_waitcnt vmcnt(0)
    s_cmp_le_u32 s26, 0
    s_cbranch_scc1 gated_mix__ssm_conv_s5__linear_kernel_hedgehog__prompt_kernel_chkd84
    v_cmp_ne_u64 vcc, s[34:35], v[106:107]
    s_nop 3
    s_cmp_eq_u64 vcc, 0
    s_cselect_b32 s4, 1, 0
    s_or_b32 s6, s6, s4
    s_cmp_le_u32 s26, 1
    s_cbranch_scc1 gated_mix__ssm_conv_s5__linear_kernel_hedgehog__prompt_kernel_chkd84
    v_cmp_ne_u64 vcc, s[34:35], v[110:111]
    s_nop 3
    s_cmp_eq_u64 vcc, 0
    s_cselect_b32 s4, 2, 0
    s_or_b32 s6, s6, s4
    s_cmp_le_u32 s26, 2
    s_cbranch_scc1 gated_mix__ssm_conv_s5__linear_kernel_hedgehog__prompt_kernel_chkd84
    v_cmp_ne_u64 vcc, s[34:35], v[114:115]
    s_nop 3
    s_cmp_eq_u64 vcc, 0
    s_cselect_b32 s4, 4, 0
    s_or_b32 s6, s6, s4
    s_cmp_le_u32 s26, 3
    s_cbranch_scc1 gated_mix__ssm_conv_s5__linear_kernel_hedgehog__prompt_kernel_chkd84
    v_cmp_ne_u64 vcc, s[34:35], v[118:119]
    s_nop 3
    s_cmp_eq_u64 vcc, 0
    s_cselect_b32 s4, 8, 0
    s_or_b32 s6, s6, s4
    s_cmp_le_u32 s26, 4
    s_cbranch_scc1 gated_mix__ssm_conv_s5__linear_kernel_hedgehog__prompt_kernel_chkd84
    v_cmp_ne_u64 vcc, s[34:35], v[122:123]
    s_nop 3
    s_cmp_eq_u64 vcc, 0
    s_cselect_b32 s4, 16, 0
    s_or_b32 s6, s6, s4
    s_cmp_le_u32 s26, 5
    s_cbranch_scc1 gated_mix__ssm_conv_s5__linear_kernel_hedgehog__prompt_kernel_chkd84
    v_cmp_ne_u64 vcc, s[34:35], v[126:127]
    s_nop 3
    s_cmp_eq_u64 vcc, 0
    s_cselect_b32 s4, 32, 0
    s_or_b32 s6, s6, s4
    s_cmp_le_u32 s26, 6
    s_cbranch_scc1 gated_mix__ssm_conv_s5__linear_kernel_hedgehog__prompt_kernel_chkd84
    v_cmp_ne_u64 vcc, s[34:35], v[130:131]
    s_nop 3
    s_cmp_eq_u64 vcc, 0
    s_cselect_b32 s4, 64, 0
    s_or_b32 s6, s6, s4
    s_cmp_le_u32 s26, 7
    s_cbranch_scc1 gated_mix__ssm_conv_s5__linear_kernel_hedgehog__prompt_kernel_chkd84
    v_cmp_ne_u64 vcc, s[34:35], v[134:135]
    s_nop 3
    s_cmp_eq_u64 vcc, 0
    s_cselect_b32 s4, 128, 0
    s_or_b32 s6, s6, s4
    s_cmp_le_u32 s26, 8
    s_cbranch_scc1 gated_mix__ssm_conv_s5__linear_kernel_hedgehog__prompt_kernel_chkd84
    v_cmp_ne_u64 vcc, s[34:35], v[138:139]
    s_nop 3
    s_cmp_eq_u64 vcc, 0
    s_cselect_b32 s4, 256, 0
    s_or_b32 s6, s6, s4
    s_cmp_le_u32 s26, 9
    s_cbranch_scc1 gated_mix__ssm_conv_s5__linear_kernel_hedgehog__prompt_kernel_chkd84
    v_cmp_ne_u64 vcc, s[34:35], v[142:143]
    s_nop 3
    s_cmp_eq_u64 vcc, 0
    s_cselect_b32 s4, 512, 0
    s_or_b32 s6, s6, s4
    s_cmp_le_u32 s26, 10
    s_cbranch_scc1 gated_mix__ssm_conv_s5__linear_kernel_hedgehog__prompt_kernel_chkd84
    v_cmp_ne_u64 vcc, s[34:35], v[146:147]
    s_nop 3
    s_cmp_eq_u64 vcc, 0
    s_cselect_b32 s4, 1024, 0
    s_or_b32 s6, s6, s4
    s_cmp_le_u32 s26, 11
    s_cbranch_scc1 gated_mix__ssm_conv_s5__linear_kernel_hedgehog__prompt_kernel_chkd84
    v_cmp_ne_u64 vcc, s[34:35], v[150:151]
    s_nop 3
    s_cmp_eq_u64 vcc, 0
    s_cselect_b32 s4, 2048, 0
    s_or_b32 s6, s6, s4
    s_cmp_le_u32 s26, 12
    s_cbranch_scc1 gated_mix__ssm_conv_s5__linear_kernel_hedgehog__prompt_kernel_chkd84
    v_cmp_ne_u64 vcc, s[34:35], v[154:155]
    s_nop 3
    s_cmp_eq_u64 vcc, 0
    s_cselect_b32 s4, 4096, 0
    s_or_b32 s6, s6, s4
    s_cmp_le_u32 s26, 13
    s_cbranch_scc1 gated_mix__ssm_conv_s5__linear_kernel_hedgehog__prompt_kernel_chkd84
    v_cmp_ne_u64 vcc, s[34:35], v[158:159]
    s_nop 3
    s_cmp_eq_u64 vcc, 0
    s_cselect_b32 s4, 8192, 0
    s_or_b32 s6, s6, s4
    s_cmp_le_u32 s26, 14
    s_cbranch_scc1 gated_mix__ssm_conv_s5__linear_kernel_hedgehog__prompt_kernel_chkd84
    v_cmp_ne_u64 vcc, s[34:35], v[162:163]
    s_nop 3
    s_cmp_eq_u64 vcc, 0
    s_cselect_b32 s4, 16384, 0
    s_or_b32 s6, s6, s4
gated_mix__ssm_conv_s5__linear_kernel_hedgehog__prompt_kernel_chkd84:
    s_add_u32 s63, s63, 1
    s_cmp_ge_u32 s63, 400000
    s_cbranch_scc1 gated_mix__ssm_conv_s5__linear_kernel_hedgehog__prompt_kernel_ok83
    s_cmp_eq_u32 s6, s7
    s_cbranch_scc0 gated_mix__ssm_conv_s5__linear_kernel_hedgehog__prompt_kernel_poll64
gated_mix__ssm_conv_s5__linear_kernel_hedgehog__prompt_kernel_ok83:
    s_cmp_le_u32 s26, 0
    s_cbranch_scc1 gated_mix__ssm_conv_s5__linear_kernel_hedgehog__prompt_kernel_lbdone66
    v_pk_fma_f32 v[64:65], v[28:29], v[56:57], v[104:105] op_sel_hi:[0,1,1]
    v_pk_fma_f32 v[56:57], v[28:29], v[56:57], v[64:65] op_sel:[1,1,0] op_sel_hi:[1,0,1] neg_lo:[1,0,0]
    s_cmp_le_u32 s26, 1
    s_cbranch_scc1 gated_mix__ssm_conv_s5__linear_kernel_hedgehog__prompt_kernel_lbdone66
    v_pk_fma_f32 v[64:65], v[28:29], v[56:57], v[108:109] op_sel_hi:[0,1,1]
    v_pk_fma_f32 v[56:57], v[28:29], v[56:57], v[64:65] op_sel:[1,1,0] op_sel_hi:[1,0,1] neg_lo:[1,0,0]
    s_cmp_le_u32 s26, 2
    s_cbranch_scc1 gated_mix__ssm_conv_s5__linear_kernel_hedgehog__prompt_kernel_lbdone66
    v_pk_fma_f32 v[64:65], v[28:29], v[56:57], v[112:113] op_sel_hi:[0,1,1]
    v_pk_fma_f32 v[56:57], v[28:29], v[56:57], v[64:65] op_sel:[1,1,0] op_sel_hi:[1,0,1] neg_lo:[1,0,0]
    s_cmp_le_u32 s26, 3
    s_cbranch_scc1 gated_mix__ssm_conv_s5__linear_kernel_hedgehog__prompt_kernel_lbdone66
    v_pk_fma_f32 v[64:65], v[28:29], v[56:57], v[116:117] op_sel_hi:[0,1,1]
    v_pk_fma_f32 v[56:57], v[28:29], v[56:57], v[64:65] op_sel:[1,1,0] op_sel_hi:[1,0,1] neg_lo:[1,0,0]
    s_cmp_le_u32 s26, 4
    s_cbranch_scc1 gated_mix__ssm_conv_s5__linear_kernel_hedgehog__prompt_kernel_lbdone66
    v_pk_fma_f32 v[64:65], v[28:29], v[56:57], v[120:121] op_sel_hi:[0,1,1]
    v_pk_fma_f32 v[56:57], v[28:29], v[56:57], v[64:65] op_sel:[1,1,0] op_sel_hi:[1,0,1] neg_lo:[1,0,0]
    s_cmp_le_u32 s26, 5
    s_cbranch_scc1 gated_mix__ssm_conv_s5__linear_kernel_hedgehog__prompt_kernel_lbdone66
    v_pk_fma_f32 v[64:65], v[28:29], v[56:57], v[124:125] op_sel_hi:[0,1,1]
    v_pk_fma_f32 v[56:57], v[28:29], v[56:57], v[64:65] op_sel:[1,1,0] op_sel_hi:[1,0,1] neg_lo:[1,0,0]
    s_cmp_le_u32 s26, 6
    s_cbranch_scc1 gated_mix__ssm_conv_s5__linear_kernel_hedgehog__prompt_kernel_lbdone66
    v_pk_fma_f32 v[64:65], v[28:29], v[56:57], v[128:129] op_sel_hi:[0,1,1]
    v_pk_fma_f32 v[56:57], v[28:29], v[56:57], v[64:65] op_sel:[1,1,0] op_sel_hi:[1,0,1] neg_lo:[1,0,0]
    s_cmp_le_u32 s26, 7
    s_cbranch_scc1 gated_mix__ssm_conv_s5__linear_kernel_hedgehog__prompt_kernel_lbdone66
    v_pk_fma_f32 v[64:65], v[28:29], v[56:57], v[132:133] op_sel_hi:[0,1,1]
    v_pk_fma_f32 v[56:57], v[28:29], v[56:57], v[64:65] op_sel:[1,1,0] op_sel_hi:[1,0,1] neg_lo:[1,0,0]
    s_cmp_le_u32 s26, 8
    s_cbranch_scc1 gated_mix__ssm_conv_s5__linear_kernel_hedgehog__prompt_kernel_lbdone66
    v_pk_fma_f32 v[64:65], v[28:29], v[56:57], v[136:137] op_sel_hi:[0,1,1]
    v_pk_fma_f32 v[56:57], v[28:29], v[56:57], v[64:65] op_sel:[1,1,0] op_sel_hi:[1,0,1] neg_lo:[1,0,0]
    s_cmp_le_u32 s26, 9
    s_cbranch_scc1 gated_mix__ssm_conv_s5__linear_kernel_hedgehog__prompt_kernel_lbdone66
    v_pk_fma_f32 v[64:65], v[28:29], v[56:57], v[140:141] op_sel_hi:[0,1,1]
    v_pk_fma_f32 v[56:57], v[28:29], v[56:57], v[64:65] op_sel:[1,1,0] op_sel_hi:[1,0,1] neg_lo:[1,0,0]
    s_cmp_le_u32 s26, 10
    s_cbranch_scc1 gated_mix__ssm_conv_s5__linear_kernel_hedgehog__prompt_kernel_lbdone66
    v_pk_fma_f32 v[64:65], v[28:29], v[56:57], v[144:145] op_sel_hi:[0,1,1]
    v_pk_fma_f32 v[56:57], v[28:29], v[56:57], v[64:65] op_sel:[1,1,0] op_sel_hi:[1,0,1] neg_lo:[1,0,0]
    s_cmp_le_u32 s26, 11
    s_cbranch_scc1 gated_mix__ssm_conv_s5__linear_kernel_hedgehog__prompt_kernel_lbdone66
    v_pk_fma_f32 v[64:65], v[28:29], v[56:57], v[148:149] op_sel_hi:[0,1,1]
    v_pk_fma_f32 v[56:57], v[28:29], v[56:57], v[64:65] op_sel:[1,1,0] op_sel_hi:[1,0,1] neg_lo:[1,0,0]
    s_cmp_le_u32 s26, 12
    s_cbranch_scc1 gated_mix__ssm_conv_s5__linear_kernel_hedgehog__prompt_kernel_lbdone66
    v_pk_fma_f32 v[64:65], v[28:29], v[56:57], v[152:153] op_sel_hi:[0,1,1]
    v_pk_fma_f32 v[56:57], v[28:29], v[56:57], v[64:65] op_sel:[1,1,0] op_sel_hi:[1,0,1] neg_lo:[1,0,0]
    s_cmp_le_u32 s26, 13
    s_cbranch_scc1 gated_mix__ssm_conv_s5__linear_kernel_hedgehog__prompt_kernel_lbdone66
    v_pk_fma_f32 v[64:65], v[28:29], v[56:57], v[156:157] op_sel_hi:[0,1,1]
    v_pk_fma_f32 v[56:57], v[28:29], v[56:57], v[64:65] op_sel:[1,1,0] op_sel_hi:[1,0,1] neg_lo:[1,0,0]
    s_cmp_le_u32 s26, 14
    s_cbranch_scc1 gated_mix__ssm_conv_s5__linear_kernel_hedgehog__prompt_kernel_lbdone66
    v_pk_fma_f32 v[64:65], v[28:29], v[56:57], v[160:161] op_sel_hi:[0,1,1]
    v_pk_fma_f32 v[56:57], v[28:29], v[56:57], v[64:65] op_sel:[1,1,0] op_sel_hi:[1,0,1] neg_lo:[1,0,0]
gated_mix__ssm_conv_s5__linear_kernel_hedgehog__prompt_kernel_lbdone66:
    ds_write_b64 v62, v[56:57]
    v_mov_b32 v58, 152456
    v_mov_b32 v59, 1
    s_waitcnt lgkmcnt(0)
    s_mov_b64 s[60:61], exec
    s_mov_b64 exec, 1
    ds_add_u32 v58, v59
    s_mov_b64 exec, s[60:61]
    s_branch gated_mix__ssm_conv_s5__linear_kernel_hedgehog__prompt_kernel_gemm
gated_mix__ssm_conv_s5__linear_kernel_hedgehog__prompt_kernel_sidedone:
    s_waitcnt vmcnt(0)
    v_mov_b32 v244, 152496
    s_mov_b32 s5, 0
gated_mix__ssm_conv_s5__linear_kernel_hedgehog__prompt_kernel_spin85:
    ds_read_b32 v245, v244
    s_waitcnt lgkmcnt(0)
    v_readfirstlane_b32 s4, v245
    s_nop 3
    s_cmp_ge_u32 s4, 1
    s_cbranch_scc1 gated_mix__ssm_conv_s5__linear_kernel_hedgehog__prompt_kernel_spun86
    s_add_u32 s5, s5, 1
    s_cmp_ge_u32 s5, 8000000
    s_cbranch_scc1 gated_mix__ssm_conv_s5__linear_kernel_hedgehog__prompt_kernel_spun86
    s_sleep 1
    s_branch gated_mix__ssm_conv_s5__linear_kernel_hedgehog__prompt_kernel_spin85
gated_mix__ssm_conv_s5__linear_kernel_hedgehog__prompt_kernel_spun86:
    ds_read_b64 v[240:241], v244
    s_waitcnt lgkmcnt(0)
    v_mov_b32 v242, v240
    v_mov_b32 v243, v241
    v_and_b32 v247, 63, v0
    s_cmp_eq_u32 s3, 7
    s_cbranch_scc1 gated_mix__ssm_conv_s5__linear_kernel_hedgehog__prompt_kernel_nfw87
    v_mov_b32 v244, 152460
    v_mov_b32 v245, 1
    s_mov_b64 s[60:61], exec
    s_mov_b64 exec, 1
    ds_add_rtn_u32 v246, v244, v245
    s_waitcnt lgkmcnt(0)
    s_mov_b64 exec, s[60:61]
    v_readfirstlane_b32 s4, v246
    s_nop 3
    s_cmp_lg_u32 s4, 1
    s_cbranch_scc1 gated_mix__ssm_conv_s5__linear_kernel_hedgehog__prompt_kernel_nfw87
    s_and_b32 s4, s2, 7
    s_lshr_b32 s5, s2, 3
    s_and_b32 s6, s5, 7
    s_lshr_b32 s5, s5, 3
    s_lshl_b32 s4, s4, 2
    s_add_u32 s4, s4, s5
    s_lshl_b32 s6, s6, 5
    s_add_u32 s4, s4, s6
    s_lshl_b32 s4, s4, 7
    s_add_u32 s4, s4, 18153472
    v_lshlrev_b32 v244, 4, v247
    s_mov_b64 s[60:61], exec
    s_mov_b64 exec, 0xff
    buffer_store_dwordx4 v[240:243], v244, s[8:11], s4 offen sc1
    s_mov_b64 exec, s[60:61]
gated_mix__ssm_conv_s5__linear_kernel_hedgehog__prompt_kernel_nfw87:
    s_cmp_lg_u32 s3, 7
    s_cbranch_scc1 gated_mix__ssm_conv_s5__linear_kernel_hedgehog__prompt_kernel_nfk789
    s_and_b32 s7, s28, 1
    s_lshl_b32 s7, s7, 2
    v_mov_b32 v244, 152504
    v_mov_b32 v245, 1
    s_mov_b64 s[60:61], exec
    s_mov_b64 exec, 1
    ds_add_rtn_u32 v246, v244, v245
    s_waitcnt lgkmcnt(0)
    s_mov_b64 exec, s[60:61]
    v_readfirstlane_b32 s4, v246
    s_nop 3
    s_cmp_lg_u32 s4, s7
    s_cbranch_scc1 gated_mix__ssm_conv_s5__linear_kernel_hedgehog__prompt_kernel_nfk789
    s_lshl_b32 s4, s26, 4
    s_add_u32 s4, s4, s28
    s_lshl_b32 s4, s4, 7
    s_add_u32 s4, s4, 18219008
    v_lshlrev_b32 v244, 4, v247
    s_mov_b64 s[60:61], exec
    s_mov_b64 exec, 0xff
    buffer_store_dwordx4 v[240:243], v244, s[8:11], s4 offen sc1
    s_mov_b64 exec, s[60:61]
gated_mix__ssm_conv_s5__linear_kernel_hedgehog__prompt_kernel_nfk789:
    s_nop 0
    v_mov_b32 v244, 152464
    v_mov_b32 v245, 1
    s_mov_b64 s[60:61], exec
    s_mov_b64 exec, 1
    ds_add_rtn_u32 v246, v244, v245
    s_waitcnt lgkmcnt(0)
    s_mov_b64 exec, s[60:61]
    v_readfirstlane_b32 s4, v246
    s_nop 3
    s_cmp_lg_u32 s4, 6
    s_cbranch_scc1 gated_mix__ssm_conv_s5__linear_kernel_hedgehog__prompt_kernel_nf188
    s_lshl_b32 s4, s26, 4
    s_add_u32 s4, s4, s28
    s_lshl_b32 s4, s4, 7
    s_add_u32 s4, s4, 18186240
    v_lshlrev_b32 v244, 4, v247
    s_mov_b64 s[60:61], exec
    s_mov_b64 exec, 0xff
    buffer_store_dwordx4 v[240:243], v244, s[8:11], s4 offen sc1
    s_mov_b64 exec, s[60:61]
gated_mix__ssm_conv_s5__linear_kernel_hedgehog__prompt_kernel_nf188:
    s_branch gated_mix__ssm_conv_s5__linear_kernel_hedgehog__prompt_kernel_gemm
gated_mix__ssm_conv_s5__linear_kernel_hedgehog__prompt_kernel_cpA:
    s_load_dwordx2 s[4:5], s[0:1], 8
    s_load_dwordx2 s[6:7], s[0:1], 16
    s_load_dwordx2 s[32:33], s[0:1], 56
    s_load_dwordx2 s[34:35], s[0:1], 88
    s_load_dwordx2 s[36:37], s[0:1], 128
    v_mov_b32 v197, v0
    v_and_b32 v194, 63, v0
    v_and_b32 v195, 15, v0
    v_bfe_u32 v196, v0, 4, 2
    s_waitcnt lgkmcnt(0)
    s_mov_b32 s8, s4
    s_and_b32 s9, s5, 0xffff
    s_mov_b32 s10, 1280
    s_mov_b32 s11, 0x20000
    s_mov_b32 s12, s6
    s_and_b32 s13, s7, 0xffff
    s_mov_b32 s14, 1280
    s_mov_b32 s15, 0x20000
    s_mov_b32 s16, s32
    s_and_b32 s17, s33, 0xffff
    s_mov_b32 s18, 1280
    s_mov_b32 s19, 0x20000
    s_mov_b32 s20, s34
    s_and_b32 s21, s35, 0xffff
    s_mov_b32 s22, 25600
    s_mov_b32 s23, 0x20000
    s_mov_b32 s40, s36
    s_and_b32 s41, s37, 0xffff
    s_mov_b32 s42, 20971520
    s_mov_b32 s43, 0x20000
    v_lshlrev_b32 v206, 4, v197
    s_mul_i32 s4, s27, 3200
    v_cmp_gt_u32 vcc, 200, v197
    v_mov_b32 v207, 0x7fffffff
    s_nop 0
    v_cndmask_b32 v207, v207, v206, vcc
    buffer_load_dwordx4 v[210:213], v207, s[20:23], s4 offen
    v_and_b32 v226, 15, v194
    s_mul_i32 s4, s27, 160
    s_add_u32 s4, s4, 0
    v_lshl_add_u32 v208, v226, 1, s4
    buffer_load_ushort v214, v208, s[8:11], 0 offen
    buffer_load_ushort v215, v208, s[12:15], 0 offen
    buffer_load_ushort v216, v208, s[16:19], 0 offen
    v_mov_b32 v0, 0
    v_mov_b32 v1, 0
    v_mov_b32 v2, 0
    v_mov_b32 v3, 0
    v_mov_b32 v4, 0
    v_mov_b32 v5, 0
    v_mov_b32 v6, 0
    v_mov_b32 v7, 0
    v_mov_b32 v8, 0
    v_mov_b32 v9, 0
    v_mov_b32 v10, 0
    v_mov_b32 v11, 0
    v_mov_b32 v12, 0
    v_mov_b32 v13, 0
    v_mov_b32 v14, 0
    v_mov_b32 v15, 0
    v_mov_b32 v16, 0
    v_mov_b32 v17, 0
    v_mov_b32 v18, 0
    v_mov_b32 v19, 0
    v_mov_b32 v20, 0
    v_mov_b32 v21, 0
    v_mov_b32 v22, 0
    v_mov_b32 v23, 0
    v_mov_b32 v24, 0
    v_mov_b32 v25, 0
    v_mov_b32 v26, 0
    v_mov_b32 v27, 0
    v_mov_b32 v28, 0
    v_mov_b32 v29, 0
    v_mov_b32 v30, 0
    v_mov_b32 v31, 0
    v_mov_b32 v32, 0
    v_mov_b32 v33, 0
    v_mov_b32 v34, 0
    v_mov_b32 v35, 0
    v_mov_b32 v36, 0
    v_mov_b32 v37, 0
    v_mov_b32 v38, 0
    v_mov_b32 v39, 0
    v_mov_b32 v40, 0
    v_mov_b32 v41, 0
    v_mov_b32 v42, 0
    v_mov_b32 v43, 0
    v_mov_b32 v44, 0
    v_mov_b32 v45, 0
    v_mov_b32 v46, 0
    v_mov_b32 v47, 0
    v_mov_b32 v48, 0
    v_mov_b32 v49, 0
    v_mov_b32 v50, 0
    v_mov_b32 v51, 0
    v_mov_b32 v52, 0
    v_mov_b32 v53, 0
    v_mov_b32 v54, 0
    v_mov_b32 v55, 0
    v_mov_b32 v56, 0
    v_mov_b32 v57, 0
    v_mov_b32 v58, 0
    v_mov_b32 v59, 0
    v_mov_b32 v60, 0
    v_mov_b32 v61, 0
    v_mov_b32 v62, 0
    v_mov_b32 v63, 0
    v_mov_b32 v64, 0
    v_mov_b32 v65, 0
    v_mov_b32 v66, 0
    v_mov_b32 v67, 0
    v_mov_b32 v68, 0
    v_mov_b32 v69, 0
    v_mov_b32 v70, 0
    v_mov_b32 v71, 0
    v_mov_b32 v72, 0
    v_mov_b32 v73, 0
    v_mov_b32 v74, 0
    v_mov_b32 v75, 0
    v_mov_b32 v76, 0
    v_mov_b32 v77, 0
    v_mov_b32 v78, 0
    v_mov_b32 v79, 0
    v_mov_b32 v80, 0
    v_mov_b32 v81, 0
    v_mov_b32 v82, 0
    v_mov_b32 v83, 0
    v_mov_b32 v84, 0
    v_mov_b32 v85, 0
    v_mov_b32 v86, 0
    v_mov_b32 v87, 0
    v_mov_b32 v88, 0
    v_mov_b32 v89, 0
    v_mov_b32 v90, 0
    v_mov_b32 v91, 0
    v_mov_b32 v92, 0
    v_mov_b32 v93, 0
    v_mov_b32 v94, 0
    v_mov_b32 v95, 0
    v_lshrrev_b32 v208, 1, v195
    v_xor_b32 v208, v208, v196
    v_lshlrev_b32 v209, 7, v195
    v_lshl_add_u32 v174, v208, 4, v209
    v_xor_b32 v208, 4, v208
    v_lshl_add_u32 v175, v208, 4, v209
    s_lshl_b32 s4, s3, 12
    v_add_u32 v172, s4, v174
    v_add_u32 v173, s4, v175
    v_lshrrev_b32 v208, 2, v195
    v_lshl_add_u32 v208, v196, 3, v208
    v_mul_u32_u24 v208, 160, v208
    v_lshl_add_u32 v208, v196, 7, v208
    v_and_b32 v209, 3, v195
    v_mul_u32_u24 v209, 40, v209
    v_add_u32 v176, v208, v209
    v_mov_b32 v230, 0
    v_mov_b32 v231, 0
    v_mov_b32 v232, 0
    v_mov_b32 v233, 0
    v_lshlrev_b32 v208, 4, v197
    v_add_u32 v208, 135296, v208
    v_and_b32 v209, 3, v197
    v_lshlrev_b32 v209, 4, v209
    v_add_u32 v209, 152448, v209
    v_cmp_gt_u32 vcc, 48, v197
    s_nop 1
    v_cndmask_b32 v208, v209, v208, vcc
    ds_write_b128 v208, v[230:233]
    s_waitcnt vmcnt(0)
    v_add_u32 v206, 132096, v206
    v_mov_b32 v207, 152512
    v_cmp_gt_u32 vcc, 200, v197
    s_nop 1
    v_cndmask_b32 v206, v207, v206, vcc
    ds_write_b128 v206, v[210:213]
    v_lshlrev_b32 v214, 16, v214
    v_lshlrev_b32 v215, 16, v215
    v_lshlrev_b32 v216, 16, v216
    v_mul_f32 v208, 0x3fb8aa3b, v216
    v_exp_f32 v208, v208
    s_nop 0
    v_cvt_pk_bf16_f32 v208, v208, v208
    v_lshlrev_b32 v208, 16, v208
    v_mul_f32 v209, v208, v215
    v_mul_f32 v208, v208, v214
    v_mul_f32 v208, 0x3fb8aa3b, v208
    v_exp_f32 v208, v208
    v_mul_f32 v209, 0x3e22f983, v209
    v_rndne_f32 v218, v209
    v_sub_f32 v209, v209, v218
    v_cos_f32 v218, v209
    v_sin_f32 v219, v209
    v_mul_f32 v218, v218, v208
    v_mul_f32 v219, v219, v208
    v_mov_b32 v220, v218
    v_mov_b32 v221, v219
    v_mul_f32 v208, v221, v221
    v_mul_f32 v221, v220, v221
    v_fma_f32 v220, v220, v220, -v208
    v_add_f32 v221, v221, v221
    v_mul_f32 v208, v221, v221
    v_mul_f32 v221, v220, v221
    v_fma_f32 v220, v220, v220, -v208
    v_add_f32 v221, v221, v221
    v_mov_b32 v222, v220
    v_mov_b32 v223, v221
    v_mul_f32 v208, v223, v223
    v_mul_f32 v223, v222, v223
    v_fma_f32 v222, v222, v222, -v208
    v_add_f32 v223, v223, v223
    v_lshlrev_b32 v208, 3, v226
    v_add_u32 v208, 161792, v208
    ds_write_b64 v208, v[222:223]
    v_lshlrev_b32 v209, 4, v226
    v_add_u32 v209, 162304, v209
    ds_write_b128 v209, v[218:221]
    v_lshlrev_b32 v209, 4, v195
    v_add_u32 v209, 162304, v209
    s_waitcnt lgkmcnt(0)
    ds_read_b128 v[178:181], v209 offset:0
    s_waitcnt lgkmcnt(0)
    s_barrier
    ds_read_b128 v[156:159], v172 offset:0
    ds_read_b128 v[160:163], v172 offset:2048
    ds_read_b64_tr_b16 v[104:105], v176 offset:16384
    ds_read_b64_tr_b16 v[106:107], v176 offset:17024
    ds_read_b64_tr_b16 v[108:109], v176 offset:16392
    ds_read_b64_tr_b16 v[110:111], v176 offset:17032
    ds_read_b64_tr_b16 v[112:113], v176 offset:16400
    ds_read_b64_tr_b16 v[114:115], v176 offset:17040
    ds_read_b64_tr_b16 v[116:117], v176 offset:16408
    ds_read_b64_tr_b16 v[118:119], v176 offset:17048
    ds_read_b64_tr_b16 v[120:121], v176 offset:16416
    ds_read_b64_tr_b16 v[122:123], v176 offset:17056
    ds_read_b64_tr_b16 v[124:125], v176 offset:27648
    ds_read_b64_tr_b16 v[126:127], v176 offset:28288
    ds_read_b64_tr_b16 v[128:129], v176 offset:27656
    ds_read_b64_tr_b16 v[130:131], v176 offset:28296
    ds_read_b64_tr_b16 v[132:133], v176 offset:27664
    ds_read_b64_tr_b16 v[134:135], v176 offset:28304
    ds_read_b64_tr_b16 v[136:137], v176 offset:27672
    ds_read_b64_tr_b16 v[138:139], v176 offset:28312
    ds_read_b64_tr_b16 v[140:141], v176 offset:27680
    ds_read_b64_tr_b16 v[142:143], v176 offset:28320
    ds_read_b128 v[144:147], v174 offset:38912
    ds_read_b128 v[148:151], v174 offset:40960
    s_mov_b32 s59, 0
    s_mov_b32 s58, 0
gated_mix__ssm_conv_s5__linear_kernel_hedgehog__prompt_kernel_main90:
    s_waitcnt lgkmcnt(15)
    v_mfma_f32_16x16x32_bf16 v[0:3], v[104:107], v[156:159], v[0:3]
    ds_read_b128 v[164:167], v173 offset:0
    ds_read_b128 v[168:171], v173 offset:2048
    v_mfma_f32_16x16x32_bf16 v[4:7], v[104:107], v[160:163], v[4:7]
    s_add_u32 s63, s58, 44032
    s_cmp_ge_u32 s63, 132096
    v_mfma_f32_16x16x32_bf16 v[8:11], v[108:111], v[156:159], v[8:11]
    s_cselect_b32 s63, 0, s63
    s_sub_u32 s62, s63, s58
    v_mfma_f32_16x16x32_bf16 v[12:15], v[108:111], v[160:163], v[12:15]
    s_mov_b32 s58, s63
    ds_read_b64_tr_b16 v[104:105], v176 offset:22016
    v_mfma_f32_16x16x32_bf16 v[16:19], v[112:115], v[156:159], v[16:19]
    ds_read_b64_tr_b16 v[106:107], v176 offset:22656
    v_mfma_f32_16x16x32_bf16 v[20:23], v[112:115], v[160:163], v[20:23]
    ds_read_b64_tr_b16 v[108:109], v176 offset:22024
    ds_read_b64_tr_b16 v[110:111], v176 offset:22664
    s_waitcnt lgkmcnt(15)
    v_mfma_f32_16x16x32_bf16 v[24:27], v[116:119], v[156:159], v[24:27]
    ds_read_b64_tr_b16 v[112:113], v176 offset:22032
    v_mfma_f32_16x16x32_bf16 v[28:31], v[116:119], v[160:163], v[28:31]
    ds_read_b64_tr_b16 v[114:115], v176 offset:22672
    v_mfma_f32_16x16x32_bf16 v[32:35], v[120:123], v[156:159], v[32:35]
    ds_read_b64_tr_b16 v[116:117], v176 offset:22040
    v_mfma_f32_16x16x32_bf16 v[36:39], v[120:123], v[160:163], v[36:39]
    ds_read_b64_tr_b16 v[118:119], v176 offset:22680
    v_mfma_f32_16x16x32_bf16 v[40:43], v[124:127], v[156:159], v[40:43]
    ds_read_b64_tr_b16 v[120:121], v176 offset:22048
    v_mfma_f32_16x16x32_bf16 v[44:47], v[124:127], v[160:163], v[44:47]
    ds_read_b64_tr_b16 v[122:123], v176 offset:22688
    s_waitcnt lgkmcnt(15)
    v_mfma_f32_16x16x32_bf16 v[48:51], v[128:131], v[156:159], v[48:51]
    ds_read_b64_tr_b16 v[124:125], v176 offset:33280
    v_mfma_f32_16x16x32_bf16 v[52:55], v[128:131], v[160:163], v[52:55]
    ds_read_b64_tr_b16 v[126:127], v176 offset:33920
    v_mfma_f32_16x16x32_bf16 v[56:59], v[132:135], v[156:159], v[56:59]
    ds_read_b64_tr_b16 v[128:129], v176 offset:33288
    v_mfma_f32_16x16x32_bf16 v[60:63], v[132:135], v[160:163], v[60:63]
    ds_read_b64_tr_b16 v[130:131], v176 offset:33928
    v_mfma_f32_16x16x32_bf16 v[64:67], v[136:139], v[156:159], v[64:67]
    ds_read_b64_tr_b16 v[132:133], v176 offset:33296
    v_mfma_f32_16x16x32_bf16 v[68:71], v[136:139], v[160:163], v[68:71]
    ds_read_b64_tr_b16 v[134:135], v176 offset:33936
    s_waitcnt lgkmcnt(15)
    v_mfma_f32_16x16x32_bf16 v[72:75], v[140:143], v[156:159], v[72:75]
    ds_read_b64_tr_b16 v[136:137], v176 offset:33304
    v_mfma_f32_16x16x32_bf16 v[76:79], v[140:143], v[160:163], v[76:79]
    ds_read_b64_tr_b16 v[138:139], v176 offset:33944
    v_mfma_f32_16x16x32_bf16 v[80:83], v[156:159], v[144:147], v[80:83]
    ds_read_b64_tr_b16 v[140:141], v176 offset:33312
    v_mfma_f32_16x16x32_bf16 v[84:87], v[160:163], v[144:147], v[84:87]
    ds_read_b64_tr_b16 v[142:143], v176 offset:33952
    v_mfma_f32_16x16x32_bf16 v[88:91], v[156:159], v[148:151], v[88:91]
    ds_read_b128 v[144:147], v175 offset:38912
    v_mfma_f32_16x16x32_bf16 v[92:95], v[160:163], v[148:151], v[92:95]
    ds_read_b128 v[148:151], v175 offset:40960
    s_waitcnt lgkmcnt(15)
    v_mfma_f32_16x16x32_bf16 v[0:3], v[104:107], v[164:167], v[0:3]
    v_mfma_f32_16x16x32_bf16 v[4:7], v[104:107], v[168:171], v[4:7]
    v_mfma_f32_16x16x32_bf16 v[8:11], v[108:111], v[164:167], v[8:11]
    v_add_u32 v172, s62, v172
    v_add_u32 v173, s62, v173
    v_mfma_f32_16x16x32_bf16 v[12:15], v[108:111], v[168:171], v[12:15]
    v_add_u32 v174, s62, v174
    v_add_u32 v175, s62, v175
    v_mfma_f32_16x16x32_bf16 v[16:19], v[112:115], v[164:167], v[16:19]
    v_add_u32 v176, s62, v176
    v_mfma_f32_16x16x32_bf16 v[20:23], v[112:115], v[168:171], v[20:23]
    s_waitcnt lgkmcnt(0)
    s_barrier
    v_mfma_f32_16x16x32_bf16 v[24:27], v[116:119], v[164:167], v[24:27]
    ds_read_b128 v[156:159], v172 offset:0
    ds_read_b128 v[160:163], v172 offset:2048
    v_mfma_f32_16x16x32_bf16 v[28:31], v[116:119], v[168:171], v[28:31]
    ds_read_b64_tr_b16 v[104:105], v176 offset:16384
    ds_read_b64_tr_b16 v[106:107], v176 offset:17024
    v_mfma_f32_16x16x32_bf16 v[32:35], v[120:123], v[164:167], v[32:35]
    ds_read_b64_tr_b16 v[108:109], v176 offset:16392
    ds_read_b64_tr_b16 v[110:111], v176 offset:17032
    v_mfma_f32_16x16x32_bf16 v[36:39], v[120:123], v[168:171], v[36:39]
    ds_read_b64_tr_b16 v[112:113], v176 offset:16400
    ds_read_b64_tr_b16 v[114:115], v176 offset:17040
    v_mfma_f32_16x16x32_bf16 v[40:43], v[124:127], v[164:167], v[40:43]
    ds_read_b64_tr_b16 v[116:117], v176 offset:16408
    ds_read_b64_tr_b16 v[118:119], v176 offset:17048
    v_mfma_f32_16x16x32_bf16 v[44:47], v[124:127], v[168:171], v[44:47]
    ds_read_b64_tr_b16 v[120:121], v176 offset:16416
    ds_read_b64_tr_b16 v[122:123], v176 offset:17056
    v_mfma_f32_16x16x32_bf16 v[48:51], v[128:131], v[164:167], v[48:51]
    ds_read_b64_tr_b16 v[124:125], v176 offset:27648
    v_mfma_f32_16x16x32_bf16 v[52:55], v[128:131], v[168:171], v[52:55]
    ds_read_b64_tr_b16 v[126:127], v176 offset:28288
    ds_read_b64_tr_b16 v[128:129], v176 offset:27656
    v_mfma_f32_16x16x32_bf16 v[56:59], v[132:135], v[164:167], v[56:59]
    ds_read_b64_tr_b16 v[130:131], v176 offset:28296
    v_mfma_f32_16x16x32_bf16 v[60:63], v[132:135], v[168:171], v[60:63]
    ds_read_b64_tr_b16 v[132:133], v176 offset:27664
    v_mfma_f32_16x16x32_bf16 v[64:67], v[136:139], v[164:167], v[64:67]
    ds_read_b64_tr_b16 v[134:135], v176 offset:28304
    v_mfma_f32_16x16x32_bf16 v[68:71], v[136:139], v[168:171], v[68:71]
    ds_read_b64_tr_b16 v[136:137], v176 offset:27672
    v_mfma_f32_16x16x32_bf16 v[72:75], v[140:143], v[164:167], v[72:75]
    ds_read_b64_tr_b16 v[138:139], v176 offset:28312
    v_mfma_f32_16x16x32_bf16 v[76:79], v[140:143], v[168:171], v[76:79]
    ds_read_b64_tr_b16 v[140:141], v176 offset:27680
    v_mfma_f32_16x16x32_bf16 v[80:83], v[164:167], v[144:147], v[80:83]
    ds_read_b64_tr_b16 v[142:143], v176 offset:28320
    v_mfma_f32_16x16x32_bf16 v[84:87], v[168:171], v[144:147], v[84:87]
    ds_read_b128 v[144:147], v174 offset:38912
    v_mfma_f32_16x16x32_bf16 v[88:91], v[164:167], v[148:151], v[88:91]
    v_mfma_f32_16x16x32_bf16 v[92:95], v[168:171], v[148:151], v[92:95]
    ds_read_b128 v[148:151], v174 offset:40960
    s_add_u32 s59, s59, 1
    s_cmp_lt_u32 s59, 9
    s_cbranch_scc1 gated_mix__ssm_conv_s5__linear_kernel_hedgehog__prompt_kernel_main90
    s_waitcnt lgkmcnt(15)
    v_mfma_f32_16x16x32_bf16 v[0:3], v[104:107], v[156:159], v[0:3]
    ds_read_b128 v[164:167], v173 offset:0
    v_mfma_f32_16x16x32_bf16 v[4:7], v[104:107], v[160:163], v[4:7]
    ds_read_b128 v[168:171], v173 offset:2048
    v_mfma_f32_16x16x32_bf16 v[8:11], v[108:111], v[156:159], v[8:11]
    ds_read_b64_tr_b16 v[104:105], v176 offset:22016
    v_mfma_f32_16x16x32_bf16 v[12:15], v[108:111], v[160:163], v[12:15]
    ds_read_b64_tr_b16 v[106:107], v176 offset:22656
    v_mfma_f32_16x16x32_bf16 v[16:19], v[112:115], v[156:159], v[16:19]
    ds_read_b64_tr_b16 v[108:109], v176 offset:22024
    v_mfma_f32_16x16x32_bf16 v[20:23], v[112:115], v[160:163], v[20:23]
    ds_read_b64_tr_b16 v[110:111], v176 offset:22664
    s_waitcnt lgkmcnt(15)
    v_mfma_f32_16x16x32_bf16 v[24:27], v[116:119], v[156:159], v[24:27]
    ds_read_b64_tr_b16 v[112:113], v176 offset:22032
    v_mfma_f32_16x16x32_bf16 v[28:31], v[116:119], v[160:163], v[28:31]
    ds_read_b64_tr_b16 v[114:115], v176 offset:22672
    v_mfma_f32_16x16x32_bf16 v[32:35], v[120:123], v[156:159], v[32:35]
    ds_read_b64_tr_b16 v[116:117], v176 offset:22040
    v_mfma_f32_16x16x32_bf16 v[36:39], v[120:123], v[160:163], v[36:39]
    ds_read_b64_tr_b16 v[118:119], v176 offset:22680
    v_mfma_f32_16x16x32_bf16 v[40:43], v[124:127], v[156:159], v[40:43]
    ds_read_b64_tr_b16 v[120:121], v176 offset:22048
    v_mfma_f32_16x16x32_bf16 v[44:47], v[124:127], v[160:163], v[44:47]
    ds_read_b64_tr_b16 v[122:123], v176 offset:22688
    s_waitcnt lgkmcnt(15)
    v_mfma_f32_16x16x32_bf16 v[48:51], v[128:131], v[156:159], v[48:51]
    ds_read_b64_tr_b16 v[124:125], v176 offset:33280
    v_mfma_f32_16x16x32_bf16 v[52:55], v[128:131], v[160:163], v[52:55]
    ds_read_b64_tr_b16 v[126:127], v176 offset:33920
    v_mfma_f32_16x16x32_bf16 v[56:59], v[132:135], v[156:159], v[56:59]
    ds_read_b64_tr_b16 v[128:129], v176 offset:33288
    v_mfma_f32_16x16x32_bf16 v[60:63], v[132:135], v[160:163], v[60:63]
    ds_read_b64_tr_b16 v[130:131], v176 offset:33928
    v_mfma_f32_16x16x32_bf16 v[64:67], v[136:139], v[156:159], v[64:67]
    ds_read_b64_tr_b16 v[132:133], v176 offset:33296
    v_mfma_f32_16x16x32_bf16 v[68:71], v[136:139], v[160:163], v[68:71]
    ds_read_b64_tr_b16 v[134:135], v176 offset:33936
    s_waitcnt lgkmcnt(15)
    v_mfma_f32_16x16x32_bf16 v[72:75], v[140:143], v[156:159], v[72:75]
    ds_read_b64_tr_b16 v[136:137], v176 offset:33304
    v_mfma_f32_16x16x32_bf16 v[76:79], v[140:143], v[160:163], v[76:79]
    ds_read_b64_tr_b16 v[138:139], v176 offset:33944
    v_mfma_f32_16x16x32_bf16 v[80:83], v[156:159], v[144:147], v[80:83]
    ds_read_b64_tr_b16 v[140:141], v176 offset:33312
    v_mfma_f32_16x16x32_bf16 v[84:87], v[160:163], v[144:147], v[84:87]
    ds_read_b64_tr_b16 v[142:143], v176 offset:33952
    v_mfma_f32_16x16x32_bf16 v[88:91], v[156:159], v[148:151], v[88:91]
    ds_read_b128 v[144:147], v175 offset:38912
    v_mfma_f32_16x16x32_bf16 v[92:95], v[160:163], v[148:151], v[92:95]
    ds_read_b128 v[148:151], v175 offset:40960
    s_waitcnt lgkmcnt(15)
    v_mfma_f32_16x16x32_bf16 v[0:3], v[104:107], v[164:167], v[0:3]
    v_mfma_f32_16x16x32_bf16 v[4:7], v[104:107], v[168:171], v[4:7]
    v_mfma_f32_16x16x32_bf16 v[8:11], v[108:111], v[164:167], v[8:11]
    v_mfma_f32_16x16x32_bf16 v[12:15], v[108:111], v[168:171], v[12:15]
    v_mfma_f32_16x16x32_bf16 v[16:19], v[112:115], v[164:167], v[16:19]
    v_mfma_f32_16x16x32_bf16 v[20:23], v[112:115], v[168:171], v[20:23]
    s_waitcnt lgkmcnt(14)
    v_mfma_f32_16x16x32_bf16 v[24:27], v[116:119], v[164:167], v[24:27]
    v_mfma_f32_16x16x32_bf16 v[28:31], v[116:119], v[168:171], v[28:31]
    s_waitcnt lgkmcnt(12)
    v_mfma_f32_16x16x32_bf16 v[32:35], v[120:123], v[164:167], v[32:35]
    v_mfma_f32_16x16x32_bf16 v[36:39], v[120:123], v[168:171], v[36:39]
    s_waitcnt lgkmcnt(10)
    v_mfma_f32_16x16x32_bf16 v[40:43], v[124:127], v[164:167], v[40:43]
    v_mfma_f32_16x16x32_bf16 v[44:47], v[124:127], v[168:171], v[44:47]
    s_waitcnt lgkmcnt(8)
    v_mfma_f32_16x16x32_bf16 v[48:51], v[128:131], v[164:167], v[48:51]
    v_mfma_f32_16x16x32_bf16 v[52:55], v[128:131], v[168:171], v[52:55]
    s_waitcnt lgkmcnt(6)
    v_mfma_f32_16x16x32_bf16 v[56:59], v[132:135], v[164:167], v[56:59]
    v_mfma_f32_16x16x32_bf16 v[60:63], v[132:135], v[168:171], v[60:63]
    s_waitcnt lgkmcnt(4)
    v_mfma_f32_16x16x32_bf16 v[64:67], v[136:139], v[164:167], v[64:67]
    v_mfma_f32_16x16x32_bf16 v[68:71], v[136:139], v[168:171], v[68:71]
    s_waitcnt lgkmcnt(2)
    v_mfma_f32_16x16x32_bf16 v[72:75], v[140:143], v[164:167], v[72:75]
    v_mfma_f32_16x16x32_bf16 v[76:79], v[140:143], v[168:171], v[76:79]
    s_waitcnt lgkmcnt(1)
    v_mfma_f32_16x16x32_bf16 v[80:83], v[164:167], v[144:147], v[80:83]
    v_mfma_f32_16x16x32_bf16 v[84:87], v[168:171], v[144:147], v[84:87]
    s_waitcnt lgkmcnt(0)
    v_mfma_f32_16x16x32_bf16 v[88:91], v[164:167], v[148:151], v[88:91]
    v_mfma_f32_16x16x32_bf16 v[92:95], v[168:171], v[148:151], v[92:95]
    s_waitcnt lgkmcnt(0)
    s_nop 7
    s_lshl_b32 s4, s3, 2
    v_add_u32 v206, s4, v196
    v_lshlrev_b32 v206, 9, v206
    v_lshl_add_u32 v206, v195, 3, v206
    v_add_u32 v206, 136064, v206
    v_pk_fma_f32 v[112:113], v[178:179], v[80:81], v[82:83] op_sel_hi:[0,1,1]
    v_pk_fma_f32 v[114:115], v[178:179], v[88:89], v[90:91] op_sel_hi:[0,1,1]
    v_pk_fma_f32 v[108:109], v[178:179], v[88:89], v[112:113] op_sel:[1,0,0] op_sel_hi:[1,1,1] neg_lo:[1,0,0] neg_hi:[1,0,0]
    v_pk_fma_f32 v[110:111], v[178:179], v[80:81], v[114:115] op_sel:[1,0,0] op_sel_hi:[1,1,1]
    v_pk_fma_f32 v[112:113], v[178:179], v[108:109], v[84:85] op_sel_hi:[0,1,1]
    v_pk_fma_f32 v[114:115], v[178:179], v[110:111], v[92:93] op_sel_hi:[0,1,1]
    v_pk_fma_f32 v[104:105], v[178:179], v[110:111], v[112:113] op_sel:[1,0,0] op_sel_hi:[1,1,1] neg_lo:[1,0,0] neg_hi:[1,0,0]
    v_pk_fma_f32 v[106:107], v[178:179], v[108:109], v[114:115] op_sel:[1,0,0] op_sel_hi:[1,1,1]
    v_pk_fma_f32 v[112:113], v[178:179], v[104:105], v[86:87] op_sel_hi:[0,1,1]
    v_pk_fma_f32 v[114:115], v[178:179], v[106:107], v[94:95] op_sel_hi:[0,1,1]
    v_pk_fma_f32 v[108:109], v[178:179], v[106:107], v[112:113] op_sel:[1,0,0] op_sel_hi:[1,1,1] neg_lo:[1,0,0] neg_hi:[1,0,0]
    v_pk_fma_f32 v[110:111], v[178:179], v[104:105], v[114:115] op_sel:[1,0,0] op_sel_hi:[1,1,1]
    v_fma_f32 v116, v180, v108, v109
    v_fma_f32 v117, v180, v110, v111
    v_fma_f32 v116, -v181, v110, v116
    v_fma_f32 v117, v181, v108, v117
    ds_write_b64 v206, v[116:117] offset:0
    v_mov_b32 v198, v108
    v_mov_b32 v199, v110
    v_mov_b32 v208, 152448
    v_mov_b32 v207, 1
    s_waitcnt lgkmcnt(0)
    s_mov_b64 s[60:61], exec
    s_mov_b64 exec, 1
    ds_add_u32 v208, v207
    s_mov_b64 exec, s[60:61]
    v_and_b32 v208, 3, v195
    v_lshrrev_b32 v209, 2, v195
    v_mul_u32_u24 v177, 800, v208
    v_mul_u32_u24 v209, 40, v209
    v_add_u32 v177, v177, v209
    v_add_u32 v177, 132096, v177
    v_cmp_eq_u32 vcc, v208, v196
    v_mov_b32 v209, 135296
    s_nop 0
    v_cndmask_b32 v177, v209, v177, vcc
    ds_read_b64_tr_b16 v[208:209], v177 offset:0
    ds_read_b64_tr_b16 v[210:211], v177 offset:160
    ds_read_b64_tr_b16 v[212:213], v177 offset:320
    ds_read_b64_tr_b16 v[214:215], v177 offset:480
    ds_read_b64_tr_b16 v[216:217], v177 offset:640
    v_mov_b32 v218, 0
    v_mov_b32 v219, 0
    ds_read_b64_tr_b16 v[220:221], v177 offset:8
    ds_read_b64_tr_b16 v[222:223], v177 offset:168
    ds_read_b64_tr_b16 v[224:225], v177 offset:328
    ds_read_b64_tr_b16 v[226:227], v177 offset:488
    ds_read_b64_tr_b16 v[228:229], v177 offset:648
    v_mov_b32 v230, 0
    v_mov_b32 v231, 0
    ds_read_b64_tr_b16 v[232:233], v177 offset:16
    ds_read_b64_tr_b16 v[234:235], v177 offset:176
    ds_read_b64_tr_b16 v[236:237], v177 offset:336
    ds_read_b64_tr_b16 v[238:239], v177 offset:496
    ds_read_b64_tr_b16 v[240:241], v177 offset:656
    v_mov_b32 v242, 0
    v_mov_b32 v243, 0
    ds_read_b64_tr_b16 v[244:245], v177 offset:24
    ds_read_b64_tr_b16 v[246:247], v177 offset:184
    ds_read_b64_tr_b16 v[248:249], v177 offset:344
    ds_read_b64_tr_b16 v[250:251], v177 offset:504
    ds_read_b64_tr_b16 v[252:253], v177 offset:664
    v_mov_b32 v254, 0
    v_mov_b32 v255, 0
    ds_read_b64_tr_b16 v[160:161], v177 offset:32
    ds_read_b64_tr_b16 v[162:163], v177 offset:192
    ds_read_b64_tr_b16 v[164:165], v177 offset:352
    ds_read_b64_tr_b16 v[166:167], v177 offset:512
    ds_read_b64_tr_b16 v[168:169], v177 offset:672
    v_mov_b32 v170, 0
    v_mov_b32 v171, 0
    v_cvt_pk_bf16_f32 v104, v0, v1
    v_cvt_pk_bf16_f32 v105, v2, v3
    v_cvt_pk_bf16_f32 v106, v8, v9
    v_cvt_pk_bf16_f32 v107, v10, v11
    v_cvt_pk_bf16_f32 v108, v16, v17
    v_cvt_pk_bf16_f32 v109, v18, v19
    v_cvt_pk_bf16_f32 v110, v24, v25
    v_cvt_pk_bf16_f32 v111, v26, v27
    v_cvt_pk_bf16_f32 v112, v32, v33
    v_cvt_pk_bf16_f32 v113, v34, v35
    v_cvt_pk_bf16_f32 v116, v4, v5
    v_cvt_pk_bf16_f32 v117, v6, v7
    v_cvt_pk_bf16_f32 v118, v12, v13
    v_cvt_pk_bf16_f32 v119, v14, v15
    v_cvt_pk_bf16_f32 v120, v20, v21
    v_cvt_pk_bf16_f32 v121, v22, v23
    v_cvt_pk_bf16_f32 v122, v28, v29
    v_cvt_pk_bf16_f32 v123, v30, v31
    v_cvt_pk_bf16_f32 v124, v36, v37
    v_cvt_pk_bf16_f32 v125, v38, v39
    v_mov_b32 v114, 0
    v_mov_b32 v115, 0
    v_mov_b32 v126, 0
    v_mov_b32 v127, 0
    s_waitcnt lgkmcnt(0)
    v_mfma_f32_16x16x32_bf16 v[0:3], v[208:211], v[104:107], 0
    v_mfma_f32_16x16x32_bf16 v[20:23], v[208:211], v[116:119], 0
    v_mfma_f32_16x16x32_bf16 v[0:3], v[212:215], v[108:111], v[0:3]
    v_mfma_f32_16x16x32_bf16 v[20:23], v[212:215], v[120:123], v[20:23]
    v_mfma_f32_16x16x32_bf16 v[0:3], v[216:219], v[112:115], v[0:3]
    v_mfma_f32_16x16x32_bf16 v[20:23], v[216:219], v[124:127], v[20:23]
    v_mfma_f32_16x16x32_bf16 v[4:7], v[220:223], v[104:107], 0
    v_mfma_f32_16x16x32_bf16 v[24:27], v[220:223], v[116:119], 0
    v_mfma_f32_16x16x32_bf16 v[4:7], v[224:227], v[108:111], v[4:7]
    v_mfma_f32_16x16x32_bf16 v[24:27], v[224:227], v[120:123], v[24:27]
    v_mfma_f32_16x16x32_bf16 v[4:7], v[228:231], v[112:115], v[4:7]
    v_mfma_f32_16x16x32_bf16 v[24:27], v[228:231], v[124:127], v[24:27]
    v_mfma_f32_16x16x32_bf16 v[8:11], v[232:235], v[104:107], 0
    v_mfma_f32_16x16x32_bf16 v[28:31], v[232:235], v[116:119], 0
    v_mfma_f32_16x16x32_bf16 v[8:11], v[236:239], v[108:111], v[8:11]
    v_mfma_f32_16x16x32_bf16 v[28:31], v[236:239], v[120:123], v[28:31]
    v_mfma_f32_16x16x32_bf16 v[8:11], v[240:243], v[112:115], v[8:11]
    v_mfma_f32_16x16x32_bf16 v[28:31], v[240:243], v[124:127], v[28:31]
    v_mfma_f32_16x16x32_bf16 v[12:15], v[244:247], v[104:107], 0
    v_mfma_f32_16x16x32_bf16 v[32:35], v[244:247], v[116:119], 0
    v_mfma_f32_16x16x32_bf16 v[12:15], v[248:251], v[108:111], v[12:15]
    v_mfma_f32_16x16x32_bf16 v[32:35], v[248:251], v[120:123], v[32:35]
    v_mfma_f32_16x16x32_bf16 v[12:15], v[252:255], v[112:115], v[12:15]
    v_mfma_f32_16x16x32_bf16 v[32:35], v[252:255], v[124:127], v[32:35]
    v_mfma_f32_16x16x32_bf16 v[16:19], v[160:163], v[104:107], 0
    v_mfma_f32_16x16x32_bf16 v[36:39], v[160:163], v[116:119], 0
    v_mfma_f32_16x16x32_bf16 v[16:19], v[164:167], v[108:111], v[16:19]
    v_mfma_f32_16x16x32_bf16 v[36:39], v[164:167], v[120:123], v[36:39]
    v_mfma_f32_16x16x32_bf16 v[16:19], v[168:171], v[112:115], v[16:19]
    v_mfma_f32_16x16x32_bf16 v[36:39], v[168:171], v[124:127], v[36:39]
    v_mov_b32 v172, 0x3fb8aa3b
    v_max3_f32 v208, v0, v1, v2
    v_max3_f32 v218, v20, v21, v22
    v_min3_f32 v209, v0, v1, v2
    v_min3_f32 v219, v20, v21, v22
    v_max3_f32 v208, v208, v3, v4
    v_max3_f32 v218, v218, v23, v24
    v_min3_f32 v209, v209, v3, v4
    v_min3_f32 v219, v219, v23, v24
    v_max3_f32 v208, v208, v5, v6
    v_max3_f32 v218, v218, v25, v26
    v_min3_f32 v209, v209, v5, v6
    v_min3_f32 v219, v219, v25, v26
    v_max3_f32 v208, v208, v7, v8
    v_max3_f32 v218, v218, v27, v28
    v_min3_f32 v209, v209, v7, v8
    v_min3_f32 v219, v219, v27, v28
    v_max3_f32 v208, v208, v9, v10
    v_max3_f32 v218, v218, v29, v30
    v_min3_f32 v209, v209, v9, v10
    v_min3_f32 v219, v219, v29, v30
    v_max3_f32 v208, v208, v11, v12
    v_max3_f32 v218, v218, v31, v32
    v_min3_f32 v209, v209, v11, v12
    v_min3_f32 v219, v219, v31, v32
    v_max3_f32 v208, v208, v13, v14
    v_max3_f32 v218, v218, v33, v34
    v_min3_f32 v209, v209, v13, v14
    v_min3_f32 v219, v219, v33, v34
    v_max3_f32 v208, v208, v15, v16
    v_max3_f32 v218, v218, v35, v36
    v_min3_f32 v209, v209, v15, v16
    v_min3_f32 v219, v219, v35, v36
    v_max3_f32 v208, v208, v17, v18
    v_max3_f32 v218, v218, v37, v38
    v_min3_f32 v209, v209, v17, v18
    v_min3_f32 v219, v219, v37, v38
    v_max_f32 v208, v208, v19
    v_max_f32 v218, v218, v39
    v_min_f32 v209, v209, v19
    v_min_f32 v219, v219, v39
    v_mul_f32 v210, v172, v208
    v_mul_f32 v220, v172, v218
    v_mul_f32 v211, v172, v209
    v_mul_f32 v221, v172, v219
    v_pk_fma_f32 v[104:105], v[0:1], v[172:173], v[210:211] op_sel:[0,0,1] op_sel_hi:[1,0,1] neg_lo:[1,0,0] neg_hi:[1,0,0]
    v_pk_fma_f32 v[128:129], v[20:21], v[172:173], v[220:221] op_sel:[0,0,1] op_sel_hi:[1,0,1] neg_lo:[1,0,0] neg_hi:[1,0,0]
    v_pk_fma_f32 v[0:1], v[0:1], v[172:173], v[210:211] op_sel_hi:[1,0,0] neg_lo:[0,0,1] neg_hi:[0,0,1]
    v_pk_fma_f32 v[20:21], v[20:21], v[172:173], v[220:221] op_sel_hi:[1,0,0] neg_lo:[0,0,1] neg_hi:[0,0,1]
    v_pk_fma_f32 v[106:107], v[2:3], v[172:173], v[210:211] op_sel:[0,0,1] op_sel_hi:[1,0,1] neg_lo:[1,0,0] neg_hi:[1,0,0]
    v_pk_fma_f32 v[130:131], v[22:23], v[172:173], v[220:221] op_sel:[0,0,1] op_sel_hi:[1,0,1] neg_lo:[1,0,0] neg_hi:[1,0,0]
    v_pk_fma_f32 v[2:3], v[2:3], v[172:173], v[210:211] op_sel_hi:[1,0,0] neg_lo:[0,0,1] neg_hi:[0,0,1]
    v_pk_fma_f32 v[22:23], v[22:23], v[172:173], v[220:221] op_sel_hi:[1,0,0] neg_lo:[0,0,1] neg_hi:[0,0,1]
    v_pk_fma_f32 v[108:109], v[4:5], v[172:173], v[210:211] op_sel:[0,0,1] op_sel_hi:[1,0,1] neg_lo:[1,0,0] neg_hi:[1,0,0]
    v_pk_fma_f32 v[132:133], v[24:25], v[172:173], v[220:221] op_sel:[0,0,1] op_sel_hi:[1,0,1] neg_lo:[1,0,0] neg_hi:[1,0,0]
    v_pk_fma_f32 v[4:5], v[4:5], v[172:173], v[210:211] op_sel_hi:[1,0,0] neg_lo:[0,0,1] neg_hi:[0,0,1]
    v_pk_fma_f32 v[24:25], v[24:25], v[172:173], v[220:221] op_sel_hi:[1,0,0] neg_lo:[0,0,1] neg_hi:[0,0,1]
    v_pk_fma_f32 v[110:111], v[6:7], v[172:173], v[210:211] op_sel:[0,0,1] op_sel_hi:[1,0,1] neg_lo:[1,0,0] neg_hi:[1,0,0]
    v_pk_fma_f32 v[134:135], v[26:27], v[172:173], v[220:221] op_sel:[0,0,1] op_sel_hi:[1,0,1] neg_lo:[1,0,0] neg_hi:[1,0,0]
    v_pk_fma_f32 v[6:7], v[6:7], v[172:173], v[210:211] op_sel_hi:[1,0,0] neg_lo:[0,0,1] neg_hi:[0,0,1]
    v_pk_fma_f32 v[26:27], v[26:27], v[172:173], v[220:221] op_sel_hi:[1,0,0] neg_lo:[0,0,1] neg_hi:[0,0,1]
    v_pk_fma_f32 v[112:113], v[8:9], v[172:173], v[210:211] op_sel:[0,0,1] op_sel_hi:[1,0,1] neg_lo:[1,0,0] neg_hi:[1,0,0]
    v_pk_fma_f32 v[136:137], v[28:29], v[172:173], v[220:221] op_sel:[0,0,1] op_sel_hi:[1,0,1] neg_lo:[1,0,0] neg_hi:[1,0,0]
    v_pk_fma_f32 v[8:9], v[8:9], v[172:173], v[210:211] op_sel_hi:[1,0,0] neg_lo:[0,0,1] neg_hi:[0,0,1]
    v_pk_fma_f32 v[28:29], v[28:29], v[172:173], v[220:221] op_sel_hi:[1,0,0] neg_lo:[0,0,1] neg_hi:[0,0,1]
    v_pk_fma_f32 v[114:115], v[10:11], v[172:173], v[210:211] op_sel:[0,0,1] op_sel_hi:[1,0,1] neg_lo:[1,0,0] neg_hi:[1,0,0]
    v_pk_fma_f32 v[138:139], v[30:31], v[172:173], v[220:221] op_sel:[0,0,1] op_sel_hi:[1,0,1] neg_lo:[1,0,0] neg_hi:[1,0,0]
    v_pk_fma_f32 v[10:11], v[10:11], v[172:173], v[210:211] op_sel_hi:[1,0,0] neg_lo:[0,0,1] neg_hi:[0,0,1]
    v_pk_fma_f32 v[30:31], v[30:31], v[172:173], v[220:221] op_sel_hi:[1,0,0] neg_lo:[0,0,1] neg_hi:[0,0,1]
    v_pk_fma_f32 v[116:117], v[12:13], v[172:173], v[210:211] op_sel:[0,0,1] op_sel_hi:[1,0,1] neg_lo:[1,0,0] neg_hi:[1,0,0]
    v_pk_fma_f32 v[140:141], v[32:33], v[172:173], v[220:221] op_sel:[0,0,1] op_sel_hi:[1,0,1] neg_lo:[1,0,0] neg_hi:[1,0,0]
    v_pk_fma_f32 v[12:13], v[12:13], v[172:173], v[210:211] op_sel_hi:[1,0,0] neg_lo:[0,0,1] neg_hi:[0,0,1]
    v_pk_fma_f32 v[32:33], v[32:33], v[172:173], v[220:221] op_sel_hi:[1,0,0] neg_lo:[0,0,1] neg_hi:[0,0,1]
    v_pk_fma_f32 v[118:119], v[14:15], v[172:173], v[210:211] op_sel:[0,0,1] op_sel_hi:[1,0,1] neg_lo:[1,0,0] neg_hi:[1,0,0]
    v_pk_fma_f32 v[142:143], v[34:35], v[172:173], v[220:221] op_sel:[0,0,1] op_sel_hi:[1,0,1] neg_lo:[1,0,0] neg_hi:[1,0,0]
    v_pk_fma_f32 v[14:15], v[14:15], v[172:173], v[210:211] op_sel_hi:[1,0,0] neg_lo:[0,0,1] neg_hi:[0,0,1]
    v_pk_fma_f32 v[34:35], v[34:35], v[172:173], v[220:221] op_sel_hi:[1,0,0] neg_lo:[0,0,1] neg_hi:[0,0,1]
    v_pk_fma_f32 v[120:121], v[16:17], v[172:173], v[210:211] op_sel:[0,0,1] op_sel_hi:[1,0,1] neg_lo:[1,0,0] neg_hi:[1,0,0]
    v_pk_fma_f32 v[144:145], v[36:37], v[172:173], v[220:221] op_sel:[0,0,1] op_sel_hi:[1,0,1] neg_lo:[1,0,0] neg_hi:[1,0,0]
    v_pk_fma_f32 v[16:17], v[16:17], v[172:173], v[210:211] op_sel_hi:[1,0,0] neg_lo:[0,0,1] neg_hi:[0,0,1]
    v_pk_fma_f32 v[36:37], v[36:37], v[172:173], v[220:221] op_sel_hi:[1,0,0] neg_lo:[0,0,1] neg_hi:[0,0,1]
    v_pk_fma_f32 v[122:123], v[18:19], v[172:173], v[210:211] op_sel:[0,0,1] op_sel_hi:[1,0,1] neg_lo:[1,0,0] neg_hi:[1,0,0]
    v_pk_fma_f32 v[146:147], v[38:39], v[172:173], v[220:221] op_sel:[0,0,1] op_sel_hi:[1,0,1] neg_lo:[1,0,0] neg_hi:[1,0,0]
    v_pk_fma_f32 v[18:19], v[18:19], v[172:173], v[210:211] op_sel_hi:[1,0,0] neg_lo:[0,0,1] neg_hi:[0,0,1]
    v_pk_fma_f32 v[38:39], v[38:39], v[172:173], v[220:221] op_sel_hi:[1,0,0] neg_lo:[0,0,1] neg_hi:[0,0,1]
    v_exp_f32 v0, v0
    v_exp_f32 v20, v20
    v_exp_f32 v104, v104
    v_exp_f32 v128, v128
    v_exp_f32 v1, v1
    v_exp_f32 v21, v21
    v_exp_f32 v105, v105
    v_exp_f32 v129, v129
    v_exp_f32 v2, v2
    v_exp_f32 v22, v22
    v_exp_f32 v106, v106
    v_exp_f32 v130, v130
    v_exp_f32 v3, v3
    v_exp_f32 v23, v23
    v_exp_f32 v107, v107
    v_exp_f32 v131, v131
    v_exp_f32 v4, v4
    v_exp_f32 v24, v24
    v_exp_f32 v108, v108
    v_exp_f32 v132, v132
    v_exp_f32 v5, v5
    v_exp_f32 v25, v25
    v_exp_f32 v109, v109
    v_exp_f32 v133, v133
    v_exp_f32 v6, v6
    v_exp_f32 v26, v26
    v_exp_f32 v110, v110
    v_exp_f32 v134, v134
    v_exp_f32 v7, v7
    v_exp_f32 v27, v27
    v_exp_f32 v111, v111
    v_exp_f32 v135, v135
    v_exp_f32 v8, v8
    v_exp_f32 v28, v28
    v_exp_f32 v112, v112
    v_exp_f32 v136, v136
    v_exp_f32 v9, v9
    v_exp_f32 v29, v29
    v_exp_f32 v113, v113
    v_exp_f32 v137, v137
    v_exp_f32 v10, v10
    v_exp_f32 v30, v30
    v_exp_f32 v114, v114
    v_exp_f32 v138, v138
    v_exp_f32 v11, v11
    v_exp_f32 v31, v31
    v_exp_f32 v115, v115
    v_exp_f32 v139, v139
    v_exp_f32 v12, v12
    v_exp_f32 v32, v32
    v_exp_f32 v116, v116
    v_exp_f32 v140, v140
    v_exp_f32 v13, v13
    v_exp_f32 v33, v33
    v_exp_f32 v117, v117
    v_exp_f32 v141, v141
    v_exp_f32 v14, v14
    v_exp_f32 v34, v34
    v_exp_f32 v118, v118
    v_exp_f32 v142, v142
    v_exp_f32 v15, v15
    v_exp_f32 v35, v35
    v_exp_f32 v119, v119
    v_exp_f32 v143, v143
    v_exp_f32 v16, v16
    v_exp_f32 v36, v36
    v_exp_f32 v120, v120
    v_exp_f32 v144, v144
    v_exp_f32 v17, v17
    v_exp_f32 v37, v37
    v_exp_f32 v121, v121
    v_exp_f32 v145, v145
    v_exp_f32 v18, v18
    v_exp_f32 v38, v38
    v_exp_f32 v122, v122
    v_exp_f32 v146, v146
    v_exp_f32 v19, v19
    v_exp_f32 v39, v39
    v_exp_f32 v123, v123
    v_exp_f32 v147, v147
    v_pk_add_f32 v[212:213], v[0:1], v[2:3]
    v_pk_add_f32 v[222:223], v[20:21], v[22:23]
    v_pk_add_f32 v[214:215], v[104:105], v[106:107]
    v_pk_add_f32 v[224:225], v[128:129], v[130:131]
    v_pk_add_f32 v[212:213], v[212:213], v[4:5]
    v_pk_add_f32 v[222:223], v[222:223], v[24:25]
    v_pk_add_f32 v[214:215], v[214:215], v[108:109]
    v_pk_add_f32 v[224:225], v[224:225], v[132:133]
    v_pk_add_f32 v[212:213], v[212:213], v[6:7]
    v_pk_add_f32 v[222:223], v[222:223], v[26:27]
    v_pk_add_f32 v[214:215], v[214:215], v[110:111]
    v_pk_add_f32 v[224:225], v[224:225], v[134:135]
    v_pk_add_f32 v[212:213], v[212:213], v[8:9]
    v_pk_add_f32 v[222:223], v[222:223], v[28:29]
    v_pk_add_f32 v[214:215], v[214:215], v[112:113]
    v_pk_add_f32 v[224:225], v[224:225], v[136:137]
    v_pk_add_f32 v[212:213], v[212:213], v[10:11]
    v_pk_add_f32 v[222:223], v[222:223], v[30:31]
    v_pk_add_f32 v[214:215], v[214:215], v[114:115]
    v_pk_add_f32 v[224:225], v[224:225], v[138:139]
    v_pk_add_f32 v[212:213], v[212:213], v[12:13]
    v_pk_add_f32 v[222:223], v[222:223], v[32:33]
    v_pk_add_f32 v[214:215], v[214:215], v[116:117]
    v_pk_add_f32 v[224:225], v[224:225], v[140:141]
    v_pk_add_f32 v[212:213], v[212:213], v[14:15]
    v_pk_add_f32 v[222:223], v[222:223], v[34:35]
    v_pk_add_f32 v[214:215], v[214:215], v[118:119]
    v_pk_add_f32 v[224:225], v[224:225], v[142:143]
    v_pk_add_f32 v[212:213], v[212:213], v[16:17]
    v_pk_add_f32 v[222:223], v[222:223], v[36:37]
    v_pk_add_f32 v[214:215], v[214:215], v[120:121]
    v_pk_add_f32 v[224:225], v[224:225], v[144:145]
    v_pk_add_f32 v[212:213], v[212:213], v[18:19]
    v_pk_add_f32 v[222:223], v[222:223], v[38:39]
    v_pk_add_f32 v[214:215], v[214:215], v[122:123]
    v_pk_add_f32 v[224:225], v[224:225], v[146:147]
    v_add_f32 v212, v212, v213
    v_add_f32 v222, v222, v223
    v_add_f32 v214, v214, v215
    v_add_f32 v224, v224, v225
    v_rcp_f32 v212, v212
    v_rcp_f32 v222, v222
    v_rcp_f32 v214, v214
    v_rcp_f32 v224, v224
    v_pk_mul_f32 v[0:1], v[0:1], v[212:213] op_sel_hi:[1,0]
    v_pk_mul_f32 v[20:21], v[20:21], v[222:223] op_sel_hi:[1,0]
    v_pk_mul_f32 v[104:105], v[104:105], v[214:215] op_sel_hi:[1,0]
    v_pk_mul_f32 v[128:129], v[128:129], v[224:225] op_sel_hi:[1,0]
    v_pk_mul_f32 v[2:3], v[2:3], v[212:213] op_sel_hi:[1,0]
    v_pk_mul_f32 v[22:23], v[22:23], v[222:223] op_sel_hi:[1,0]
    v_pk_mul_f32 v[106:107], v[106:107], v[214:215] op_sel_hi:[1,0]
    v_pk_mul_f32 v[130:131], v[130:131], v[224:225] op_sel_hi:[1,0]
    v_pk_mul_f32 v[4:5], v[4:5], v[212:213] op_sel_hi:[1,0]
    v_pk_mul_f32 v[24:25], v[24:25], v[222:223] op_sel_hi:[1,0]
    v_pk_mul_f32 v[108:109], v[108:109], v[214:215] op_sel_hi:[1,0]
    v_pk_mul_f32 v[132:133], v[132:133], v[224:225] op_sel_hi:[1,0]
    v_pk_mul_f32 v[6:7], v[6:7], v[212:213] op_sel_hi:[1,0]
    v_pk_mul_f32 v[26:27], v[26:27], v[222:223] op_sel_hi:[1,0]
    v_pk_mul_f32 v[110:111], v[110:111], v[214:215] op_sel_hi:[1,0]
    v_pk_mul_f32 v[134:135], v[134:135], v[224:225] op_sel_hi:[1,0]
    v_pk_mul_f32 v[8:9], v[8:9], v[212:213] op_sel_hi:[1,0]
    v_pk_mul_f32 v[28:29], v[28:29], v[222:223] op_sel_hi:[1,0]
    v_pk_mul_f32 v[112:113], v[112:113], v[214:215] op_sel_hi:[1,0]
    v_pk_mul_f32 v[136:137], v[136:137], v[224:225] op_sel_hi:[1,0]
    v_pk_mul_f32 v[10:11], v[10:11], v[212:213] op_sel_hi:[1,0]
    v_pk_mul_f32 v[30:31], v[30:31], v[222:223] op_sel_hi:[1,0]
    v_pk_mul_f32 v[114:115], v[114:115], v[214:215] op_sel_hi:[1,0]
    v_pk_mul_f32 v[138:139], v[138:139], v[224:225] op_sel_hi:[1,0]
    v_pk_mul_f32 v[12:13], v[12:13], v[212:213] op_sel_hi:[1,0]
    v_pk_mul_f32 v[32:33], v[32:33], v[222:223] op_sel_hi:[1,0]
    v_pk_mul_f32 v[116:117], v[116:117], v[214:215] op_sel_hi:[1,0]
    v_pk_mul_f32 v[140:141], v[140:141], v[224:225] op_sel_hi:[1,0]
    v_pk_mul_f32 v[14:15], v[14:15], v[212:213] op_sel_hi:[1,0]
    v_pk_mul_f32 v[34:35], v[34:35], v[222:223] op_sel_hi:[1,0]
    v_pk_mul_f32 v[118:119], v[118:119], v[214:215] op_sel_hi:[1,0]
    v_pk_mul_f32 v[142:143], v[142:143], v[224:225] op_sel_hi:[1,0]
    v_pk_mul_f32 v[16:17], v[16:17], v[212:213] op_sel_hi:[1,0]
    v_pk_mul_f32 v[36:37], v[36:37], v[222:223] op_sel_hi:[1,0]
    v_pk_mul_f32 v[120:121], v[120:121], v[214:215] op_sel_hi:[1,0]
    v_pk_mul_f32 v[144:145], v[144:145], v[224:225] op_sel_hi:[1,0]
    v_pk_mul_f32 v[18:19], v[18:19], v[212:213] op_sel_hi:[1,0]
    v_pk_mul_f32 v[38:39], v[38:39], v[222:223] op_sel_hi:[1,0]
    v_pk_mul_f32 v[122:123], v[122:123], v[214:215] op_sel_hi:[1,0]
    v_pk_mul_f32 v[146:147], v[146:147], v[224:225] op_sel_hi:[1,0]
    v_cvt_pk_bf16_f32 v152, v0, v1
    v_cvt_pk_bf16_f32 v230, v20, v21
    v_cvt_pk_bf16_f32 v162, v104, v105
    v_cvt_pk_bf16_f32 v240, v128, v129
    v_cvt_pk_bf16_f32 v153, v2, v3
    v_cvt_pk_bf16_f32 v231, v22, v23
    v_cvt_pk_bf16_f32 v163, v106, v107
    v_cvt_pk_bf16_f32 v241, v130, v131
    v_cvt_pk_bf16_f32 v154, v4, v5
    v_cvt_pk_bf16_f32 v232, v24, v25
    v_cvt_pk_bf16_f32 v164, v108, v109
    v_cvt_pk_bf16_f32 v242, v132, v133
    v_cvt_pk_bf16_f32 v155, v6, v7
    v_cvt_pk_bf16_f32 v233, v26, v27
    v_cvt_pk_bf16_f32 v165, v110, v111
    v_cvt_pk_bf16_f32 v243, v134, v135
    v_cvt_pk_bf16_f32 v156, v8, v9
    v_cvt_pk_bf16_f32 v234, v28, v29
    v_cvt_pk_bf16_f32 v166, v112, v113
    v_cvt_pk_bf16_f32 v244, v136, v137
    v_cvt_pk_bf16_f32 v157, v10, v11
    v_cvt_pk_bf16_f32 v235, v30, v31
    v_cvt_pk_bf16_f32 v167, v114, v115
    v_cvt_pk_bf16_f32 v245, v138, v139
    v_cvt_pk_bf16_f32 v158, v12, v13
    v_cvt_pk_bf16_f32 v236, v32, v33
    v_cvt_pk_bf16_f32 v168, v116, v117
    v_cvt_pk_bf16_f32 v246, v140, v141
    v_cvt_pk_bf16_f32 v159, v14, v15
    v_cvt_pk_bf16_f32 v237, v34, v35
    v_cvt_pk_bf16_f32 v169, v118, v119
    v_cvt_pk_bf16_f32 v247, v142, v143
    v_cvt_pk_bf16_f32 v160, v16, v17
    v_cvt_pk_bf16_f32 v238, v36, v37
    v_cvt_pk_bf16_f32 v170, v120, v121
    v_cvt_pk_bf16_f32 v248, v144, v145
    v_cvt_pk_bf16_f32 v161, v18, v19
    v_cvt_pk_bf16_f32 v239, v38, v39
    v_cvt_pk_bf16_f32 v171, v122, v123
    v_cvt_pk_bf16_f32 v249, v146, v147
    v_mov_b32 v210, 152448
gated_mix__ssm_conv_s5__linear_kernel_hedgehog__prompt_kernel_spin91:
    ds_read_b32 v211, v210
    s_waitcnt lgkmcnt(0)
    v_readfirstlane_b32 s4, v211
    s_nop 3
    s_cmp_ge_u32 s4, 4
    s_cbranch_scc1 gated_mix__ssm_conv_s5__linear_kernel_hedgehog__prompt_kernel_spun92
    s_branch gated_mix__ssm_conv_s5__linear_kernel_hedgehog__prompt_kernel_spin91
gated_mix__ssm_conv_s5__linear_kernel_hedgehog__prompt_kernel_spun92:
    v_lshrrev_b32 v208, 2, v195
    v_lshlrev_b32 v208, 3, v208
    v_and_b32 v209, 1, v195
    v_lshl_add_u32 v208, v209, 2, v208
    v_bfe_u32 v209, v195, 1, 1
    v_add_u32 v208, v208, v209
    s_lshl_b32 s4, s3, 5
    v_add_u32 v208, s4, v208
    v_mul_u32_u24 v208, 144, v208
    v_mul_u32_u24 v209, 18432, v196
    v_add_u32 v208, v208, v209
    ds_write_b128 v208, v[152:155] offset:0
    ds_write_b128 v208, v[156:159] offset:16
    ds_write_b128 v208, v[160:163] offset:32
    ds_write_b128 v208, v[164:167] offset:48
    ds_write_b128 v208, v[168:171] offset:64
    ds_write_b128 v208, v[230:233] offset:288
    ds_write_b128 v208, v[234:237] offset:304
    ds_write_b128 v208, v[238:241] offset:320
    ds_write_b128 v208, v[242:245] offset:336
    ds_write_b128 v208, v[246:249] offset:352
    v_cvt_pk_bf16_f32 v104, v40, v41
    v_cvt_pk_bf16_f32 v105, v42, v43
    v_cvt_pk_bf16_f32 v106, v48, v49
    v_cvt_pk_bf16_f32 v107, v50, v51
    v_cvt_pk_bf16_f32 v108, v56, v57
    v_cvt_pk_bf16_f32 v109, v58, v59
    v_cvt_pk_bf16_f32 v110, v64, v65
    v_cvt_pk_bf16_f32 v111, v66, v67
    v_cvt_pk_bf16_f32 v112, v72, v73
    v_cvt_pk_bf16_f32 v113, v74, v75
    v_mov_b32 v114, 0x3f80
    v_mov_b32 v115, 0
    ds_write_b128 v208, v[104:107] offset:80
    ds_write_b128 v208, v[108:111] offset:96
    ds_write_b128 v208, v[112:115] offset:112
    v_cvt_pk_bf16_f32 v116, v44, v45
    v_cvt_pk_bf16_f32 v117, v46, v47
    v_cvt_pk_bf16_f32 v118, v52, v53
    v_cvt_pk_bf16_f32 v119, v54, v55
    v_cvt_pk_bf16_f32 v120, v60, v61
    v_cvt_pk_bf16_f32 v121, v62, v63
    v_cvt_pk_bf16_f32 v122, v68, v69
    v_cvt_pk_bf16_f32 v123, v70, v71
    v_cvt_pk_bf16_f32 v124, v76, v77
    v_cvt_pk_bf16_f32 v125, v78, v79
    v_mov_b32 v126, 0x3f80
    v_mov_b32 v127, 0
    ds_write_b128 v208, v[116:119] offset:368
    ds_write_b128 v208, v[120:123] offset:384
    ds_write_b128 v208, v[124:127] offset:400
    s_waitcnt lgkmcnt(0)
    v_mov_b32 v206, 152452
    v_mov_b32 v207, 1
    s_mov_b64 s[60:61], exec
    s_mov_b64 exec, 1
    ds_add_u32 v206, v207
    s_mov_b64 exec, s[60:61]
gated_mix__ssm_conv_s5__linear_kernel_hedgehog__prompt_kernel_spin93:
    ds_read_b32 v207, v206
    s_waitcnt lgkmcnt(0)
    v_readfirstlane_b32 s4, v207
    s_nop 3
    s_cmp_ge_u32 s4, 4
    s_cbranch_scc1 gated_mix__ssm_conv_s5__linear_kernel_hedgehog__prompt_kernel_spun94
    s_sleep 1
    s_branch gated_mix__ssm_conv_s5__linear_kernel_hedgehog__prompt_kernel_spin93
gated_mix__ssm_conv_s5__linear_kernel_hedgehog__prompt_kernel_spun94:
    v_lshrrev_b32 v208, 2, v195
    v_lshl_add_u32 v208, v196, 3, v208
    v_mul_u32_u24 v208, 144, v208
    v_and_b32 v209, 3, v195
    v_lshl_add_u32 v208, v209, 3, v208
    s_mul_i32 s4, s3, 18432
    v_add_u32 v208, s4, v208
    ds_read_b64_tr_b16 v[128:129], v208 offset:0
    ds_read_b64_tr_b16 v[130:131], v208 offset:576
    ds_read_b64_tr_b16 v[132:133], v208 offset:32
    ds_read_b64_tr_b16 v[134:135], v208 offset:608
    ds_read_b64_tr_b16 v[136:137], v208 offset:64
    ds_read_b64_tr_b16 v[138:139], v208 offset:640
    ds_read_b64_tr_b16 v[140:141], v208 offset:80
    ds_read_b64_tr_b16 v[142:143], v208 offset:656
    ds_read_b64_tr_b16 v[144:145], v208 offset:112
    ds_read_b64_tr_b16 v[146:147], v208 offset:688
    ds_read_b64_tr_b16 v[148:149], v208 offset:4608
    ds_read_b64_tr_b16 v[150:151], v208 offset:5184
    ds_read_b64_tr_b16 v[152:153], v208 offset:4640
    ds_read_b64_tr_b16 v[154:155], v208 offset:5216
    ds_read_b64_tr_b16 v[156:157], v208 offset:4672
    ds_read_b64_tr_b16 v[158:159], v208 offset:5248
    ds_read_b64_tr_b16 v[160:161], v208 offset:4688
    ds_read_b64_tr_b16 v[162:163], v208 offset:5264
    ds_read_b64_tr_b16 v[164:165], v208 offset:4720
    ds_read_b64_tr_b16 v[166:167], v208 offset:5296
    s_waitcnt lgkmcnt(10)
    v_mfma_f32_16x16x32_bf16 v[104:107], v[128:131], v[140:143], 0
    v_mfma_f32_16x16x32_bf16 v[108:111], v[128:131], v[144:147], 0
    v_mfma_f32_16x16x32_bf16 v[112:115], v[132:135], v[140:143], 0
    v_mfma_f32_16x16x32_bf16 v[116:119], v[132:135], v[144:147], 0
    v_mfma_f32_16x16x32_bf16 v[120:123], v[136:139], v[140:143], 0
    v_mfma_f32_16x16x32_bf16 v[124:127], v[136:139], v[144:147], 0
    ds_read_b64_tr_b16 v[128:129], v208 offset:9216
    ds_read_b64_tr_b16 v[130:131], v208 offset:9792
    ds_read_b64_tr_b16 v[132:133], v208 offset:9248
    ds_read_b64_tr_b16 v[134:135], v208 offset:9824
    ds_read_b64_tr_b16 v[136:137], v208 offset:9280
    ds_read_b64_tr_b16 v[138:139], v208 offset:9856
    ds_read_b64_tr_b16 v[140:141], v208 offset:9296
    ds_read_b64_tr_b16 v[142:143], v208 offset:9872
    ds_read_b64_tr_b16 v[144:145], v208 offset:9328
    ds_read_b64_tr_b16 v[146:147], v208 offset:9904
    s_waitcnt lgkmcnt(10)
    v_mfma_f32_16x16x32_bf16 v[104:107], v[148:151], v[160:163], v[104:107]
    v_mfma_f32_16x16x32_bf16 v[108:111], v[148:151], v[164:167], v[108:111]
    v_mfma_f32_16x16x32_bf16 v[112:115], v[152:155], v[160:163], v[112:115]
    v_mfma_f32_16x16x32_bf16 v[116:119], v[152:155], v[164:167], v[116:119]
    v_mfma_f32_16x16x32_bf16 v[120:123], v[156:159], v[160:163], v[120:123]
    v_mfma_f32_16x16x32_bf16 v[124:127], v[156:159], v[164:167], v[124:127]
    ds_read_b64_tr_b16 v[148:149], v208 offset:13824
    ds_read_b64_tr_b16 v[150:151], v208 offset:14400
    ds_read_b64_tr_b16 v[152:153], v208 offset:13856
    ds_read_b64_tr_b16 v[154:155], v208 offset:14432
    ds_read_b64_tr_b16 v[156:157], v208 offset:13888
    ds_read_b64_tr_b16 v[158:159], v208 offset:14464
    ds_read_b64_tr_b16 v[160:161], v208 offset:13904
    ds_read_b64_tr_b16 v[162:163], v208 offset:14480
    ds_read_b64_tr_b16 v[164:165], v208 offset:13936
    ds_read_b64_tr_b16 v[166:167], v208 offset:14512
    s_waitcnt lgkmcnt(10)
    v_mfma_f32_16x16x32_bf16 v[104:107], v[128:131], v[140:143], v[104:107]
    v_mfma_f32_16x16x32_bf16 v[108:111], v[128:131], v[144:147], v[108:111]
    v_mfma_f32_16x16x32_bf16 v[112:115], v[132:135], v[140:143], v[112:115]
    v_mfma_f32_16x16x32_bf16 v[116:119], v[132:135], v[144:147], v[116:119]
    v_mfma_f32_16x16x32_bf16 v[120:123], v[136:139], v[140:143], v[120:123]
    v_mfma_f32_16x16x32_bf16 v[124:127], v[136:139], v[144:147], v[124:127]
    s_waitcnt lgkmcnt(0)
    v_mfma_f32_16x16x32_bf16 v[104:107], v[148:151], v[160:163], v[104:107]
    v_mfma_f32_16x16x32_bf16 v[108:111], v[148:151], v[164:167], v[108:111]
    v_mfma_f32_16x16x32_bf16 v[112:115], v[152:155], v[160:163], v[112:115]
    v_mfma_f32_16x16x32_bf16 v[116:119], v[152:155], v[164:167], v[116:119]
    v_mfma_f32_16x16x32_bf16 v[120:123], v[156:159], v[160:163], v[120:123]
    v_mfma_f32_16x16x32_bf16 v[124:127], v[156:159], v[164:167], v[124:127]
    v_mov_b32 v254, 152496
    s_mov_b32 s5, 0
gated_mix__ssm_conv_s5__linear_kernel_hedgehog__prompt_kernel_spin95:
    ds_read_b32 v255, v254
    s_waitcnt lgkmcnt(0)
    v_readfirstlane_b32 s4, v255
    s_nop 3
    s_cmp_ge_u32 s4, 1
    s_cbranch_scc1 gated_mix__ssm_conv_s5__linear_kernel_hedgehog__prompt_kernel_spun96
    s_add_u32 s5, s5, 1
    s_cmp_ge_u32 s5, 8000000
    s_cbranch_scc1 gated_mix__ssm_conv_s5__linear_kernel_hedgehog__prompt_kernel_spun96
    s_sleep 1
    s_branch gated_mix__ssm_conv_s5__linear_kernel_hedgehog__prompt_kernel_spin95
gated_mix__ssm_conv_s5__linear_kernel_hedgehog__prompt_kernel_spun96:
    ds_read_b64 v[250:251], v254
    s_waitcnt lgkmcnt(0)
    v_mov_b32 v252, v250
    v_mov_b32 v253, v251
    s_lshl_b32 s4, s3, 12
    s_add_u32 s4, s4, 83968
    v_mul_u32_u24 v210, 160, v195
    v_lshl_add_u32 v210, v196, 4, v210
    v_add_u32 v210, s4, v210
    s_add_u32 s5, s4, 3584
    v_mov_b32 v214, s5
    v_add_u32 v211, 2560, v210
    v_add_u32 v212, 128, v210
    v_add_u32 v213, 2688, v210
    v_cmp_gt_u32 vcc, 5, v195
    s_nop 1
    v_cndmask_b32 v211, v214, v211, vcc
    v_cndmask_b32 v213, v214, v213, vcc
    v_cmp_gt_u32 vcc, 2, v196
    s_nop 1
    v_cndmask_b32 v212, v214, v212, vcc
    v_cndmask_b32 v213, v214, v213, vcc
    v_mov_b32 v218, v250
    v_mov_b32 v219, v251
    v_mov_b32 v222, v250
    v_mov_b32 v223, v251
    v_cvt_pk_bf16_f32 v216, v104, v105
    v_cvt_pk_bf16_f32 v217, v106, v107
    ds_write_b128 v210, v[216:219] offset:0
    v_cvt_pk_bf16_f32 v220, v108, v109
    v_cvt_pk_bf16_f32 v221, v110, v111
    ds_write_b128 v211, v[220:223] offset:0
    v_cvt_pk_bf16_f32 v216, v112, v113
    v_cvt_pk_bf16_f32 v217, v114, v115
    ds_write_b128 v210, v[216:219] offset:64
    v_cvt_pk_bf16_f32 v220, v116, v117
    v_cvt_pk_bf16_f32 v221, v118, v119
    ds_write_b128 v211, v[220:223] offset:64
    v_cvt_pk_bf16_f32 v216, v120, v121
    v_cvt_pk_bf16_f32 v217, v122, v123
    ds_write_b128 v212, v[216:219]
    v_cvt_pk_bf16_f32 v220, v124, v125
    v_cvt_pk_bf16_f32 v221, v126, v127
    ds_write_b128 v213, v[220:223]
    v_lshlrev_b32 v210, 4, v194
    v_add_u32 v211, s4, v210
    s_waitcnt lgkmcnt(0)
    ds_read_b128 v[104:107], v211 offset:0
    ds_read_b128 v[108:111], v211 offset:1024
    ds_read_b128 v[112:115], v211 offset:2048
    ds_read_b128 v[116:119], v211 offset:3072
    s_lshl_b32 s4, s27, 2
    s_add_u32 s4, s4, s3
    s_lshl_b32 s4, s4, 4
    s_add_u32 s4, s4, s26
    s_lshl_b32 s4, s4, 12
    s_add_u32 s4, s4, 18874368
    s_waitcnt lgkmcnt(0)
    buffer_store_dwordx4 v[104:107], v210, s[40:43], s4 offen offset:0 sc1
    buffer_store_dwordx4 v[108:111], v210, s[40:43], s4 offen offset:1024 sc1
    buffer_store_dwordx4 v[112:115], v210, s[40:43], s4 offen offset:2048 sc1
    buffer_store_dwordx4 v[116:119], v210, s[40:43], s4 offen offset:3072 sc1
    s_lshl_b32 s4, s3, 2
    v_add_u32 v206, s4, v196
    v_lshlrev_b32 v206, 9, v206
    v_lshl_add_u32 v206, v195, 3, v206
    v_add_u32 v206, 144256, v206
    v_lshlrev_b32 v210, 3, v195
    v_add_u32 v210, 153088, v210
    s_mul_i32 s4, s3, 2560
    s_add_u32 s4, s4, 73728
    v_mul_u32_u24 v207, 80, v195
    v_lshl_add_u32 v207, v196, 4, v207
    v_add_u32 v207, s4, v207
    v_lshrrev_b32 v208, 2, v195
    v_lshl_add_u32 v208, v196, 3, v208
    v_mul_u32_u24 v208, 80, v208
    v_and_b32 v209, 3, v195
    v_lshl_add_u32 v208, v209, 4, v208
    v_add_u32 v208, s4, v208
    v_lshlrev_b32 v209, 4, v194
    s_lshl_b32 s4, s26, 3
    s_lshl_b32 s5, s3, 1
    s_add_u32 s4, s4, s5
    s_mul_i32 s4, s4, 40960
    s_mul_i32 s5, s27, 5
    s_add_u32 s5, s5, 0
    s_lshl_b32 s5, s5, 10
    s_add_u32 s4, s4, s5
    s_add_u32 s6, s4, 0
    v_mov_b32 v212, 152456
gated_mix__ssm_conv_s5__linear_kernel_hedgehog__prompt_kernel_spin97:
    ds_read_b32 v213, v212
    s_waitcnt lgkmcnt(0)
    v_readfirstlane_b32 s4, v213
    s_nop 3
    s_cmp_ge_u32 s4, 1
    s_cbranch_scc1 gated_mix__ssm_conv_s5__linear_kernel_hedgehog__prompt_kernel_spun98
    s_sleep 1
    s_branch gated_mix__ssm_conv_s5__linear_kernel_hedgehog__prompt_kernel_spin97
gated_mix__ssm_conv_s5__linear_kernel_hedgehog__prompt_kernel_spun98:
    ds_read_b64 v[104:105], v206 offset:0
    ds_read_b64 v[106:107], v206 offset:9344
    ds_read_b64 v[108:109], v210 offset:0
    s_waitcnt lgkmcnt(0)
    v_pk_fma_f32 v[110:111], v[106:107], v[108:109], v[104:105] op_sel_hi:[0,1,1]
    v_pk_fma_f32 v[110:111], v[106:107], v[108:109], v[110:111] op_sel:[1,1,0] op_sel_hi:[1,0,1] neg_lo:[1,0,0]
    v_mov_b32 v112, v110
    v_mov_b32 v114, v111
    v_fma_f32 v113, v180, v110, v198
    v_fma_f32 v115, v180, v111, v199
    v_fma_f32 v113, -v181, v111, v113
    v_fma_f32 v115, v181, v110, v115
    v_pk_fma_f32 v[116:117], v[178:179], v[112:113], v[80:81] op_sel_hi:[0,1,1]
    v_pk_fma_f32 v[118:119], v[178:179], v[114:115], v[88:89] op_sel_hi:[0,1,1]
    v_pk_fma_f32 v[80:81], v[178:179], v[114:115], v[116:117] op_sel:[1,0,0] op_sel_hi:[1,1,1] neg_lo:[1,0,0] neg_hi:[1,0,0]
    v_pk_fma_f32 v[88:89], v[178:179], v[112:113], v[118:119] op_sel:[1,0,0] op_sel_hi:[1,1,1]
    v_pk_fma_f32 v[116:117], v[178:179], v[80:81], v[82:83] op_sel_hi:[0,1,1]
    v_pk_fma_f32 v[118:119], v[178:179], v[88:89], v[90:91] op_sel_hi:[0,1,1]
    v_pk_fma_f32 v[82:83], v[178:179], v[88:89], v[116:117] op_sel:[1,0,0] op_sel_hi:[1,1,1] neg_lo:[1,0,0] neg_hi:[1,0,0]
    v_pk_fma_f32 v[90:91], v[178:179], v[80:81], v[118:119] op_sel:[1,0,0] op_sel_hi:[1,1,1]
    v_pk_fma_f32 v[116:117], v[178:179], v[82:83], v[84:85] op_sel_hi:[0,1,1]
    v_pk_fma_f32 v[118:119], v[178:179], v[90:91], v[92:93] op_sel_hi:[0,1,1]
    v_pk_fma_f32 v[84:85], v[178:179], v[90:91], v[116:117] op_sel:[1,0,0] op_sel_hi:[1,1,1] neg_lo:[1,0,0] neg_hi:[1,0,0]
    v_pk_fma_f32 v[92:93], v[178:179], v[82:83], v[118:119] op_sel:[1,0,0] op_sel_hi:[1,1,1]
    v_pk_fma_f32 v[116:117], v[178:179], v[84:85], v[86:87] op_sel_hi:[0,1,1]
    v_pk_fma_f32 v[118:119], v[178:179], v[92:93], v[94:95] op_sel_hi:[0,1,1]
    v_pk_fma_f32 v[86:87], v[178:179], v[92:93], v[116:117] op_sel:[1,0,0] op_sel_hi:[1,1,1] neg_lo:[1,0,0] neg_hi:[1,0,0]
    v_pk_fma_f32 v[94:95], v[178:179], v[84:85], v[118:119] op_sel:[1,0,0] op_sel_hi:[1,1,1]
    v_cvt_pk_bf16_f32 v104, v80, v81
    v_cvt_pk_bf16_f32 v105, v82, v83
    v_cvt_pk_bf16_f32 v106, v84, v85
    v_cvt_pk_bf16_f32 v107, v86, v87
    ds_write_b128 v207, v[104:107] offset:0
    v_cvt_pk_bf16_f32 v108, v88, v89
    v_cvt_pk_bf16_f32 v109, v90, v91
    v_cvt_pk_bf16_f32 v110, v92, v93
    v_cvt_pk_bf16_f32 v111, v94, v95
    ds_write_b128 v207, v[108:111] offset:1280
    s_waitcnt lgkmcnt(0)
    ds_read_b64_tr_b16 v[112:113], v208 offset:0
    ds_read_b64_tr_b16 v[114:115], v208 offset:320
    ds_read_b64_tr_b16 v[116:117], v208 offset:8
    ds_read_b64_tr_b16 v[118:119], v208 offset:328
    s_add_u32 s5, s6, 0
    s_waitcnt lgkmcnt(2)
    buffer_store_dwordx4 v[112:115], v209, s[40:43], s5 offen sc1
    s_add_u32 s5, s6, 40960
    s_waitcnt lgkmcnt(0)
    buffer_store_dwordx4 v[116:119], v209, s[40:43], s5 offen sc1
    s_lshl_b32 s52, s26, 4
    s_add_u32 s52, s52, s28
    s_lshl_b32 s52, s52, 7
    s_add_u32 s52, s52, 18186240
    s_waitcnt vmcnt(0)
    v_mov_b32 v244, 152464
    v_mov_b32 v245, 1
    s_mov_b64 s[60:61], exec
    s_mov_b64 exec, 1
    ds_add_rtn_u32 v246, v244, v245
    s_waitcnt lgkmcnt(0)
    s_mov_b64 exec, s[60:61]
    v_readfirstlane_b32 s4, v246
    s_nop 3
    s_cmp_lg_u32 s4, 6
    s_cbranch_scc1 gated_mix__ssm_conv_s5__linear_kernel_hedgehog__prompt_kernel_nf199
    v_lshlrev_b32 v244, 4, v194
    s_mov_b64 s[60:61], exec
    s_mov_b64 exec, 0xff
    buffer_store_dwordx4 v[250:253], v244, s[40:43], s52 offen sc1
    s_mov_b64 exec, s[60:61]
gated_mix__ssm_conv_s5__linear_kernel_hedgehog__prompt_kernel_nf199:
    s_branch gated_mix__ssm_conv_s5__linear_kernel_hedgehog__prompt_kernel_ojob
gated_mix__ssm_conv_s5__linear_kernel_hedgehog__prompt_kernel_cpB:
    s_load_dwordx2 s[4:5], s[0:1], 8
    s_load_dwordx2 s[6:7], s[0:1], 16
    s_load_dwordx2 s[32:33], s[0:1], 56
    s_load_dwordx2 s[34:35], s[0:1], 88
    s_load_dwordx2 s[36:37], s[0:1], 128
    v_mov_b32 v197, v0
    v_and_b32 v194, 63, v0
    v_and_b32 v195, 15, v0
    v_bfe_u32 v196, v0, 4, 2
    s_waitcnt lgkmcnt(0)
    s_mov_b32 s8, s4
    s_and_b32 s9, s5, 0xffff
    s_mov_b32 s10, 1280
    s_mov_b32 s11, 0x20000
    s_mov_b32 s12, s6
    s_and_b32 s13, s7, 0xffff
    s_mov_b32 s14, 1280
    s_mov_b32 s15, 0x20000
    s_mov_b32 s16, s32
    s_and_b32 s17, s33, 0xffff
    s_mov_b32 s18, 1280
    s_mov_b32 s19, 0x20000
    s_mov_b32 s20, s34
    s_and_b32 s21, s35, 0xffff
    s_mov_b32 s22, 25600
    s_mov_b32 s23, 0x20000
    s_mov_b32 s40, s36
    s_and_b32 s41, s37, 0xffff
    s_mov_b32 s42, 20971520
    s_mov_b32 s43, 0x20000
    v_lshlrev_b32 v206, 4, v197
    s_mul_i32 s4, s27, 3200
    v_cmp_gt_u32 vcc, 200, v197
    v_mov_b32 v207, 0x7fffffff
    s_nop 0
    v_cndmask_b32 v207, v207, v206, vcc
    buffer_load_dwordx4 v[210:213], v207, s[20:23], s4 offen
    v_and_b32 v226, 63, v194
    s_mul_i32 s4, s27, 160
    s_add_u32 s4, s4, 32
    v_lshl_add_u32 v208, v226, 1, s4
    buffer_load_ushort v214, v208, s[8:11], 0 offen
    buffer_load_ushort v215, v208, s[12:15], 0 offen
    buffer_load_ushort v216, v208, s[16:19], 0 offen
    v_mov_b32 v0, 0
    v_mov_b32 v1, 0
    v_mov_b32 v2, 0
    v_mov_b32 v3, 0
    v_mov_b32 v4, 0
    v_mov_b32 v5, 0
    v_mov_b32 v6, 0
    v_mov_b32 v7, 0
    v_mov_b32 v8, 0
    v_mov_b32 v9, 0
    v_mov_b32 v10, 0
    v_mov_b32 v11, 0
    v_mov_b32 v12, 0
    v_mov_b32 v13, 0
    v_mov_b32 v14, 0
    v_mov_b32 v15, 0
    v_mov_b32 v16, 0
    v_mov_b32 v17, 0
    v_mov_b32 v18, 0
    v_mov_b32 v19, 0
    v_mov_b32 v20, 0
    v_mov_b32 v21, 0
    v_mov_b32 v22, 0
    v_mov_b32 v23, 0
    v_mov_b32 v24, 0
    v_mov_b32 v25, 0
    v_mov_b32 v26, 0
    v_mov_b32 v27, 0
    v_mov_b32 v28, 0
    v_mov_b32 v29, 0
    v_mov_b32 v30, 0
    v_mov_b32 v31, 0
    v_mov_b32 v32, 0
    v_mov_b32 v33, 0
    v_mov_b32 v34, 0
    v_mov_b32 v35, 0
    v_mov_b32 v36, 0
    v_mov_b32 v37, 0
    v_mov_b32 v38, 0
    v_mov_b32 v39, 0
    v_mov_b32 v40, 0
    v_mov_b32 v41, 0
    v_mov_b32 v42, 0
    v_mov_b32 v43, 0
    v_mov_b32 v44, 0
    v_mov_b32 v45, 0
    v_mov_b32 v46, 0
    v_mov_b32 v47, 0
    v_mov_b32 v48, 0
    v_mov_b32 v49, 0
    v_mov_b32 v50, 0
    v_mov_b32 v51, 0
    v_mov_b32 v52, 0
    v_mov_b32 v53, 0
    v_mov_b32 v54, 0
    v_mov_b32 v55, 0
    v_mov_b32 v56, 0
    v_mov_b32 v57, 0
    v_mov_b32 v58, 0
    v_mov_b32 v59, 0
    v_mov_b32 v60, 0
    v_mov_b32 v61, 0
    v_mov_b32 v62, 0
    v_mov_b32 v63, 0
    v_mov_b32 v64, 0
    v_mov_b32 v65, 0
    v_mov_b32 v66, 0
    v_mov_b32 v67, 0
    v_mov_b32 v68, 0
    v_mov_b32 v69, 0
    v_mov_b32 v70, 0
    v_mov_b32 v71, 0
    v_mov_b32 v72, 0
    v_mov_b32 v73, 0
    v_mov_b32 v74, 0
    v_mov_b32 v75, 0
    v_mov_b32 v76, 0
    v_mov_b32 v77, 0
    v_mov_b32 v78, 0
    v_mov_b32 v79, 0
    v_mov_b32 v80, 0
    v_mov_b32 v81, 0
    v_mov_b32 v82, 0
    v_mov_b32 v83, 0
    v_mov_b32 v84, 0
    v_mov_b32 v85, 0
    v_mov_b32 v86, 0
    v_mov_b32 v87, 0
    v_mov_b32 v88, 0
    v_mov_b32 v89, 0
    v_mov_b32 v90, 0
    v_mov_b32 v91, 0
    v_mov_b32 v92, 0
    v_mov_b32 v93, 0
    v_mov_b32 v94, 0
    v_mov_b32 v95, 0
    v_mov_b32 v96, 0
    v_mov_b32 v97, 0
    v_mov_b32 v98, 0
    v_mov_b32 v99, 0
    v_mov_b32 v100, 0
    v_mov_b32 v101, 0
    v_mov_b32 v102, 0
    v_mov_b32 v103, 0
    v_lshrrev_b32 v208, 1, v195
    v_xor_b32 v208, v208, v196
    v_lshlrev_b32 v209, 7, v195
    v_lshl_add_u32 v174, v208, 4, v209
    v_xor_b32 v208, 4, v208
    v_lshl_add_u32 v175, v208, 4, v209
    s_lshl_b32 s4, s3, 12
    v_add_u32 v172, s4, v174
    v_add_u32 v173, s4, v175
    v_lshrrev_b32 v208, 2, v195
    v_lshl_add_u32 v208, v196, 3, v208
    v_mul_u32_u24 v208, 160, v208
    v_lshl_add_u32 v208, v196, 7, v208
    v_and_b32 v209, 3, v195
    v_mul_u32_u24 v209, 40, v209
    v_add_u32 v176, v208, v209
    v_mov_b32 v230, 0
    v_mov_b32 v231, 0
    v_mov_b32 v232, 0
    v_mov_b32 v233, 0
    v_lshlrev_b32 v208, 4, v197
    v_add_u32 v208, 135296, v208
    v_and_b32 v209, 3, v197
    v_lshlrev_b32 v209, 4, v209
    v_add_u32 v209, 152448, v209
    v_cmp_gt_u32 vcc, 48, v197
    s_nop 1
    v_cndmask_b32 v208, v209, v208, vcc
    ds_write_b128 v208, v[230:233]
    s_waitcnt vmcnt(0)
    v_add_u32 v206, 132096, v206
    v_mov_b32 v207, 152512
    v_cmp_gt_u32 vcc, 200, v197
    s_nop 1
    v_cndmask_b32 v206, v207, v206, vcc
    ds_write_b128 v206, v[210:213]
    v_lshlrev_b32 v214, 16, v214
    v_lshlrev_b32 v215, 16, v215
    v_lshlrev_b32 v216, 16, v216
    v_mul_f32 v208, 0x3fb8aa3b, v216
    v_exp_f32 v208, v208
    s_nop 0
    v_cvt_pk_bf16_f32 v208, v208, v208
    v_lshlrev_b32 v208, 16, v208
    v_mul_f32 v209, v208, v215
    v_mul_f32 v208, v208, v214
    v_mul_f32 v208, 0x3fb8aa3b, v208
    v_exp_f32 v208, v208
    v_mul_f32 v209, 0x3e22f983, v209
    v_rndne_f32 v218, v209
    v_sub_f32 v209, v209, v218
    v_cos_f32 v218, v209
    v_sin_f32 v219, v209
    v_mul_f32 v218, v218, v208
    v_mul_f32 v219, v219, v208
    v_mov_b32 v220, v218
    v_mov_b32 v221, v219
    v_mul_f32 v208, v221, v221
    v_mul_f32 v221, v220, v221
    v_fma_f32 v220, v220, v220, -v208
    v_add_f32 v221, v221, v221
    v_mul_f32 v208, v221, v221
    v_mul_f32 v221, v220, v221
    v_fma_f32 v220, v220, v220, -v208
    v_add_f32 v221, v221, v221
    v_mov_b32 v222, v220
    v_mov_b32 v223, v221
    v_mul_f32 v208, v223, v223
    v_mul_f32 v223, v222, v223
    v_fma_f32 v222, v222, v222, -v208
    v_add_f32 v223, v223, v223
    v_lshlrev_b32 v208, 3, v226
    v_add_u32 v208, 161792, v208
    ds_write_b64 v208, v[222:223]
    v_lshlrev_b32 v209, 4, v226
    v_add_u32 v209, 162304, v209
    ds_write_b128 v209, v[218:221]
    v_lshlrev_b32 v209, 4, v195
    v_add_u32 v209, 162304, v209
    s_waitcnt lgkmcnt(0)
    ds_read_b128 v[178:181], v209 offset:0
    ds_read_b128 v[182:185], v209 offset:256
    ds_read_b128 v[186:189], v209 offset:512
    ds_read_b128 v[190:193], v209 offset:768
    s_waitcnt lgkmcnt(0)
    s_barrier
    ds_read_b128 v[156:159], v172 offset:0
    ds_read_b128 v[160:163], v172 offset:2048
    ds_read_b64_tr_b16 v[104:105], v176 offset:16384
    ds_read_b64_tr_b16 v[106:107], v176 offset:17024
    ds_read_b64_tr_b16 v[108:109], v176 offset:16392
    ds_read_b64_tr_b16 v[110:111], v176 offset:17032
    ds_read_b64_tr_b16 v[112:113], v176 offset:16400
    ds_read_b64_tr_b16 v[114:115], v176 offset:17040
    ds_read_b64_tr_b16 v[116:117], v176 offset:16408
    ds_read_b64_tr_b16 v[118:119], v176 offset:17048
    ds_read_b64_tr_b16 v[120:121], v176 offset:16416
    ds_read_b64_tr_b16 v[122:123], v176 offset:17056
    ds_read_b128 v[124:127], v174 offset:27648
    ds_read_b128 v[128:131], v174 offset:29696
    ds_read_b128 v[132:135], v174 offset:31744
    ds_read_b128 v[136:139], v174 offset:33792
    ds_read_b128 v[140:143], v174 offset:35840
    ds_read_b128 v[144:147], v174 offset:37888
    ds_read_b128 v[148:151], v174 offset:39936
    ds_read_b128 v[152:155], v174 offset:41984
    s_mov_b32 s59, 0
    s_mov_b32 s58, 0
gated_mix__ssm_conv_s5__linear_kernel_hedgehog__prompt_kernel_main100:
    s_waitcnt lgkmcnt(15)
    v_mfma_f32_16x16x32_bf16 v[0:3], v[104:107], v[156:159], v[0:3]
    ds_read_b128 v[164:167], v173 offset:0
    ds_read_b128 v[168:171], v173 offset:2048
    v_mfma_f32_16x16x32_bf16 v[4:7], v[104:107], v[160:163], v[4:7]
    s_add_u32 s63, s58, 44032
    s_cmp_ge_u32 s63, 132096
    s_waitcnt lgkmcnt(15)
    v_mfma_f32_16x16x32_bf16 v[8:11], v[108:111], v[156:159], v[8:11]
    s_cselect_b32 s63, 0, s63
    s_sub_u32 s62, s63, s58
    v_mfma_f32_16x16x32_bf16 v[12:15], v[108:111], v[160:163], v[12:15]
    s_mov_b32 s58, s63
    ds_read_b64_tr_b16 v[104:105], v176 offset:22016
    s_waitcnt lgkmcnt(15)
    v_mfma_f32_16x16x32_bf16 v[16:19], v[112:115], v[156:159], v[16:19]
    ds_read_b64_tr_b16 v[106:107], v176 offset:22656
    v_mfma_f32_16x16x32_bf16 v[20:23], v[112:115], v[160:163], v[20:23]
    ds_read_b64_tr_b16 v[108:109], v176 offset:22024
    ds_read_b64_tr_b16 v[110:111], v176 offset:22664
    s_waitcnt lgkmcnt(15)
    v_mfma_f32_16x16x32_bf16 v[24:27], v[116:119], v[156:159], v[24:27]
    ds_read_b64_tr_b16 v[112:113], v176 offset:22032
    v_mfma_f32_16x16x32_bf16 v[28:31], v[116:119], v[160:163], v[28:31]
    ds_read_b64_tr_b16 v[114:115], v176 offset:22672
    s_waitcnt lgkmcnt(15)
    v_mfma_f32_16x16x32_bf16 v[32:35], v[120:123], v[156:159], v[32:35]
    ds_read_b64_tr_b16 v[116:117], v176 offset:22040
    v_mfma_f32_16x16x32_bf16 v[36:39], v[120:123], v[160:163], v[36:39]
    ds_read_b64_tr_b16 v[118:119], v176 offset:22680
    v_mfma_f32_16x16x32_bf16 v[40:43], v[156:159], v[124:127], v[40:43]
    ds_read_b64_tr_b16 v[120:121], v176 offset:22048
    v_mfma_f32_16x16x32_bf16 v[44:47], v[160:163], v[124:127], v[44:47]
    ds_read_b64_tr_b16 v[122:123], v176 offset:22688
    s_waitcnt lgkmcnt(15)
    v_mfma_f32_16x16x32_bf16 v[48:51], v[156:159], v[128:131], v[48:51]
    ds_read_b128 v[124:127], v175 offset:27648
    v_mfma_f32_16x16x32_bf16 v[52:55], v[160:163], v[128:131], v[52:55]
    ds_read_b128 v[128:131], v175 offset:29696
    v_mfma_f32_16x16x32_bf16 v[56:59], v[156:159], v[132:135], v[56:59]
    v_mfma_f32_16x16x32_bf16 v[60:63], v[160:163], v[132:135], v[60:63]
    ds_read_b128 v[132:135], v175 offset:31744
    v_mfma_f32_16x16x32_bf16 v[64:67], v[156:159], v[136:139], v[64:67]
    v_mfma_f32_16x16x32_bf16 v[68:71], v[160:163], v[136:139], v[68:71]
    ds_read_b128 v[136:139], v175 offset:33792
    v_mfma_f32_16x16x32_bf16 v[72:75], v[156:159], v[140:143], v[72:75]
    v_mfma_f32_16x16x32_bf16 v[76:79], v[160:163], v[140:143], v[76:79]
    ds_read_b128 v[140:143], v175 offset:35840
    s_waitcnt lgkmcnt(15)
    v_mfma_f32_16x16x32_bf16 v[80:83], v[156:159], v[144:147], v[80:83]
    v_mfma_f32_16x16x32_bf16 v[84:87], v[160:163], v[144:147], v[84:87]
    ds_read_b128 v[144:147], v175 offset:37888
    v_mfma_f32_16x16x32_bf16 v[88:91], v[156:159], v[148:151], v[88:91]
    v_mfma_f32_16x16x32_bf16 v[92:95], v[160:163], v[148:151], v[92:95]
    ds_read_b128 v[148:151], v175 offset:39936
    v_mfma_f32_16x16x32_bf16 v[96:99], v[156:159], v[152:155], v[96:99]
    v_mfma_f32_16x16x32_bf16 v[100:103], v[160:163], v[152:155], v[100:103]
    ds_read_b128 v[152:155], v175 offset:41984
    s_waitcnt lgkmcnt(15)
    v_mfma_f32_16x16x32_bf16 v[0:3], v[104:107], v[164:167], v[0:3]
    v_mfma_f32_16x16x32_bf16 v[4:7], v[104:107], v[168:171], v[4:7]
    s_waitcnt lgkmcnt(14)
    v_mfma_f32_16x16x32_bf16 v[8:11], v[108:111], v[164:167], v[8:11]
    v_add_u32 v172, s62, v172
    v_add_u32 v173, s62, v173
    v_mfma_f32_16x16x32_bf16 v[12:15], v[108:111], v[168:171], v[12:15]
    v_add_u32 v174, s62, v174
    v_add_u32 v175, s62, v175
    s_waitcnt lgkmcnt(12)
    v_mfma_f32_16x16x32_bf16 v[16:19], v[112:115], v[164:167], v[16:19]
    v_add_u32 v176, s62, v176
    v_mfma_f32_16x16x32_bf16 v[20:23], v[112:115], v[168:171], v[20:23]
    s_waitcnt lgkmcnt(0)
    s_barrier
    v_mfma_f32_16x16x32_bf16 v[24:27], v[116:119], v[164:167], v[24:27]
    ds_read_b128 v[156:159], v172 offset:0
    ds_read_b128 v[160:163], v172 offset:2048
    v_mfma_f32_16x16x32_bf16 v[28:31], v[116:119], v[168:171], v[28:31]
    ds_read_b64_tr_b16 v[104:105], v176 offset:16384
    ds_read_b64_tr_b16 v[106:107], v176 offset:17024
    v_mfma_f32_16x16x32_bf16 v[32:35], v[120:123], v[164:167], v[32:35]
    ds_read_b64_tr_b16 v[108:109], v176 offset:16392
    ds_read_b64_tr_b16 v[110:111], v176 offset:17032
    v_mfma_f32_16x16x32_bf16 v[36:39], v[120:123], v[168:171], v[36:39]
    ds_read_b64_tr_b16 v[112:113], v176 offset:16400
    ds_read_b64_tr_b16 v[114:115], v176 offset:17040
    v_mfma_f32_16x16x32_bf16 v[40:43], v[164:167], v[124:127], v[40:43]
    ds_read_b64_tr_b16 v[116:117], v176 offset:16408
    ds_read_b64_tr_b16 v[118:119], v176 offset:17048
    v_mfma_f32_16x16x32_bf16 v[44:47], v[168:171], v[124:127], v[44:47]
    ds_read_b64_tr_b16 v[120:121], v176 offset:16416
    ds_read_b64_tr_b16 v[122:123], v176 offset:17056
    v_mfma_f32_16x16x32_bf16 v[48:51], v[164:167], v[128:131], v[48:51]
    ds_read_b128 v[124:127], v174 offset:27648
    v_mfma_f32_16x16x32_bf16 v[52:55], v[168:171], v[128:131], v[52:55]
    ds_read_b128 v[128:131], v174 offset:29696
    v_mfma_f32_16x16x32_bf16 v[56:59], v[164:167], v[132:135], v[56:59]
    v_mfma_f32_16x16x32_bf16 v[60:63], v[168:171], v[132:135], v[60:63]
    ds_read_b128 v[132:135], v174 offset:31744
    v_mfma_f32_16x16x32_bf16 v[64:67], v[164:167], v[136:139], v[64:67]
    v_mfma_f32_16x16x32_bf16 v[68:71], v[168:171], v[136:139], v[68:71]
    ds_read_b128 v[136:139], v174 offset:33792
    v_mfma_f32_16x16x32_bf16 v[72:75], v[164:167], v[140:143], v[72:75]
    v_mfma_f32_16x16x32_bf16 v[76:79], v[168:171], v[140:143], v[76:79]
    ds_read_b128 v[140:143], v174 offset:35840
    v_mfma_f32_16x16x32_bf16 v[80:83], v[164:167], v[144:147], v[80:83]
    v_mfma_f32_16x16x32_bf16 v[84:87], v[168:171], v[144:147], v[84:87]
    ds_read_b128 v[144:147], v174 offset:37888
    v_mfma_f32_16x16x32_bf16 v[88:91], v[164:167], v[148:151], v[88:91]
    v_mfma_f32_16x16x32_bf16 v[92:95], v[168:171], v[148:151], v[92:95]
    ds_read_b128 v[148:151], v174 offset:39936
    v_mfma_f32_16x16x32_bf16 v[96:99], v[164:167], v[152:155], v[96:99]
    v_mfma_f32_16x16x32_bf16 v[100:103], v[168:171], v[152:155], v[100:103]
    ds_read_b128 v[152:155], v174 offset:41984
    s_add_u32 s59, s59, 1
    s_cmp_lt_u32 s59, 9
    s_cbranch_scc1 gated_mix__ssm_conv_s5__linear_kernel_hedgehog__prompt_kernel_main100
    s_waitcnt lgkmcnt(15)
    v_mfma_f32_16x16x32_bf16 v[0:3], v[104:107], v[156:159], v[0:3]
    ds_read_b128 v[164:167], v173 offset:0
    v_mfma_f32_16x16x32_bf16 v[4:7], v[104:107], v[160:163], v[4:7]
    ds_read_b128 v[168:171], v173 offset:2048
    s_waitcnt lgkmcnt(15)
    v_mfma_f32_16x16x32_bf16 v[8:11], v[108:111], v[156:159], v[8:11]
    ds_read_b64_tr_b16 v[104:105], v176 offset:22016
    v_mfma_f32_16x16x32_bf16 v[12:15], v[108:111], v[160:163], v[12:15]
    ds_read_b64_tr_b16 v[106:107], v176 offset:22656
    s_waitcnt lgkmcnt(15)
    v_mfma_f32_16x16x32_bf16 v[16:19], v[112:115], v[156:159], v[16:19]
    ds_read_b64_tr_b16 v[108:109], v176 offset:22024
    v_mfma_f32_16x16x32_bf16 v[20:23], v[112:115], v[160:163], v[20:23]
    ds_read_b64_tr_b16 v[110:111], v176 offset:22664
    s_waitcnt lgkmcnt(15)
    v_mfma_f32_16x16x32_bf16 v[24:27], v[116:119], v[156:159], v[24:27]
    ds_read_b64_tr_b16 v[112:113], v176 offset:22032
    v_mfma_f32_16x16x32_bf16 v[28:31], v[116:119], v[160:163], v[28:31]
    ds_read_b64_tr_b16 v[114:115], v176 offset:22672
    s_waitcnt lgkmcnt(15)
    v_mfma_f32_16x16x32_bf16 v[32:35], v[120:123], v[156:159], v[32:35]
    ds_read_b64_tr_b16 v[116:117], v176 offset:22040
    v_mfma_f32_16x16x32_bf16 v[36:39], v[120:123], v[160:163], v[36:39]
    ds_read_b64_tr_b16 v[118:119], v176 offset:22680
    v_mfma_f32_16x16x32_bf16 v[40:43], v[156:159], v[124:127], v[40:43]
    ds_read_b64_tr_b16 v[120:121], v176 offset:22048
    v_mfma_f32_16x16x32_bf16 v[44:47], v[160:163], v[124:127], v[44:47]
    ds_read_b64_tr_b16 v[122:123], v176 offset:22688
    s_waitcnt lgkmcnt(15)
    v_mfma_f32_16x16x32_bf16 v[48:51], v[156:159], v[128:131], v[48:51]
    ds_read_b128 v[124:127], v175 offset:27648
    v_mfma_f32_16x16x32_bf16 v[52:55], v[160:163], v[128:131], v[52:55]
    ds_read_b128 v[128:131], v175 offset:29696
    v_mfma_f32_16x16x32_bf16 v[56:59], v[156:159], v[132:135], v[56:59]
    v_mfma_f32_16x16x32_bf16 v[60:63], v[160:163], v[132:135], v[60:63]
    ds_read_b128 v[132:135], v175 offset:31744
    v_mfma_f32_16x16x32_bf16 v[64:67], v[156:159], v[136:139], v[64:67]
    v_mfma_f32_16x16x32_bf16 v[68:71], v[160:163], v[136:139], v[68:71]
    ds_read_b128 v[136:139], v175 offset:33792
    v_mfma_f32_16x16x32_bf16 v[72:75], v[156:159], v[140:143], v[72:75]
    v_mfma_f32_16x16x32_bf16 v[76:79], v[160:163], v[140:143], v[76:79]
    ds_read_b128 v[140:143], v175 offset:35840
    s_waitcnt lgkmcnt(15)
    v_mfma_f32_16x16x32_bf16 v[80:83], v[156:159], v[144:147], v[80:83]
    v_mfma_f32_16x16x32_bf16 v[84:87], v[160:163], v[144:147], v[84:87]
    ds_read_b128 v[144:147], v175 offset:37888
    v_mfma_f32_16x16x32_bf16 v[88:91], v[156:159], v[148:151], v[88:91]
    v_mfma_f32_16x16x32_bf16 v[92:95], v[160:163], v[148:151], v[92:95]
    ds_read_b128 v[148:151], v175 offset:39936
    v_mfma_f32_16x16x32_bf16 v[96:99], v[156:159], v[152:155], v[96:99]
    v_mfma_f32_16x16x32_bf16 v[100:103], v[160:163], v[152:155], v[100:103]
    ds_read_b128 v[152:155], v175 offset:41984
    s_waitcnt lgkmcnt(15)
    v_mfma_f32_16x16x32_bf16 v[0:3], v[104:107], v[164:167], v[0:3]
    v_mfma_f32_16x16x32_bf16 v[4:7], v[104:107], v[168:171], v[4:7]
    s_waitcnt lgkmcnt(14)
    v_mfma_f32_16x16x32_bf16 v[8:11], v[108:111], v[164:167], v[8:11]
    v_mfma_f32_16x16x32_bf16 v[12:15], v[108:111], v[168:171], v[12:15]
    s_waitcnt lgkmcnt(12)
    v_mfma_f32_16x16x32_bf16 v[16:19], v[112:115], v[164:167], v[16:19]
    v_mfma_f32_16x16x32_bf16 v[20:23], v[112:115], v[168:171], v[20:23]
    s_waitcnt lgkmcnt(10)
    v_mfma_f32_16x16x32_bf16 v[24:27], v[116:119], v[164:167], v[24:27]
    v_mfma_f32_16x16x32_bf16 v[28:31], v[116:119], v[168:171], v[28:31]
    s_waitcnt lgkmcnt(8)
    v_mfma_f32_16x16x32_bf16 v[32:35], v[120:123], v[164:167], v[32:35]
    v_mfma_f32_16x16x32_bf16 v[36:39], v[120:123], v[168:171], v[36:39]
    s_waitcnt lgkmcnt(7)
    v_mfma_f32_16x16x32_bf16 v[40:43], v[164:167], v[124:127], v[40:43]
    v_mfma_f32_16x16x32_bf16 v[44:47], v[168:171], v[124:127], v[44:47]
    s_waitcnt lgkmcnt(6)
    v_mfma_f32_16x16x32_bf16 v[48:51], v[164:167], v[128:131], v[48:51]
    v_mfma_f32_16x16x32_bf16 v[52:55], v[168:171], v[128:131], v[52:55]
    s_waitcnt lgkmcnt(5)
    v_mfma_f32_16x16x32_bf16 v[56:59], v[164:167], v[132:135], v[56:59]
    v_mfma_f32_16x16x32_bf16 v[60:63], v[168:171], v[132:135], v[60:63]
    s_waitcnt lgkmcnt(4)
    v_mfma_f32_16x16x32_bf16 v[64:67], v[164:167], v[136:139], v[64:67]
    v_mfma_f32_16x16x32_bf16 v[68:71], v[168:171], v[136:139], v[68:71]
    s_waitcnt lgkmcnt(3)
    v_mfma_f32_16x16x32_bf16 v[72:75], v[164:167], v[140:143], v[72:75]
    v_mfma_f32_16x16x32_bf16 v[76:79], v[168:171], v[140:143], v[76:79]
    s_waitcnt lgkmcnt(2)
    v_mfma_f32_16x16x32_bf16 v[80:83], v[164:167], v[144:147], v[80:83]
    v_mfma_f32_16x16x32_bf16 v[84:87], v[168:171], v[144:147], v[84:87]
    s_waitcnt lgkmcnt(1)
    v_mfma_f32_16x16x32_bf16 v[88:91], v[164:167], v[148:151], v[88:91]
    v_mfma_f32_16x16x32_bf16 v[92:95], v[168:171], v[148:151], v[92:95]
    s_waitcnt lgkmcnt(0)
    v_mfma_f32_16x16x32_bf16 v[96:99], v[164:167], v[152:155], v[96:99]
    v_mfma_f32_16x16x32_bf16 v[100:103], v[168:171], v[152:155], v[100:103]
    s_waitcnt lgkmcnt(0)
    s_nop 7
    s_lshl_b32 s4, s3, 2
    v_add_u32 v206, s4, v196
    v_lshlrev_b32 v206, 9, v206
    v_lshl_add_u32 v206, v195, 3, v206
    v_add_u32 v206, 136064, v206
    v_pk_fma_f32 v[112:113], v[178:179], v[40:41], v[42:43] op_sel_hi:[0,1,1]
    v_pk_fma_f32 v[126:127], v[182:183], v[56:57], v[58:59] op_sel_hi:[0,1,1]
    v_pk_fma_f32 v[140:141], v[186:187], v[72:73], v[74:75] op_sel_hi:[0,1,1]
    v_pk_fma_f32 v[154:155], v[190:191], v[88:89], v[90:91] op_sel_hi:[0,1,1]
    v_pk_fma_f32 v[114:115], v[178:179], v[48:49], v[50:51] op_sel_hi:[0,1,1]
    v_pk_fma_f32 v[128:129], v[182:183], v[64:65], v[66:67] op_sel_hi:[0,1,1]
    v_pk_fma_f32 v[142:143], v[186:187], v[80:81], v[82:83] op_sel_hi:[0,1,1]
    v_pk_fma_f32 v[156:157], v[190:191], v[96:97], v[98:99] op_sel_hi:[0,1,1]
    v_pk_fma_f32 v[108:109], v[178:179], v[48:49], v[112:113] op_sel:[1,0,0] op_sel_hi:[1,1,1] neg_lo:[1,0,0] neg_hi:[1,0,0]
    v_pk_fma_f32 v[122:123], v[182:183], v[64:65], v[126:127] op_sel:[1,0,0] op_sel_hi:[1,1,1] neg_lo:[1,0,0] neg_hi:[1,0,0]
    v_pk_fma_f32 v[136:137], v[186:187], v[80:81], v[140:141] op_sel:[1,0,0] op_sel_hi:[1,1,1] neg_lo:[1,0,0] neg_hi:[1,0,0]
    v_pk_fma_f32 v[150:151], v[190:191], v[96:97], v[154:155] op_sel:[1,0,0] op_sel_hi:[1,1,1] neg_lo:[1,0,0] neg_hi:[1,0,0]
    v_pk_fma_f32 v[110:111], v[178:179], v[40:41], v[114:115] op_sel:[1,0,0] op_sel_hi:[1,1,1]
    v_pk_fma_f32 v[124:125], v[182:183], v[56:57], v[128:129] op_sel:[1,0,0] op_sel_hi:[1,1,1]
    v_pk_fma_f32 v[138:139], v[186:187], v[72:73], v[142:143] op_sel:[1,0,0] op_sel_hi:[1,1,1]
    v_pk_fma_f32 v[152:153], v[190:191], v[88:89], v[156:157] op_sel:[1,0,0] op_sel_hi:[1,1,1]
    v_pk_fma_f32 v[112:113], v[178:179], v[108:109], v[44:45] op_sel_hi:[0,1,1]
    v_pk_fma_f32 v[126:127], v[182:183], v[122:123], v[60:61] op_sel_hi:[0,1,1]
    v_pk_fma_f32 v[140:141], v[186:187], v[136:137], v[76:77] op_sel_hi:[0,1,1]
    v_pk_fma_f32 v[154:155], v[190:191], v[150:151], v[92:93] op_sel_hi:[0,1,1]
    v_pk_fma_f32 v[114:115], v[178:179], v[110:111], v[52:53] op_sel_hi:[0,1,1]
    v_pk_fma_f32 v[128:129], v[182:183], v[124:125], v[68:69] op_sel_hi:[0,1,1]
    v_pk_fma_f32 v[142:143], v[186:187], v[138:139], v[84:85] op_sel_hi:[0,1,1]
    v_pk_fma_f32 v[156:157], v[190:191], v[152:153], v[100:101] op_sel_hi:[0,1,1]
    v_pk_fma_f32 v[104:105], v[178:179], v[110:111], v[112:113] op_sel:[1,0,0] op_sel_hi:[1,1,1] neg_lo:[1,0,0] neg_hi:[1,0,0]
    v_pk_fma_f32 v[118:119], v[182:183], v[124:125], v[126:127] op_sel:[1,0,0] op_sel_hi:[1,1,1] neg_lo:[1,0,0] neg_hi:[1,0,0]
    v_pk_fma_f32 v[132:133], v[186:187], v[138:139], v[140:141] op_sel:[1,0,0] op_sel_hi:[1,1,1] neg_lo:[1,0,0] neg_hi:[1,0,0]
    v_pk_fma_f32 v[146:147], v[190:191], v[152:153], v[154:155] op_sel:[1,0,0] op_sel_hi:[1,1,1] neg_lo:[1,0,0] neg_hi:[1,0,0]
    v_pk_fma_f32 v[106:107], v[178:179], v[108:109], v[114:115] op_sel:[1,0,0] op_sel_hi:[1,1,1]
    v_pk_fma_f32 v[120:121], v[182:183], v[122:123], v[128:129] op_sel:[1,0,0] op_sel_hi:[1,1,1]
    v_pk_fma_f32 v[134:135], v[186:187], v[136:137], v[142:143] op_sel:[1,0,0] op_sel_hi:[1,1,1]
    v_pk_fma_f32 v[148:149], v[190:191], v[150:151], v[156:157] op_sel:[1,0,0] op_sel_hi:[1,1,1]
    v_pk_fma_f32 v[112:113], v[178:179], v[104:105], v[46:47] op_sel_hi:[0,1,1]
    v_pk_fma_f32 v[126:127], v[182:183], v[118:119], v[62:63] op_sel_hi:[0,1,1]
    v_pk_fma_f32 v[140:141], v[186:187], v[132:133], v[78:79] op_sel_hi:[0,1,1]
    v_pk_fma_f32 v[154:155], v[190:191], v[146:147], v[94:95] op_sel_hi:[0,1,1]
    v_pk_fma_f32 v[114:115], v[178:179], v[106:107], v[54:55] op_sel_hi:[0,1,1]
    v_pk_fma_f32 v[128:129], v[182:183], v[120:121], v[70:71] op_sel_hi:[0,1,1]
    v_pk_fma_f32 v[142:143], v[186:187], v[134:135], v[86:87] op_sel_hi:[0,1,1]
    v_pk_fma_f32 v[156:157], v[190:191], v[148:149], v[102:103] op_sel_hi:[0,1,1]
    v_pk_fma_f32 v[108:109], v[178:179], v[106:107], v[112:113] op_sel:[1,0,0] op_sel_hi:[1,1,1] neg_lo:[1,0,0] neg_hi:[1,0,0]
    v_pk_fma_f32 v[122:123], v[182:183], v[120:121], v[126:127] op_sel:[1,0,0] op_sel_hi:[1,1,1] neg_lo:[1,0,0] neg_hi:[1,0,0]
    v_pk_fma_f32 v[136:137], v[186:187], v[134:135], v[140:141] op_sel:[1,0,0] op_sel_hi:[1,1,1] neg_lo:[1,0,0] neg_hi:[1,0,0]
    v_pk_fma_f32 v[150:151], v[190:191], v[148:149], v[154:155] op_sel:[1,0,0] op_sel_hi:[1,1,1] neg_lo:[1,0,0] neg_hi:[1,0,0]
    v_pk_fma_f32 v[110:111], v[178:179], v[104:105], v[114:115] op_sel:[1,0,0] op_sel_hi:[1,1,1]
    v_pk_fma_f32 v[124:125], v[182:183], v[118:119], v[128:129] op_sel:[1,0,0] op_sel_hi:[1,1,1]
    v_pk_fma_f32 v[138:139], v[186:187], v[132:133], v[142:143] op_sel:[1,0,0] op_sel_hi:[1,1,1]
    v_pk_fma_f32 v[152:153], v[190:191], v[146:147], v[156:157] op_sel:[1,0,0] op_sel_hi:[1,1,1]
    v_fma_f32 v116, v180, v108, v109
    v_fma_f32 v130, v184, v122, v123
    v_fma_f32 v144, v188, v136, v137
    v_fma_f32 v158, v192, v150, v151
    v_fma_f32 v117, v180, v110, v111
    v_fma_f32 v131, v184, v124, v125
    v_fma_f32 v145, v188, v138, v139
    v_fma_f32 v159, v192, v152, v153
    v_fma_f32 v116, -v181, v110, v116
    v_fma_f32 v130, -v185, v124, v130
    v_fma_f32 v144, -v189, v138, v144
    v_fma_f32 v158, -v193, v152, v158
    v_fma_f32 v117, v181, v108, v117
    v_fma_f32 v131, v185, v122, v131
    v_fma_f32 v145, v189, v136, v145
    v_fma_f32 v159, v193, v150, v159
    ds_write_b64 v206, v[116:117] offset:0
    ds_write_b64 v206, v[130:131] offset:128
    ds_write_b64 v206, v[144:145] offset:256
    ds_write_b64 v206, v[158:159] offset:384
    v_mov_b32 v198, v108
    v_mov_b32 v200, v122
    v_mov_b32 v202, v136
    v_mov_b32 v204, v150
    v_mov_b32 v199, v110
    v_mov_b32 v201, v124
    v_mov_b32 v203, v138
    v_mov_b32 v205, v152
    v_mov_b32 v208, 152448
    v_mov_b32 v207, 1
    s_waitcnt lgkmcnt(0)
    s_mov_b64 s[60:61], exec
    s_mov_b64 exec, 1
    ds_add_u32 v208, v207
    s_mov_b64 exec, s[60:61]
    v_and_b32 v208, 3, v195
    v_lshrrev_b32 v209, 2, v195
    v_mul_u32_u24 v177, 800, v208
    v_mul_u32_u24 v209, 40, v209
    v_add_u32 v177, v177, v209
    v_add_u32 v177, 132096, v177
    v_cmp_eq_u32 vcc, v208, v196
    v_mov_b32 v209, 135296
    s_nop 0
    v_cndmask_b32 v177, v209, v177, vcc
    ds_read_b64_tr_b16 v[208:209], v177 offset:0
    ds_read_b64_tr_b16 v[210:211], v177 offset:160
    ds_read_b64_tr_b16 v[212:213], v177 offset:320
    ds_read_b64_tr_b16 v[214:215], v177 offset:480
    ds_read_b64_tr_b16 v[216:217], v177 offset:640
    v_mov_b32 v218, 0
    v_mov_b32 v219, 0
    ds_read_b64_tr_b16 v[220:221], v177 offset:8
    ds_read_b64_tr_b16 v[222:223], v177 offset:168
    ds_read_b64_tr_b16 v[224:225], v177 offset:328
    ds_read_b64_tr_b16 v[226:227], v177 offset:488
    ds_read_b64_tr_b16 v[228:229], v177 offset:648
    v_mov_b32 v230, 0
    v_mov_b32 v231, 0
    ds_read_b64_tr_b16 v[232:233], v177 offset:16
    ds_read_b64_tr_b16 v[234:235], v177 offset:176
    ds_read_b64_tr_b16 v[236:237], v177 offset:336
    ds_read_b64_tr_b16 v[238:239], v177 offset:496
    ds_read_b64_tr_b16 v[240:241], v177 offset:656
    v_mov_b32 v242, 0
    v_mov_b32 v243, 0
    ds_read_b64_tr_b16 v[244:245], v177 offset:24
    ds_read_b64_tr_b16 v[246:247], v177 offset:184
    ds_read_b64_tr_b16 v[248:249], v177 offset:344
    ds_read_b64_tr_b16 v[250:251], v177 offset:504
    ds_read_b64_tr_b16 v[252:253], v177 offset:664
    v_mov_b32 v254, 0
    v_mov_b32 v255, 0
    ds_read_b64_tr_b16 v[160:161], v177 offset:32
    ds_read_b64_tr_b16 v[162:163], v177 offset:192
    ds_read_b64_tr_b16 v[164:165], v177 offset:352
    ds_read_b64_tr_b16 v[166:167], v177 offset:512
    ds_read_b64_tr_b16 v[168:169], v177 offset:672
    v_mov_b32 v170, 0
    v_mov_b32 v171, 0
    v_cvt_pk_bf16_f32 v104, v0, v1
    v_cvt_pk_bf16_f32 v105, v2, v3
    v_cvt_pk_bf16_f32 v106, v8, v9
    v_cvt_pk_bf16_f32 v107, v10, v11
    v_cvt_pk_bf16_f32 v108, v16, v17
    v_cvt_pk_bf16_f32 v109, v18, v19
    v_cvt_pk_bf16_f32 v110, v24, v25
    v_cvt_pk_bf16_f32 v111, v26, v27
    v_cvt_pk_bf16_f32 v112, v32, v33
    v_cvt_pk_bf16_f32 v113, v34, v35
    v_cvt_pk_bf16_f32 v116, v4, v5
    v_cvt_pk_bf16_f32 v117, v6, v7
    v_cvt_pk_bf16_f32 v118, v12, v13
    v_cvt_pk_bf16_f32 v119, v14, v15
    v_cvt_pk_bf16_f32 v120, v20, v21
    v_cvt_pk_bf16_f32 v121, v22, v23
    v_cvt_pk_bf16_f32 v122, v28, v29
    v_cvt_pk_bf16_f32 v123, v30, v31
    v_cvt_pk_bf16_f32 v124, v36, v37
    v_cvt_pk_bf16_f32 v125, v38, v39
    v_mov_b32 v114, 0
    v_mov_b32 v115, 0
    v_mov_b32 v126, 0
    v_mov_b32 v127, 0
    s_waitcnt lgkmcnt(0)
    v_mfma_f32_16x16x32_bf16 v[0:3], v[208:211], v[104:107], 0
    v_mfma_f32_16x16x32_bf16 v[20:23], v[208:211], v[116:119], 0
    v_mfma_f32_16x16x32_bf16 v[0:3], v[212:215], v[108:111], v[0:3]
    v_mfma_f32_16x16x32_bf16 v[20:23], v[212:215], v[120:123], v[20:23]
    v_mfma_f32_16x16x32_bf16 v[0:3], v[216:219], v[112:115], v[0:3]
    v_mfma_f32_16x16x32_bf16 v[20:23], v[216:219], v[124:127], v[20:23]
    v_mfma_f32_16x16x32_bf16 v[4:7], v[220:223], v[104:107], 0
    v_mfma_f32_16x16x32_bf16 v[24:27], v[220:223], v[116:119], 0
    v_mfma_f32_16x16x32_bf16 v[4:7], v[224:227], v[108:111], v[4:7]
    v_mfma_f32_16x16x32_bf16 v[24:27], v[224:227], v[120:123], v[24:27]
    v_mfma_f32_16x16x32_bf16 v[4:7], v[228:231], v[112:115], v[4:7]
    v_mfma_f32_16x16x32_bf16 v[24:27], v[228:231], v[124:127], v[24:27]
    v_mfma_f32_16x16x32_bf16 v[8:11], v[232:235], v[104:107], 0
    v_mfma_f32_16x16x32_bf16 v[28:31], v[232:235], v[116:119], 0
    v_mfma_f32_16x16x32_bf16 v[8:11], v[236:239], v[108:111], v[8:11]
    v_mfma_f32_16x16x32_bf16 v[28:31], v[236:239], v[120:123], v[28:31]
    v_mfma_f32_16x16x32_bf16 v[8:11], v[240:243], v[112:115], v[8:11]
    v_mfma_f32_16x16x32_bf16 v[28:31], v[240:243], v[124:127], v[28:31]
    v_mfma_f32_16x16x32_bf16 v[12:15], v[244:247], v[104:107], 0
    v_mfma_f32_16x16x32_bf16 v[32:35], v[244:247], v[116:119], 0
    v_mfma_f32_16x16x32_bf16 v[12:15], v[248:251], v[108:111], v[12:15]
    v_mfma_f32_16x16x32_bf16 v[32:35], v[248:251], v[120:123], v[32:35]
    v_mfma_f32_16x16x32_bf16 v[12:15], v[252:255], v[112:115], v[12:15]
    v_mfma_f32_16x16x32_bf16 v[32:35], v[252:255], v[124:127], v[32:35]
    v_mfma_f32_16x16x32_bf16 v[16:19], v[160:163], v[104:107], 0
    v_mfma_f32_16x16x32_bf16 v[36:39], v[160:163], v[116:119], 0
    v_mfma_f32_16x16x32_bf16 v[16:19], v[164:167], v[108:111], v[16:19]
    v_mfma_f32_16x16x32_bf16 v[36:39], v[164:167], v[120:123], v[36:39]
    v_mfma_f32_16x16x32_bf16 v[16:19], v[168:171], v[112:115], v[16:19]
    v_mfma_f32_16x16x32_bf16 v[36:39], v[168:171], v[124:127], v[36:39]
    v_mov_b32 v172, 0x3fb8aa3b
    v_max3_f32 v208, v0, v1, v2
    v_max3_f32 v218, v20, v21, v22
    v_min3_f32 v209, v0, v1, v2
    v_min3_f32 v219, v20, v21, v22
    v_max3_f32 v208, v208, v3, v4
    v_max3_f32 v218, v218, v23, v24
    v_min3_f32 v209, v209, v3, v4
    v_min3_f32 v219, v219, v23, v24
    v_max3_f32 v208, v208, v5, v6
    v_max3_f32 v218, v218, v25, v26
    v_min3_f32 v209, v209, v5, v6
    v_min3_f32 v219, v219, v25, v26
    v_max3_f32 v208, v208, v7, v8
    v_max3_f32 v218, v218, v27, v28
    v_min3_f32 v209, v209, v7, v8
    v_min3_f32 v219, v219, v27, v28
    v_max3_f32 v208, v208, v9, v10
    v_max3_f32 v218, v218, v29, v30
    v_min3_f32 v209, v209, v9, v10
    v_min3_f32 v219, v219, v29, v30
    v_max3_f32 v208, v208, v11, v12
    v_max3_f32 v218, v218, v31, v32
    v_min3_f32 v209, v209, v11, v12
    v_min3_f32 v219, v219, v31, v32
    v_max3_f32 v208, v208, v13, v14
    v_max3_f32 v218, v218, v33, v34
    v_min3_f32 v209, v209, v13, v14
    v_min3_f32 v219, v219, v33, v34
    v_max3_f32 v208, v208, v15, v16
    v_max3_f32 v218, v218, v35, v36
    v_min3_f32 v209, v209, v15, v16
    v_min3_f32 v219, v219, v35, v36
    v_max3_f32 v208, v208, v17, v18
    v_max3_f32 v218, v218, v37, v38
    v_min3_f32 v209, v209, v17, v18
    v_min3_f32 v219, v219, v37, v38
    v_max_f32 v208, v208, v19
    v_max_f32 v218, v218, v39
    v_min_f32 v209, v209, v19
    v_min_f32 v219, v219, v39
    v_mul_f32 v210, v172, v208
    v_mul_f32 v220, v172, v218
    v_mul_f32 v211, v172, v209
    v_mul_f32 v221, v172, v219
    v_pk_fma_f32 v[104:105], v[0:1], v[172:173], v[210:211] op_sel:[0,0,1] op_sel_hi:[1,0,1] neg_lo:[1,0,0] neg_hi:[1,0,0]
    v_pk_fma_f32 v[128:129], v[20:21], v[172:173], v[220:221] op_sel:[0,0,1] op_sel_hi:[1,0,1] neg_lo:[1,0,0] neg_hi:[1,0,0]
    v_pk_fma_f32 v[0:1], v[0:1], v[172:173], v[210:211] op_sel_hi:[1,0,0] neg_lo:[0,0,1] neg_hi:[0,0,1]
    v_pk_fma_f32 v[20:21], v[20:21], v[172:173], v[220:221] op_sel_hi:[1,0,0] neg_lo:[0,0,1] neg_hi:[0,0,1]
    v_pk_fma_f32 v[106:107], v[2:3], v[172:173], v[210:211] op_sel:[0,0,1] op_sel_hi:[1,0,1] neg_lo:[1,0,0] neg_hi:[1,0,0]
    v_pk_fma_f32 v[130:131], v[22:23], v[172:173], v[220:221] op_sel:[0,0,1] op_sel_hi:[1,0,1] neg_lo:[1,0,0] neg_hi:[1,0,0]
    v_pk_fma_f32 v[2:3], v[2:3], v[172:173], v[210:211] op_sel_hi:[1,0,0] neg_lo:[0,0,1] neg_hi:[0,0,1]
    v_pk_fma_f32 v[22:23], v[22:23], v[172:173], v[220:221] op_sel_hi:[1,0,0] neg_lo:[0,0,1] neg_hi:[0,0,1]
    v_pk_fma_f32 v[108:109], v[4:5], v[172:173], v[210:211] op_sel:[0,0,1] op_sel_hi:[1,0,1] neg_lo:[1,0,0] neg_hi:[1,0,0]
    v_pk_fma_f32 v[132:133], v[24:25], v[172:173], v[220:221] op_sel:[0,0,1] op_sel_hi:[1,0,1] neg_lo:[1,0,0] neg_hi:[1,0,0]
    v_pk_fma_f32 v[4:5], v[4:5], v[172:173], v[210:211] op_sel_hi:[1,0,0] neg_lo:[0,0,1] neg_hi:[0,0,1]
    v_pk_fma_f32 v[24:25], v[24:25], v[172:173], v[220:221] op_sel_hi:[1,0,0] neg_lo:[0,0,1] neg_hi:[0,0,1]
    v_pk_fma_f32 v[110:111], v[6:7], v[172:173], v[210:211] op_sel:[0,0,1] op_sel_hi:[1,0,1] neg_lo:[1,0,0] neg_hi:[1,0,0]
    v_pk_fma_f32 v[134:135], v[26:27], v[172:173], v[220:221] op_sel:[0,0,1] op_sel_hi:[1,0,1] neg_lo:[1,0,0] neg_hi:[1,0,0]
    v_pk_fma_f32 v[6:7], v[6:7], v[172:173], v[210:211] op_sel_hi:[1,0,0] neg_lo:[0,0,1] neg_hi:[0,0,1]
    v_pk_fma_f32 v[26:27], v[26:27], v[172:173], v[220:221] op_sel_hi:[1,0,0] neg_lo:[0,0,1] neg_hi:[0,0,1]
    v_pk_fma_f32 v[112:113], v[8:9], v[172:173], v[210:211] op_sel:[0,0,1] op_sel_hi:[1,0,1] neg_lo:[1,0,0] neg_hi:[1,0,0]
    v_pk_fma_f32 v[136:137], v[28:29], v[172:173], v[220:221] op_sel:[0,0,1] op_sel_hi:[1,0,1] neg_lo:[1,0,0] neg_hi:[1,0,0]
    v_pk_fma_f32 v[8:9], v[8:9], v[172:173], v[210:211] op_sel_hi:[1,0,0] neg_lo:[0,0,1] neg_hi:[0,0,1]
    v_pk_fma_f32 v[28:29], v[28:29], v[172:173], v[220:221] op_sel_hi:[1,0,0] neg_lo:[0,0,1] neg_hi:[0,0,1]
    v_pk_fma_f32 v[114:115], v[10:11], v[172:173], v[210:211] op_sel:[0,0,1] op_sel_hi:[1,0,1] neg_lo:[1,0,0] neg_hi:[1,0,0]
    v_pk_fma_f32 v[138:139], v[30:31], v[172:173], v[220:221] op_sel:[0,0,1] op_sel_hi:[1,0,1] neg_lo:[1,0,0] neg_hi:[1,0,0]
    v_pk_fma_f32 v[10:11], v[10:11], v[172:173], v[210:211] op_sel_hi:[1,0,0] neg_lo:[0,0,1] neg_hi:[0,0,1]
    v_pk_fma_f32 v[30:31], v[30:31], v[172:173], v[220:221] op_sel_hi:[1,0,0] neg_lo:[0,0,1] neg_hi:[0,0,1]
    v_pk_fma_f32 v[116:117], v[12:13], v[172:173], v[210:211] op_sel:[0,0,1] op_sel_hi:[1,0,1] neg_lo:[1,0,0] neg_hi:[1,0,0]
    v_pk_fma_f32 v[140:141], v[32:33], v[172:173], v[220:221] op_sel:[0,0,1] op_sel_hi:[1,0,1] neg_lo:[1,0,0] neg_hi:[1,0,0]
    v_pk_fma_f32 v[12:13], v[12:13], v[172:173], v[210:211] op_sel_hi:[1,0,0] neg_lo:[0,0,1] neg_hi:[0,0,1]
    v_pk_fma_f32 v[32:33], v[32:33], v[172:173], v[220:221] op_sel_hi:[1,0,0] neg_lo:[0,0,1] neg_hi:[0,0,1]
    v_pk_fma_f32 v[118:119], v[14:15], v[172:173], v[210:211] op_sel:[0,0,1] op_sel_hi:[1,0,1] neg_lo:[1,0,0] neg_hi:[1,0,0]
    v_pk_fma_f32 v[142:143], v[34:35], v[172:173], v[220:221] op_sel:[0,0,1] op_sel_hi:[1,0,1] neg_lo:[1,0,0] neg_hi:[1,0,0]
    v_pk_fma_f32 v[14:15], v[14:15], v[172:173], v[210:211] op_sel_hi:[1,0,0] neg_lo:[0,0,1] neg_hi:[0,0,1]
    v_pk_fma_f32 v[34:35], v[34:35], v[172:173], v[220:221] op_sel_hi:[1,0,0] neg_lo:[0,0,1] neg_hi:[0,0,1]
    v_pk_fma_f32 v[120:121], v[16:17], v[172:173], v[210:211] op_sel:[0,0,1] op_sel_hi:[1,0,1] neg_lo:[1,0,0] neg_hi:[1,0,0]
    v_pk_fma_f32 v[144:145], v[36:37], v[172:173], v[220:221] op_sel:[0,0,1] op_sel_hi:[1,0,1] neg_lo:[1,0,0] neg_hi:[1,0,0]
    v_pk_fma_f32 v[16:17], v[16:17], v[172:173], v[210:211] op_sel_hi:[1,0,0] neg_lo:[0,0,1] neg_hi:[0,0,1]
    v_pk_fma_f32 v[36:37], v[36:37], v[172:173], v[220:221] op_sel_hi:[1,0,0] neg_lo:[0,0,1] neg_hi:[0,0,1]
    v_pk_fma_f32 v[122:123], v[18:19], v[172:173], v[210:211] op_sel:[0,0,1] op_sel_hi:[1,0,1] neg_lo:[1,0,0] neg_hi:[1,0,0]
    v_pk_fma_f32 v[146:147], v[38:39], v[172:173], v[220:221] op_sel:[0,0,1] op_sel_hi:[1,0,1] neg_lo:[1,0,0] neg_hi:[1,0,0]
    v_pk_fma_f32 v[18:19], v[18:19], v[172:173], v[210:211] op_sel_hi:[1,0,0] neg_lo:[0,0,1] neg_hi:[0,0,1]
    v_pk_fma_f32 v[38:39], v[38:39], v[172:173], v[220:221] op_sel_hi:[1,0,0] neg_lo:[0,0,1] neg_hi:[0,0,1]
    v_exp_f32 v0, v0
    v_exp_f32 v20, v20
    v_exp_f32 v104, v104
    v_exp_f32 v128, v128
    v_exp_f32 v1, v1
    v_exp_f32 v21, v21
    v_exp_f32 v105, v105
    v_exp_f32 v129, v129
    v_exp_f32 v2, v2
    v_exp_f32 v22, v22
    v_exp_f32 v106, v106
    v_exp_f32 v130, v130
    v_exp_f32 v3, v3
    v_exp_f32 v23, v23
    v_exp_f32 v107, v107
    v_exp_f32 v131, v131
    v_exp_f32 v4, v4
    v_exp_f32 v24, v24
    v_exp_f32 v108, v108
    v_exp_f32 v132, v132
    v_exp_f32 v5, v5
    v_exp_f32 v25, v25
    v_exp_f32 v109, v109
    v_exp_f32 v133, v133
    v_exp_f32 v6, v6
    v_exp_f32 v26, v26
    v_exp_f32 v110, v110
    v_exp_f32 v134, v134
    v_exp_f32 v7, v7
    v_exp_f32 v27, v27
    v_exp_f32 v111, v111
    v_exp_f32 v135, v135
    v_exp_f32 v8, v8
    v_exp_f32 v28, v28
    v_exp_f32 v112, v112
    v_exp_f32 v136, v136
    v_exp_f32 v9, v9
    v_exp_f32 v29, v29
    v_exp_f32 v113, v113
    v_exp_f32 v137, v137
    v_exp_f32 v10, v10
    v_exp_f32 v30, v30
    v_exp_f32 v114, v114
    v_exp_f32 v138, v138
    v_exp_f32 v11, v11
    v_exp_f32 v31, v31
    v_exp_f32 v115, v115
    v_exp_f32 v139, v139
    v_exp_f32 v12, v12
    v_exp_f32 v32, v32
    v_exp_f32 v116, v116
    v_exp_f32 v140, v140
    v_exp_f32 v13, v13
    v_exp_f32 v33, v33
    v_exp_f32 v117, v117
    v_exp_f32 v141, v141
    v_exp_f32 v14, v14
    v_exp_f32 v34, v34
    v_exp_f32 v118, v118
    v_exp_f32 v142, v142
    v_exp_f32 v15, v15
    v_exp_f32 v35, v35
    v_exp_f32 v119, v119
    v_exp_f32 v143, v143
    v_exp_f32 v16, v16
    v_exp_f32 v36, v36
    v_exp_f32 v120, v120
    v_exp_f32 v144, v144
    v_exp_f32 v17, v17
    v_exp_f32 v37, v37
    v_exp_f32 v121, v121
    v_exp_f32 v145, v145
    v_exp_f32 v18, v18
    v_exp_f32 v38, v38
    v_exp_f32 v122, v122
    v_exp_f32 v146, v146
    v_exp_f32 v19, v19
    v_exp_f32 v39, v39
    v_exp_f32 v123, v123
    v_exp_f32 v147, v147
    v_pk_add_f32 v[212:213], v[0:1], v[2:3]
    v_pk_add_f32 v[222:223], v[20:21], v[22:23]
    v_pk_add_f32 v[214:215], v[104:105], v[106:107]
    v_pk_add_f32 v[224:225], v[128:129], v[130:131]
    v_pk_add_f32 v[212:213], v[212:213], v[4:5]
    v_pk_add_f32 v[222:223], v[222:223], v[24:25]
    v_pk_add_f32 v[214:215], v[214:215], v[108:109]
    v_pk_add_f32 v[224:225], v[224:225], v[132:133]
    v_pk_add_f32 v[212:213], v[212:213], v[6:7]
    v_pk_add_f32 v[222:223], v[222:223], v[26:27]
    v_pk_add_f32 v[214:215], v[214:215], v[110:111]
    v_pk_add_f32 v[224:225], v[224:225], v[134:135]
    v_pk_add_f32 v[212:213], v[212:213], v[8:9]
    v_pk_add_f32 v[222:223], v[222:223], v[28:29]
    v_pk_add_f32 v[214:215], v[214:215], v[112:113]
    v_pk_add_f32 v[224:225], v[224:225], v[136:137]
    v_pk_add_f32 v[212:213], v[212:213], v[10:11]
    v_pk_add_f32 v[222:223], v[222:223], v[30:31]
    v_pk_add_f32 v[214:215], v[214:215], v[114:115]
    v_pk_add_f32 v[224:225], v[224:225], v[138:139]
    v_pk_add_f32 v[212:213], v[212:213], v[12:13]
    v_pk_add_f32 v[222:223], v[222:223], v[32:33]
    v_pk_add_f32 v[214:215], v[214:215], v[116:117]
    v_pk_add_f32 v[224:225], v[224:225], v[140:141]
    v_pk_add_f32 v[212:213], v[212:213], v[14:15]
    v_pk_add_f32 v[222:223], v[222:223], v[34:35]
    v_pk_add_f32 v[214:215], v[214:215], v[118:119]
    v_pk_add_f32 v[224:225], v[224:225], v[142:143]
    v_pk_add_f32 v[212:213], v[212:213], v[16:17]
    v_pk_add_f32 v[222:223], v[222:223], v[36:37]
    v_pk_add_f32 v[214:215], v[214:215], v[120:121]
    v_pk_add_f32 v[224:225], v[224:225], v[144:145]
    v_pk_add_f32 v[212:213], v[212:213], v[18:19]
    v_pk_add_f32 v[222:223], v[222:223], v[38:39]
    v_pk_add_f32 v[214:215], v[214:215], v[122:123]
    v_pk_add_f32 v[224:225], v[224:225], v[146:147]
    v_add_f32 v212, v212, v213
    v_add_f32 v222, v222, v223
    v_add_f32 v214, v214, v215
    v_add_f32 v224, v224, v225
    v_rcp_f32 v212, v212
    v_rcp_f32 v222, v222
    v_rcp_f32 v214, v214
    v_rcp_f32 v224, v224
    v_pk_mul_f32 v[0:1], v[0:1], v[212:213] op_sel_hi:[1,0]
    v_pk_mul_f32 v[20:21], v[20:21], v[222:223] op_sel_hi:[1,0]
    v_pk_mul_f32 v[104:105], v[104:105], v[214:215] op_sel_hi:[1,0]
    v_pk_mul_f32 v[128:129], v[128:129], v[224:225] op_sel_hi:[1,0]
    v_pk_mul_f32 v[2:3], v[2:3], v[212:213] op_sel_hi:[1,0]
    v_pk_mul_f32 v[22:23], v[22:23], v[222:223] op_sel_hi:[1,0]
    v_pk_mul_f32 v[106:107], v[106:107], v[214:215] op_sel_hi:[1,0]
    v_pk_mul_f32 v[130:131], v[130:131], v[224:225] op_sel_hi:[1,0]
    v_pk_mul_f32 v[4:5], v[4:5], v[212:213] op_sel_hi:[1,0]
    v_pk_mul_f32 v[24:25], v[24:25], v[222:223] op_sel_hi:[1,0]
    v_pk_mul_f32 v[108:109], v[108:109], v[214:215] op_sel_hi:[1,0]
    v_pk_mul_f32 v[132:133], v[132:133], v[224:225] op_sel_hi:[1,0]
    v_pk_mul_f32 v[6:7], v[6:7], v[212:213] op_sel_hi:[1,0]
    v_pk_mul_f32 v[26:27], v[26:27], v[222:223] op_sel_hi:[1,0]
    v_pk_mul_f32 v[110:111], v[110:111], v[214:215] op_sel_hi:[1,0]
    v_pk_mul_f32 v[134:135], v[134:135], v[224:225] op_sel_hi:[1,0]
    v_pk_mul_f32 v[8:9], v[8:9], v[212:213] op_sel_hi:[1,0]
    v_pk_mul_f32 v[28:29], v[28:29], v[222:223] op_sel_hi:[1,0]
    v_pk_mul_f32 v[112:113], v[112:113], v[214:215] op_sel_hi:[1,0]
    v_pk_mul_f32 v[136:137], v[136:137], v[224:225] op_sel_hi:[1,0]
    v_pk_mul_f32 v[10:11], v[10:11], v[212:213] op_sel_hi:[1,0]
    v_pk_mul_f32 v[30:31], v[30:31], v[222:223] op_sel_hi:[1,0]
    v_pk_mul_f32 v[114:115], v[114:115], v[214:215] op_sel_hi:[1,0]
    v_pk_mul_f32 v[138:139], v[138:139], v[224:225] op_sel_hi:[1,0]
    v_pk_mul_f32 v[12:13], v[12:13], v[212:213] op_sel_hi:[1,0]
    v_pk_mul_f32 v[32:33], v[32:33], v[222:223] op_sel_hi:[1,0]
    v_pk_mul_f32 v[116:117], v[116:117], v[214:215] op_sel_hi:[1,0]
    v_pk_mul_f32 v[140:141], v[140:141], v[224:225] op_sel_hi:[1,0]
    v_pk_mul_f32 v[14:15], v[14:15], v[212:213] op_sel_hi:[1,0]
    v_pk_mul_f32 v[34:35], v[34:35], v[222:223] op_sel_hi:[1,0]
    v_pk_mul_f32 v[118:119], v[118:119], v[214:215] op_sel_hi:[1,0]
    v_pk_mul_f32 v[142:143], v[142:143], v[224:225] op_sel_hi:[1,0]
    v_pk_mul_f32 v[16:17], v[16:17], v[212:213] op_sel_hi:[1,0]
    v_pk_mul_f32 v[36:37], v[36:37], v[222:223] op_sel_hi:[1,0]
    v_pk_mul_f32 v[120:121], v[120:121], v[214:215] op_sel_hi:[1,0]
    v_pk_mul_f32 v[144:145], v[144:145], v[224:225] op_sel_hi:[1,0]
    v_pk_mul_f32 v[18:19], v[18:19], v[212:213] op_sel_hi:[1,0]
    v_pk_mul_f32 v[38:39], v[38:39], v[222:223] op_sel_hi:[1,0]
    v_pk_mul_f32 v[122:123], v[122:123], v[214:215] op_sel_hi:[1,0]
    v_pk_mul_f32 v[146:147], v[146:147], v[224:225] op_sel_hi:[1,0]
    v_cvt_pk_bf16_f32 v152, v0, v1
    v_cvt_pk_bf16_f32 v230, v20, v21
    v_cvt_pk_bf16_f32 v162, v104, v105
    v_cvt_pk_bf16_f32 v240, v128, v129
    v_cvt_pk_bf16_f32 v153, v2, v3
    v_cvt_pk_bf16_f32 v231, v22, v23
    v_cvt_pk_bf16_f32 v163, v106, v107
    v_cvt_pk_bf16_f32 v241, v130, v131
    v_cvt_pk_bf16_f32 v154, v4, v5
    v_cvt_pk_bf16_f32 v232, v24, v25
    v_cvt_pk_bf16_f32 v164, v108, v109
    v_cvt_pk_bf16_f32 v242, v132, v133
    v_cvt_pk_bf16_f32 v155, v6, v7
    v_cvt_pk_bf16_f32 v233, v26, v27
    v_cvt_pk_bf16_f32 v165, v110, v111
    v_cvt_pk_bf16_f32 v243, v134, v135
    v_cvt_pk_bf16_f32 v156, v8, v9
    v_cvt_pk_bf16_f32 v234, v28, v29
    v_cvt_pk_bf16_f32 v166, v112, v113
    v_cvt_pk_bf16_f32 v244, v136, v137
    v_cvt_pk_bf16_f32 v157, v10, v11
    v_cvt_pk_bf16_f32 v235, v30, v31
    v_cvt_pk_bf16_f32 v167, v114, v115
    v_cvt_pk_bf16_f32 v245, v138, v139
    v_cvt_pk_bf16_f32 v158, v12, v13
    v_cvt_pk_bf16_f32 v236, v32, v33
    v_cvt_pk_bf16_f32 v168, v116, v117
    v_cvt_pk_bf16_f32 v246, v140, v141
    v_cvt_pk_bf16_f32 v159, v14, v15
    v_cvt_pk_bf16_f32 v237, v34, v35
    v_cvt_pk_bf16_f32 v169, v118, v119
    v_cvt_pk_bf16_f32 v247, v142, v143
    v_cvt_pk_bf16_f32 v160, v16, v17
    v_cvt_pk_bf16_f32 v238, v36, v37
    v_cvt_pk_bf16_f32 v170, v120, v121
    v_cvt_pk_bf16_f32 v248, v144, v145
    v_cvt_pk_bf16_f32 v161, v18, v19
    v_cvt_pk_bf16_f32 v239, v38, v39
    v_cvt_pk_bf16_f32 v171, v122, v123
    v_cvt_pk_bf16_f32 v249, v146, v147
    s_lshl_b32 s4, s27, 7
    s_lshl_b32 s5, s26, 1
    s_add_u32 s4, s4, s5
    s_lshr_b32 s5, s3, 1
    s_add_u32 s4, s4, s5
    s_mul_i32 s4, s4, 5120
    s_and_b32 s5, s3, 1
    s_lshl_b32 s5, s5, 9
    s_add_u32 s4, s4, s5
    s_add_u32 s4, s4, 5242880
    s_add_u32 s5, s4, 4096
    v_lshlrev_b32 v208, 4, v195
    v_mul_u32_u24 v209, 163840, v196
    v_add_u32 v208, v208, v209
    buffer_store_dwordx4 v[152:155], v208, s[40:43], s4 offen offset:0 sc1
    buffer_store_dwordx4 v[156:159], v208, s[40:43], s4 offen offset:1024 sc1
    buffer_store_dwordx4 v[160:163], v208, s[40:43], s4 offen offset:2048 sc1
    buffer_store_dwordx4 v[164:167], v208, s[40:43], s4 offen offset:3072 sc1
    buffer_store_dwordx4 v[168:171], v208, s[40:43], s5 offen offset:0 sc1
    buffer_store_dwordx4 v[230:233], v208, s[40:43], s4 offen offset:256 sc1
    buffer_store_dwordx4 v[234:237], v208, s[40:43], s4 offen offset:1280 sc1
    buffer_store_dwordx4 v[238:241], v208, s[40:43], s4 offen offset:2304 sc1
    buffer_store_dwordx4 v[242:245], v208, s[40:43], s4 offen offset:3328 sc1
    buffer_store_dwordx4 v[246:249], v208, s[40:43], s5 offen offset:256 sc1
    s_waitcnt vmcnt(0)
    v_mov_b32 v254, 152496
    s_mov_b32 s5, 0
gated_mix__ssm_conv_s5__linear_kernel_hedgehog__prompt_kernel_spin102:
    ds_read_b32 v255, v254
    s_waitcnt lgkmcnt(0)
    v_readfirstlane_b32 s4, v255
    s_nop 3
    s_cmp_ge_u32 s4, 1
    s_cbranch_scc1 gated_mix__ssm_conv_s5__linear_kernel_hedgehog__prompt_kernel_spun103
    s_add_u32 s5, s5, 1
    s_cmp_ge_u32 s5, 8000000
    s_cbranch_scc1 gated_mix__ssm_conv_s5__linear_kernel_hedgehog__prompt_kernel_spun103
    s_sleep 1
    s_branch gated_mix__ssm_conv_s5__linear_kernel_hedgehog__prompt_kernel_spin102
gated_mix__ssm_conv_s5__linear_kernel_hedgehog__prompt_kernel_spun103:
    ds_read_b64 v[250:251], v254
    s_waitcnt lgkmcnt(0)
    v_mov_b32 v252, v250
    v_mov_b32 v253, v251
    v_mov_b32 v254, 152504
    v_mov_b32 v255, 1
    s_mov_b64 s[60:61], exec
    s_mov_b64 exec, 1
    ds_add_rtn_u32 v254, v254, v255
    s_waitcnt lgkmcnt(0)
    s_mov_b64 exec, s[60:61]
    v_readfirstlane_b32 s4, v254
    s_nop 3
    s_cmp_lg_u32 s4, 4
    s_cbranch_scc1 gated_mix__ssm_conv_s5__linear_kernel_hedgehog__prompt_kernel_nfk101
    s_lshl_b32 s4, s26, 4
    s_add_u32 s4, s4, s28
    s_lshl_b32 s4, s4, 7
    s_add_u32 s4, s4, 18219008
    v_lshlrev_b32 v254, 4, v194
    s_mov_b64 s[60:61], exec
    s_mov_b64 exec, 0xff
    buffer_store_dwordx4 v[250:253], v254, s[40:43], s4 offen sc1
    s_mov_b64 exec, s[60:61]
gated_mix__ssm_conv_s5__linear_kernel_hedgehog__prompt_kernel_nfk101:
    s_lshl_b32 s4, s3, 2
    v_add_u32 v206, s4, v196
    v_lshlrev_b32 v206, 9, v206
    v_lshl_add_u32 v206, v195, 3, v206
    v_add_u32 v206, 144256, v206
    v_lshlrev_b32 v210, 3, v195
    v_add_u32 v210, 153088, v210
    s_mul_i32 s4, s3, 10240
    s_add_u32 s4, s4, 0
    v_mul_u32_u24 v207, 80, v195
    v_lshl_add_u32 v207, v196, 4, v207
    v_add_u32 v207, s4, v207
    v_lshrrev_b32 v208, 2, v195
    v_lshl_add_u32 v208, v196, 3, v208
    v_mul_u32_u24 v208, 80, v208
    v_and_b32 v209, 3, v195
    v_lshl_add_u32 v208, v209, 4, v208
    v_add_u32 v208, s4, v208
    v_lshlrev_b32 v209, 4, v194
    s_lshl_b32 s4, s26, 3
    s_lshl_b32 s5, s3, 1
    s_add_u32 s4, s4, s5
    s_mul_i32 s4, s4, 40960
    s_mul_i32 s5, s27, 5
    s_add_u32 s5, s5, 1
    s_lshl_b32 s5, s5, 10
    s_add_u32 s4, s4, s5
    s_add_u32 s6, s4, 0
    v_mov_b32 v212, 152456
gated_mix__ssm_conv_s5__linear_kernel_hedgehog__prompt_kernel_spin104:
    ds_read_b32 v213, v212
    s_waitcnt lgkmcnt(0)
    v_readfirstlane_b32 s4, v213
    s_nop 3
    s_cmp_ge_u32 s4, 1
    s_cbranch_scc1 gated_mix__ssm_conv_s5__linear_kernel_hedgehog__prompt_kernel_spun105
    s_sleep 1
    s_branch gated_mix__ssm_conv_s5__linear_kernel_hedgehog__prompt_kernel_spin104
gated_mix__ssm_conv_s5__linear_kernel_hedgehog__prompt_kernel_spun105:
    ds_read_b64 v[104:105], v206 offset:0
    ds_read_b64 v[106:107], v206 offset:9344
    ds_read_b64 v[108:109], v210 offset:0
    ds_read_b64 v[120:121], v206 offset:128
    ds_read_b64 v[122:123], v206 offset:9472
    ds_read_b64 v[124:125], v210 offset:128
    ds_read_b64 v[136:137], v206 offset:256
    ds_read_b64 v[138:139], v206 offset:9600
    ds_read_b64 v[140:141], v210 offset:256
    ds_read_b64 v[152:153], v206 offset:384
    ds_read_b64 v[154:155], v206 offset:9728
    ds_read_b64 v[156:157], v210 offset:384
    s_waitcnt lgkmcnt(0)
    v_pk_fma_f32 v[110:111], v[106:107], v[108:109], v[104:105] op_sel_hi:[0,1,1]
    v_pk_fma_f32 v[126:127], v[122:123], v[124:125], v[120:121] op_sel_hi:[0,1,1]
    v_pk_fma_f32 v[142:143], v[138:139], v[140:141], v[136:137] op_sel_hi:[0,1,1]
    v_pk_fma_f32 v[158:159], v[154:155], v[156:157], v[152:153] op_sel_hi:[0,1,1]
    v_pk_fma_f32 v[110:111], v[106:107], v[108:109], v[110:111] op_sel:[1,1,0] op_sel_hi:[1,0,1] neg_lo:[1,0,0]
    v_pk_fma_f32 v[126:127], v[122:123], v[124:125], v[126:127] op_sel:[1,1,0] op_sel_hi:[1,0,1] neg_lo:[1,0,0]
    v_pk_fma_f32 v[142:143], v[138:139], v[140:141], v[142:143] op_sel:[1,1,0] op_sel_hi:[1,0,1] neg_lo:[1,0,0]
    v_pk_fma_f32 v[158:159], v[154:155], v[156:157], v[158:159] op_sel:[1,1,0] op_sel_hi:[1,0,1] neg_lo:[1,0,0]
    v_mov_b32 v112, v110
    v_mov_b32 v128, v126
    v_mov_b32 v144, v142
    v_mov_b32 v160, v158
    v_mov_b32 v114, v111
    v_mov_b32 v130, v127
    v_mov_b32 v146, v143
    v_mov_b32 v162, v159
    v_fma_f32 v113, v180, v110, v198
    v_fma_f32 v129, v184, v126, v200
    v_fma_f32 v145, v188, v142, v202
    v_fma_f32 v161, v192, v158, v204
    v_fma_f32 v115, v180, v111, v199
    v_fma_f32 v131, v184, v127, v201
    v_fma_f32 v147, v188, v143, v203
    v_fma_f32 v163, v192, v159, v205
    v_fma_f32 v113, -v181, v111, v113
    v_fma_f32 v129, -v185, v127, v129
    v_fma_f32 v145, -v189, v143, v145
    v_fma_f32 v161, -v193, v159, v161
    v_fma_f32 v115, v181, v110, v115
    v_fma_f32 v131, v185, v126, v131
    v_fma_f32 v147, v189, v142, v147
    v_fma_f32 v163, v193, v158, v163
    v_pk_fma_f32 v[116:117], v[178:179], v[112:113], v[40:41] op_sel_hi:[0,1,1]
    v_pk_fma_f32 v[132:133], v[182:183], v[128:129], v[56:57] op_sel_hi:[0,1,1]
    v_pk_fma_f32 v[148:149], v[186:187], v[144:145], v[72:73] op_sel_hi:[0,1,1]
    v_pk_fma_f32 v[164:165], v[190:191], v[160:161], v[88:89] op_sel_hi:[0,1,1]
    v_pk_fma_f32 v[118:119], v[178:179], v[114:115], v[48:49] op_sel_hi:[0,1,1]
    v_pk_fma_f32 v[134:135], v[182:183], v[130:131], v[64:65] op_sel_hi:[0,1,1]
    v_pk_fma_f32 v[150:151], v[186:187], v[146:147], v[80:81] op_sel_hi:[0,1,1]
    v_pk_fma_f32 v[166:167], v[190:191], v[162:163], v[96:97] op_sel_hi:[0,1,1]
    v_pk_fma_f32 v[40:41], v[178:179], v[114:115], v[116:117] op_sel:[1,0,0] op_sel_hi:[1,1,1] neg_lo:[1,0,0] neg_hi:[1,0,0]
    v_pk_fma_f32 v[56:57], v[182:183], v[130:131], v[132:133] op_sel:[1,0,0] op_sel_hi:[1,1,1] neg_lo:[1,0,0] neg_hi:[1,0,0]
    v_pk_fma_f32 v[72:73], v[186:187], v[146:147], v[148:149] op_sel:[1,0,0] op_sel_hi:[1,1,1] neg_lo:[1,0,0] neg_hi:[1,0,0]
    v_pk_fma_f32 v[88:89], v[190:191], v[162:163], v[164:165] op_sel:[1,0,0] op_sel_hi:[1,1,1] neg_lo:[1,0,0] neg_hi:[1,0,0]
    v_pk_fma_f32 v[48:49], v[178:179], v[112:113], v[118:119] op_sel:[1,0,0] op_sel_hi:[1,1,1]
    v_pk_fma_f32 v[64:65], v[182:183], v[128:129], v[134:135] op_sel:[1,0,0] op_sel_hi:[1,1,1]
    v_pk_fma_f32 v[80:81], v[186:187], v[144:145], v[150:151] op_sel:[1,0,0] op_sel_hi:[1,1,1]
    v_pk_fma_f32 v[96:97], v[190:191], v[160:161], v[166:167] op_sel:[1,0,0] op_sel_hi:[1,1,1]
    v_pk_fma_f32 v[116:117], v[178:179], v[40:41], v[42:43] op_sel_hi:[0,1,1]
    v_pk_fma_f32 v[132:133], v[182:183], v[56:57], v[58:59] op_sel_hi:[0,1,1]
    v_pk_fma_f32 v[148:149], v[186:187], v[72:73], v[74:75] op_sel_hi:[0,1,1]
    v_pk_fma_f32 v[164:165], v[190:191], v[88:89], v[90:91] op_sel_hi:[0,1,1]
    v_pk_fma_f32 v[118:119], v[178:179], v[48:49], v[50:51] op_sel_hi:[0,1,1]
    v_pk_fma_f32 v[134:135], v[182:183], v[64:65], v[66:67] op_sel_hi:[0,1,1]
    v_pk_fma_f32 v[150:151], v[186:187], v[80:81], v[82:83] op_sel_hi:[0,1,1]
    v_pk_fma_f32 v[166:167], v[190:191], v[96:97], v[98:99] op_sel_hi:[0,1,1]
    v_pk_fma_f32 v[42:43], v[178:179], v[48:49], v[116:117] op_sel:[1,0,0] op_sel_hi:[1,1,1] neg_lo:[1,0,0] neg_hi:[1,0,0]
    v_pk_fma_f32 v[58:59], v[182:183], v[64:65], v[132:133] op_sel:[1,0,0] op_sel_hi:[1,1,1] neg_lo:[1,0,0] neg_hi:[1,0,0]
    v_pk_fma_f32 v[74:75], v[186:187], v[80:81], v[148:149] op_sel:[1,0,0] op_sel_hi:[1,1,1] neg_lo:[1,0,0] neg_hi:[1,0,0]
    v_pk_fma_f32 v[90:91], v[190:191], v[96:97], v[164:165] op_sel:[1,0,0] op_sel_hi:[1,1,1] neg_lo:[1,0,0] neg_hi:[1,0,0]
    v_pk_fma_f32 v[50:51], v[178:179], v[40:41], v[118:119] op_sel:[1,0,0] op_sel_hi:[1,1,1]
    v_pk_fma_f32 v[66:67], v[182:183], v[56:57], v[134:135] op_sel:[1,0,0] op_sel_hi:[1,1,1]
    v_pk_fma_f32 v[82:83], v[186:187], v[72:73], v[150:151] op_sel:[1,0,0] op_sel_hi:[1,1,1]
    v_pk_fma_f32 v[98:99], v[190:191], v[88:89], v[166:167] op_sel:[1,0,0] op_sel_hi:[1,1,1]
    v_pk_fma_f32 v[116:117], v[178:179], v[42:43], v[44:45] op_sel_hi:[0,1,1]
    v_pk_fma_f32 v[132:133], v[182:183], v[58:59], v[60:61] op_sel_hi:[0,1,1]
    v_pk_fma_f32 v[148:149], v[186:187], v[74:75], v[76:77] op_sel_hi:[0,1,1]
    v_pk_fma_f32 v[164:165], v[190:191], v[90:91], v[92:93] op_sel_hi:[0,1,1]
    v_pk_fma_f32 v[118:119], v[178:179], v[50:51], v[52:53] op_sel_hi:[0,1,1]
    v_pk_fma_f32 v[134:135], v[182:183], v[66:67], v[68:69] op_sel_hi:[0,1,1]
    v_pk_fma_f32 v[150:151], v[186:187], v[82:83], v[84:85] op_sel_hi:[0,1,1]
    v_pk_fma_f32 v[166:167], v[190:191], v[98:99], v[100:101] op_sel_hi:[0,1,1]
    v_pk_fma_f32 v[44:45], v[178:179], v[50:51], v[116:117] op_sel:[1,0,0] op_sel_hi:[1,1,1] neg_lo:[1,0,0] neg_hi:[1,0,0]
    v_pk_fma_f32 v[60:61], v[182:183], v[66:67], v[132:133] op_sel:[1,0,0] op_sel_hi:[1,1,1] neg_lo:[1,0,0] neg_hi:[1,0,0]
    v_pk_fma_f32 v[76:77], v[186:187], v[82:83], v[148:149] op_sel:[1,0,0] op_sel_hi:[1,1,1] neg_lo:[1,0,0] neg_hi:[1,0,0]
    v_pk_fma_f32 v[92:93], v[190:191], v[98:99], v[164:165] op_sel:[1,0,0] op_sel_hi:[1,1,1] neg_lo:[1,0,0] neg_hi:[1,0,0]
    v_pk_fma_f32 v[52:53], v[178:179], v[42:43], v[118:119] op_sel:[1,0,0] op_sel_hi:[1,1,1]
    v_pk_fma_f32 v[68:69], v[182:183], v[58:59], v[134:135] op_sel:[1,0,0] op_sel_hi:[1,1,1]
    v_pk_fma_f32 v[84:85], v[186:187], v[74:75], v[150:151] op_sel:[1,0,0] op_sel_hi:[1,1,1]
    v_pk_fma_f32 v[100:101], v[190:191], v[90:91], v[166:167] op_sel:[1,0,0] op_sel_hi:[1,1,1]
    v_pk_fma_f32 v[116:117], v[178:179], v[44:45], v[46:47] op_sel_hi:[0,1,1]
    v_pk_fma_f32 v[132:133], v[182:183], v[60:61], v[62:63] op_sel_hi:[0,1,1]
    v_pk_fma_f32 v[148:149], v[186:187], v[76:77], v[78:79] op_sel_hi:[0,1,1]
    v_pk_fma_f32 v[164:165], v[190:191], v[92:93], v[94:95] op_sel_hi:[0,1,1]
    v_pk_fma_f32 v[118:119], v[178:179], v[52:53], v[54:55] op_sel_hi:[0,1,1]
    v_pk_fma_f32 v[134:135], v[182:183], v[68:69], v[70:71] op_sel_hi:[0,1,1]
    v_pk_fma_f32 v[150:151], v[186:187], v[84:85], v[86:87] op_sel_hi:[0,1,1]
    v_pk_fma_f32 v[166:167], v[190:191], v[100:101], v[102:103] op_sel_hi:[0,1,1]
    v_pk_fma_f32 v[46:47], v[178:179], v[52:53], v[116:117] op_sel:[1,0,0] op_sel_hi:[1,1,1] neg_lo:[1,0,0] neg_hi:[1,0,0]
    v_pk_fma_f32 v[62:63], v[182:183], v[68:69], v[132:133] op_sel:[1,0,0] op_sel_hi:[1,1,1] neg_lo:[1,0,0] neg_hi:[1,0,0]
    v_pk_fma_f32 v[78:79], v[186:187], v[84:85], v[148:149] op_sel:[1,0,0] op_sel_hi:[1,1,1] neg_lo:[1,0,0] neg_hi:[1,0,0]
    v_pk_fma_f32 v[94:95], v[190:191], v[100:101], v[164:165] op_sel:[1,0,0] op_sel_hi:[1,1,1] neg_lo:[1,0,0] neg_hi:[1,0,0]
    v_pk_fma_f32 v[54:55], v[178:179], v[44:45], v[118:119] op_sel:[1,0,0] op_sel_hi:[1,1,1]
    v_pk_fma_f32 v[70:71], v[182:183], v[60:61], v[134:135] op_sel:[1,0,0] op_sel_hi:[1,1,1]
    v_pk_fma_f32 v[86:87], v[186:187], v[76:77], v[150:151] op_sel:[1,0,0] op_sel_hi:[1,1,1]
    v_pk_fma_f32 v[102:103], v[190:191], v[92:93], v[166:167] op_sel:[1,0,0] op_sel_hi:[1,1,1]
    v_cvt_pk_bf16_f32 v104, v40, v41
    v_cvt_pk_bf16_f32 v120, v56, v57
    v_cvt_pk_bf16_f32 v136, v72, v73
    v_cvt_pk_bf16_f32 v152, v88, v89
    v_cvt_pk_bf16_f32 v105, v42, v43
    v_cvt_pk_bf16_f32 v121, v58, v59
    v_cvt_pk_bf16_f32 v137, v74, v75
    v_cvt_pk_bf16_f32 v153, v90, v91
    v_cvt_pk_bf16_f32 v106, v44, v45
    v_cvt_pk_bf16_f32 v122, v60, v61
    v_cvt_pk_bf16_f32 v138, v76, v77
    v_cvt_pk_bf16_f32 v154, v92, v93
    v_cvt_pk_bf16_f32 v107, v46, v47
    v_cvt_pk_bf16_f32 v123, v62, v63
    v_cvt_pk_bf16_f32 v139, v78, v79
    v_cvt_pk_bf16_f32 v155, v94, v95
    ds_write_b128 v207, v[104:107] offset:0
    ds_write_b128 v207, v[120:123] offset:2560
    ds_write_b128 v207, v[136:139] offset:5120
    ds_write_b128 v207, v[152:155] offset:7680
    v_cvt_pk_bf16_f32 v108, v48, v49
    v_cvt_pk_bf16_f32 v124, v64, v65
    v_cvt_pk_bf16_f32 v140, v80, v81
    v_cvt_pk_bf16_f32 v156, v96, v97
    v_cvt_pk_bf16_f32 v109, v50, v51
    v_cvt_pk_bf16_f32 v125, v66, v67
    v_cvt_pk_bf16_f32 v141, v82, v83
    v_cvt_pk_bf16_f32 v157, v98, v99
    v_cvt_pk_bf16_f32 v110, v52, v53
    v_cvt_pk_bf16_f32 v126, v68, v69
    v_cvt_pk_bf16_f32 v142, v84, v85
    v_cvt_pk_bf16_f32 v158, v100, v101
    v_cvt_pk_bf16_f32 v111, v54, v55
    v_cvt_pk_bf16_f32 v127, v70, v71
    v_cvt_pk_bf16_f32 v143, v86, v87
    v_cvt_pk_bf16_f32 v159, v102, v103
    ds_write_b128 v207, v[108:111] offset:1280
    ds_write_b128 v207, v[124:127] offset:3840
    ds_write_b128 v207, v[140:143] offset:6400
    ds_write_b128 v207, v[156:159] offset:8960
    s_waitcnt lgkmcnt(0)
    ds_read_b64_tr_b16 v[112:113], v208 offset:0
    ds_read_b64_tr_b16 v[114:115], v208 offset:320
    ds_read_b64_tr_b16 v[116:117], v208 offset:8
    ds_read_b64_tr_b16 v[118:119], v208 offset:328
    ds_read_b64_tr_b16 v[128:129], v208 offset:2560
    ds_read_b64_tr_b16 v[130:131], v208 offset:2880
    ds_read_b64_tr_b16 v[132:133], v208 offset:2568
    ds_read_b64_tr_b16 v[134:135], v208 offset:2888
    ds_read_b64_tr_b16 v[144:145], v208 offset:5120
    ds_read_b64_tr_b16 v[146:147], v208 offset:5440
    ds_read_b64_tr_b16 v[148:149], v208 offset:5128
    ds_read_b64_tr_b16 v[150:151], v208 offset:5448
    ds_read_b64_tr_b16 v[160:161], v208 offset:7680
    ds_read_b64_tr_b16 v[162:163], v208 offset:8000
    ds_read_b64_tr_b16 v[164:165], v208 offset:7688
    ds_read_b64_tr_b16 v[166:167], v208 offset:8008
    s_add_u32 s5, s6, 0
    s_waitcnt lgkmcnt(14)
    buffer_store_dwordx4 v[112:115], v209, s[40:43], s5 offen sc1
    s_add_u32 s5, s6, 40960
    s_waitcnt lgkmcnt(12)
    buffer_store_dwordx4 v[116:119], v209, s[40:43], s5 offen sc1
    s_add_u32 s5, s6, 1024
    s_waitcnt lgkmcnt(10)
    buffer_store_dwordx4 v[128:131], v209, s[40:43], s5 offen sc1
    s_add_u32 s5, s6, 41984
    s_waitcnt lgkmcnt(8)
    buffer_store_dwordx4 v[132:135], v209, s[40:43], s5 offen sc1
    s_add_u32 s5, s6, 2048
    s_waitcnt lgkmcnt(6)
    buffer_store_dwordx4 v[144:147], v209, s[40:43], s5 offen sc1
    s_add_u32 s5, s6, 43008
    s_waitcnt lgkmcnt(4)
    buffer_store_dwordx4 v[148:151], v209, s[40:43], s5 offen sc1
    s_add_u32 s5, s6, 3072
    s_waitcnt lgkmcnt(2)
    buffer_store_dwordx4 v[160:163], v209, s[40:43], s5 offen sc1
    s_add_u32 s5, s6, 44032
    s_waitcnt lgkmcnt(0)
    buffer_store_dwordx4 v[164:167], v209, s[40:43], s5 offen sc1
    s_lshl_b32 s52, s26, 4
    s_add_u32 s52, s52, s28
    s_lshl_b32 s52, s52, 7
    s_add_u32 s52, s52, 18186240
    s_waitcnt vmcnt(0)
    v_mov_b32 v244, 152464
    v_mov_b32 v245, 1
    s_mov_b64 s[60:61], exec
    s_mov_b64 exec, 1
    ds_add_rtn_u32 v246, v244, v245
    s_waitcnt lgkmcnt(0)
    s_mov_b64 exec, s[60:61]
    v_readfirstlane_b32 s4, v246
    s_nop 3
    s_cmp_lg_u32 s4, 6
    s_cbranch_scc1 gated_mix__ssm_conv_s5__linear_kernel_hedgehog__prompt_kernel_nf1106
    v_lshlrev_b32 v244, 4, v194
    s_mov_b64 s[60:61], exec
    s_mov_b64 exec, 0xff
    buffer_store_dwordx4 v[250:253], v244, s[40:43], s52 offen sc1
    s_mov_b64 exec, s[60:61]
gated_mix__ssm_conv_s5__linear_kernel_hedgehog__prompt_kernel_nf1106:
    s_branch gated_mix__ssm_conv_s5__linear_kernel_hedgehog__prompt_kernel_ojob
gated_mix__ssm_conv_s5__linear_kernel_hedgehog__prompt_kernel_gemm:
    s_setprio 0
    s_load_dwordx2 s[4:5], s[0:1], 128
    s_load_dwordx2 s[6:7], s[0:1], 112
    s_load_dwordx2 s[40:41], s[0:1], 0
    s_load_dwordx2 s[42:43], s[0:1], 64
    s_sub_u32 s26, s3, 4
    s_and_b32 s57, s2, 7
    s_lshr_b32 s58, s2, 3
    s_and_b32 s28, s58, 7
    s_lshr_b32 s53, s58, 3
    s_lshl_b32 s27, s57, 2
    s_add_u32 s27, s27, s53
    s_xor_b32 s53, s53, s28
    s_and_b32 s53, s53, 1
    s_and_b32 s29, s58, 3
    s_lshl_b32 s57, s57, 2
    s_add_u32 s29, s29, s57
    s_lshr_b32 s30, s58, 2
    v_and_b32 v83, 63, v0
    v_lshlrev_b32 v80, 4, v83
    v_and_b32 v84, 15, v83
    v_lshrrev_b32 v85, 4, v83
    s_waitcnt lgkmcnt(0)
    s_mov_b32 s8, s4
    s_and_b32 s9, s5, 0xffff
    s_mov_b32 s10, 20971520
    s_mov_b32 s11, 0x20000
    s_mov_b32 s16, s40
    s_and_b32 s17, s41, 0xffff
    s_mov_b32 s18, 2621440
    s_mov_b32 s19, 0x20000
    s_mov_b32 s20, s42
    s_and_b32 s21, s43, 0xffff
    s_mov_b32 s22, 1280
    s_mov_b32 s23, 0x20000
    s_mov_b32 s12, s6
    s_and_b32 s13, s7, 0xffff
    s_mov_b32 s14, 5242880
    s_mov_b32 s15, 0x20000
    s_mul_i32 s57, s27, 163840
    s_add_u32 s32, s57, 0
    s_add_u32 s33, s57, 40960
    s_add_u32 s34, s57, 81920
    s_add_u32 s35, s57, 122880
    s_mul_i32 s57, s28, 204800
    s_add_u32 s36, s57, 10485760
    s_add_u32 s37, s57, 10526720
    s_add_u32 s38, s57, 10567680
    s_add_u32 s39, s57, 10608640
    s_add_u32 s40, s57, 10649600
    s_mul_i32 s57, s27, 81920
    s_add_u32 s44, s57, 13631488
    s_add_u32 s45, s57, 13651968
    s_add_u32 s46, s57, 13672448
    s_add_u32 s47, s57, 13692928
    s_mul_i32 s57, s28, 102400
    s_add_u32 s48, s57, 12582912
    s_add_u32 s49, s57, 12603392
    s_add_u32 s50, s57, 12623872
    s_add_u32 s51, s57, 12644352
    s_add_u32 s52, s57, 12664832
    v_lshrrev_b32 v86, 2, v84
    v_lshlrev_b32 v86, 3, v86
    v_and_b32 v92, 1, v84
    v_lshl_add_u32 v86, v92, 2, v86
    v_bfe_u32 v92, v84, 1, 1
    v_add_u32 v86, v86, v92
    s_lshr_b32 s57, s26, 1
    s_lshl_b32 s57, s57, 5
    s_and_b32 s58, s26, 1
    s_lshl_b32 s58, s58, 1
    s_add_u32 s63, s57, s58
    s_lshl_b32 s57, s27, 6
    s_add_u32 s63, s63, s57
    s_mul_i32 s57, s63, 1280
    s_mul_i32 s58, s28, 160
    s_add_u32 s57, s57, s58
    v_mul_u32_u24 v112, 1280, v86
    v_lshl_add_u32 v112, v85, 3, v112
    v_lshlrev_b32 v113, 3, v85
    buffer_load_dwordx2 v[92:93], v112, s[16:19], s57 offen offset:0
    buffer_load_dwordx2 v[94:95], v112, s[16:19], s57 offen offset:32
    buffer_load_dwordx2 v[96:97], v112, s[16:19], s57 offen offset:64
    buffer_load_dwordx2 v[98:99], v112, s[16:19], s57 offen offset:96
    buffer_load_dwordx2 v[100:101], v112, s[16:19], s57 offen offset:128
    buffer_load_dwordx2 v[102:103], v113, s[20:23], s58 offen offset:0
    buffer_load_dwordx2 v[104:105], v113, s[20:23], s58 offen offset:32
    buffer_load_dwordx2 v[106:107], v113, s[20:23], s58 offen offset:64
    buffer_load_dwordx2 v[108:109], v113, s[20:23], s58 offen offset:96
    buffer_load_dwordx2 v[110:111], v113, s[20:23], s58 offen offset:128
    v_mov_b32 v120, 152496
    s_mov_b32 s58, 0
gated_mix__ssm_conv_s5__linear_kernel_hedgehog__prompt_kernel_spin107:
    ds_read_b32 v121, v120
    s_waitcnt lgkmcnt(0)
    v_readfirstlane_b32 s57, v121
    s_nop 3
    s_cmp_ge_u32 s57, 1
    s_cbranch_scc1 gated_mix__ssm_conv_s5__linear_kernel_hedgehog__prompt_kernel_spun108
    s_add_u32 s58, s58, 1
    s_cmp_ge_u32 s58, 8000000
    s_cbranch_scc1 gated_mix__ssm_conv_s5__linear_kernel_hedgehog__prompt_kernel_spun108
    s_sleep 1
    s_branch gated_mix__ssm_conv_s5__linear_kernel_hedgehog__prompt_kernel_spin107
gated_mix__ssm_conv_s5__linear_kernel_hedgehog__prompt_kernel_spun108:
    ds_read_b64 v[116:117], v120
    s_waitcnt lgkmcnt(0)
    v_mov_b32 v118, v116
    v_mov_b32 v119, v117
    s_waitcnt vmcnt(0)
    v_lshlrev_b32 v120, 16, v92
    v_lshlrev_b32 v121, 16, v102
    v_mul_f32 v0, v120, v121
    v_and_b32 v122, 0xffff0000, v92
    v_and_b32 v123, 0xffff0000, v102
    v_mul_f32 v1, v122, v123
    v_lshlrev_b32 v120, 16, v93
    v_lshlrev_b32 v121, 16, v103
    v_mul_f32 v2, v120, v121
    v_and_b32 v122, 0xffff0000, v93
    v_and_b32 v123, 0xffff0000, v103
    v_mul_f32 v3, v122, v123
    v_lshlrev_b32 v120, 16, v94
    v_lshlrev_b32 v121, 16, v104
    v_mul_f32 v4, v120, v121
    v_and_b32 v122, 0xffff0000, v94
    v_and_b32 v123, 0xffff0000, v104
    v_mul_f32 v5, v122, v123
    v_lshlrev_b32 v120, 16, v95
    v_lshlrev_b32 v121, 16, v105
    v_mul_f32 v6, v120, v121
    v_and_b32 v122, 0xffff0000, v95
    v_and_b32 v123, 0xffff0000, v105
    v_mul_f32 v7, v122, v123
    v_lshlrev_b32 v120, 16, v96
    v_lshlrev_b32 v121, 16, v106
    v_mul_f32 v8, v120, v121
    v_and_b32 v122, 0xffff0000, v96
    v_and_b32 v123, 0xffff0000, v106
    v_mul_f32 v9, v122, v123
    v_lshlrev_b32 v120, 16, v97
    v_lshlrev_b32 v121, 16, v107
    v_mul_f32 v10, v120, v121
    v_and_b32 v122, 0xffff0000, v97
    v_and_b32 v123, 0xffff0000, v107
    v_mul_f32 v11, v122, v123
    v_lshlrev_b32 v120, 16, v98
    v_lshlrev_b32 v121, 16, v108
    v_mul_f32 v12, v120, v121
    v_and_b32 v122, 0xffff0000, v98
    v_and_b32 v123, 0xffff0000, v108
    v_mul_f32 v13, v122, v123
    v_lshlrev_b32 v120, 16, v99
    v_lshlrev_b32 v121, 16, v109
    v_mul_f32 v14, v120, v121
    v_and_b32 v122, 0xffff0000, v99
    v_and_b32 v123, 0xffff0000, v109
    v_mul_f32 v15, v122, v123
    v_lshlrev_b32 v120, 16, v100
    v_lshlrev_b32 v121, 16, v110
    v_mul_f32 v16, v120, v121
    v_and_b32 v122, 0xffff0000, v100
    v_and_b32 v123, 0xffff0000, v110
    v_mul_f32 v17, v122, v123
    v_lshlrev_b32 v120, 16, v101
    v_lshlrev_b32 v121, 16, v111
    v_mul_f32 v18, v120, v121
    v_and_b32 v122, 0xffff0000, v101
    v_and_b32 v123, 0xffff0000, v111
    v_mul_f32 v19, v122, v123
    s_cmp_eq_u32 s26, 3
    s_cselect_b64 vcc, -1, 0
    v_cndmask_b32 v60, 0, v0, vcc
    v_cndmask_b32 v61, 0, v1, vcc
    v_cndmask_b32 v62, 0, v2, vcc
    v_cndmask_b32 v63, 0, v3, vcc
    v_cndmask_b32 v64, 0, v4, vcc
    v_cndmask_b32 v65, 0, v5, vcc
    v_cndmask_b32 v66, 0, v6, vcc
    v_cndmask_b32 v67, 0, v7, vcc
    v_cndmask_b32 v68, 0, v8, vcc
    v_cndmask_b32 v69, 0, v9, vcc
    v_cndmask_b32 v70, 0, v10, vcc
    v_cndmask_b32 v71, 0, v11, vcc
    v_cndmask_b32 v72, 0, v12, vcc
    v_cndmask_b32 v73, 0, v13, vcc
    v_cndmask_b32 v74, 0, v14, vcc
    v_cndmask_b32 v75, 0, v15, vcc
    v_cndmask_b32 v76, 0, v16, vcc
    v_cndmask_b32 v77, 0, v17, vcc
    v_cndmask_b32 v78, 0, v18, vcc
    v_cndmask_b32 v79, 0, v19, vcc
    s_cmp_eq_u32 s26, 2
    s_cselect_b64 vcc, -1, 0
    v_cndmask_b32 v40, 0, v0, vcc
    v_cndmask_b32 v41, 0, v1, vcc
    v_cndmask_b32 v42, 0, v2, vcc
    v_cndmask_b32 v43, 0, v3, vcc
    v_cndmask_b32 v44, 0, v4, vcc
    v_cndmask_b32 v45, 0, v5, vcc
    v_cndmask_b32 v46, 0, v6, vcc
    v_cndmask_b32 v47, 0, v7, vcc
    v_cndmask_b32 v48, 0, v8, vcc
    v_cndmask_b32 v49, 0, v9, vcc
    v_cndmask_b32 v50, 0, v10, vcc
    v_cndmask_b32 v51, 0, v11, vcc
    v_cndmask_b32 v52, 0, v12, vcc
    v_cndmask_b32 v53, 0, v13, vcc
    v_cndmask_b32 v54, 0, v14, vcc
    v_cndmask_b32 v55, 0, v15, vcc
    v_cndmask_b32 v56, 0, v16, vcc
    v_cndmask_b32 v57, 0, v17, vcc
    v_cndmask_b32 v58, 0, v18, vcc
    v_cndmask_b32 v59, 0, v19, vcc
    s_cmp_eq_u32 s26, 1
    s_cselect_b64 vcc, -1, 0
    v_cndmask_b32 v20, 0, v0, vcc
    v_cndmask_b32 v21, 0, v1, vcc
    v_cndmask_b32 v22, 0, v2, vcc
    v_cndmask_b32 v23, 0, v3, vcc
    v_cndmask_b32 v24, 0, v4, vcc
    v_cndmask_b32 v25, 0, v5, vcc
    v_cndmask_b32 v26, 0, v6, vcc
    v_cndmask_b32 v27, 0, v7, vcc
    v_cndmask_b32 v28, 0, v8, vcc
    v_cndmask_b32 v29, 0, v9, vcc
    v_cndmask_b32 v30, 0, v10, vcc
    v_cndmask_b32 v31, 0, v11, vcc
    v_cndmask_b32 v32, 0, v12, vcc
    v_cndmask_b32 v33, 0, v13, vcc
    v_cndmask_b32 v34, 0, v14, vcc
    v_cndmask_b32 v35, 0, v15, vcc
    v_cndmask_b32 v36, 0, v16, vcc
    v_cndmask_b32 v37, 0, v17, vcc
    v_cndmask_b32 v38, 0, v18, vcc
    v_cndmask_b32 v39, 0, v19, vcc
    s_cmp_eq_u32 s26, 0
    s_cselect_b64 vcc, -1, 0
    v_cndmask_b32 v0, 0, v0, vcc
    v_cndmask_b32 v1, 0, v1, vcc
    v_cndmask_b32 v2, 0, v2, vcc
    v_cndmask_b32 v3, 0, v3, vcc
    v_cndmask_b32 v4, 0, v4, vcc
    v_cndmask_b32 v5, 0, v5, vcc
    v_cndmask_b32 v6, 0, v6, vcc
    v_cndmask_b32 v7, 0, v7, vcc
    v_cndmask_b32 v8, 0, v8, vcc
    v_cndmask_b32 v9, 0, v9, vcc
    v_cndmask_b32 v10, 0, v10, vcc
    v_cndmask_b32 v11, 0, v11, vcc
    v_cndmask_b32 v12, 0, v12, vcc
    v_cndmask_b32 v13, 0, v13, vcc
    v_cndmask_b32 v14, 0, v14, vcc
    v_cndmask_b32 v15, 0, v15, vcc
    v_cndmask_b32 v16, 0, v16, vcc
    v_cndmask_b32 v17, 0, v17, vcc
    v_cndmask_b32 v18, 0, v18, vcc
    v_cndmask_b32 v19, 0, v19, vcc
    v_mov_b32 v120, 152464
    s_mov_b32 s58, 0
gated_mix__ssm_conv_s5__linear_kernel_hedgehog__prompt_kernel_spin109:
    ds_read_b32 v121, v120
    s_waitcnt lgkmcnt(0)
    v_readfirstlane_b32 s57, v121
    s_nop 3
    s_cmp_ge_u32 s57, 7
    s_cbranch_scc1 gated_mix__ssm_conv_s5__linear_kernel_hedgehog__prompt_kernel_spun110
    s_add_u32 s58, s58, 1
    s_cmp_ge_u32 s58, 8000000
    s_cbranch_scc1 gated_mix__ssm_conv_s5__linear_kernel_hedgehog__prompt_kernel_spun110
    s_sleep 1
    s_branch gated_mix__ssm_conv_s5__linear_kernel_hedgehog__prompt_kernel_spin109
gated_mix__ssm_conv_s5__linear_kernel_hedgehog__prompt_kernel_spun110:
    s_cmp_lg_u32 s3, 5
    s_cbranch_scc1 gated_mix__ssm_conv_s5__linear_kernel_hedgehog__prompt_kernel_notw111
    s_lshl_b32 s57, s28, 12
    s_add_u32 s57, s57, 18153472
    v_and_b32 v120, 31, v83
    v_lshlrev_b32 v120, 7, v120
    v_add_u32 v120, s57, v120
    s_mov_b32 s57, 0
gated_mix__ssm_conv_s5__linear_kernel_hedgehog__prompt_kernel_poll112:
    buffer_load_dwordx2 v[122:123], v120, s[8:11], 0 offen sc1
    s_waitcnt vmcnt(0)
    v_cmp_ne_u64 vcc, v[122:123], v[116:117]
    s_nop 3
    s_cmp_eq_u64 vcc, 0
    s_cbranch_scc1 gated_mix__ssm_conv_s5__linear_kernel_hedgehog__prompt_kernel_polled113
    s_add_u32 s57, s57, 1
    s_cmp_ge_u32 s57, 400000
    s_cbranch_scc1 gated_mix__ssm_conv_s5__linear_kernel_hedgehog__prompt_kernel_polled113
    s_sleep 4
    s_branch gated_mix__ssm_conv_s5__linear_kernel_hedgehog__prompt_kernel_poll112
gated_mix__ssm_conv_s5__linear_kernel_hedgehog__prompt_kernel_polled113:
    v_mov_b32 v120, 152468
    v_mov_b32 v121, 1
    ds_write_b32 v120, v121
gated_mix__ssm_conv_s5__linear_kernel_hedgehog__prompt_kernel_notw111:
    v_mov_b32 v120, 152468
    s_mov_b32 s58, 0
gated_mix__ssm_conv_s5__linear_kernel_hedgehog__prompt_kernel_spin114:
    ds_read_b32 v121, v120
    s_waitcnt lgkmcnt(0)
    v_readfirstlane_b32 s57, v121
    s_nop 3
    s_cmp_ge_u32 s57, 1
    s_cbranch_scc1 gated_mix__ssm_conv_s5__linear_kernel_hedgehog__prompt_kernel_spun115
    s_add_u32 s58, s58, 1
    s_cmp_ge_u32 s58, 8000000
    s_cbranch_scc1 gated_mix__ssm_conv_s5__linear_kernel_hedgehog__prompt_kernel_spun115
    s_sleep 1
    s_branch gated_mix__ssm_conv_s5__linear_kernel_hedgehog__prompt_kernel_spin114
gated_mix__ssm_conv_s5__linear_kernel_hedgehog__prompt_kernel_spun115:
    s_lshl_b32 s55, s26, 10
    v_add_u32 v96, s55, v80
    buffer_load_dwordx4 v[196:199], v96, s[8:11], s48 offen sc1
    buffer_load_dwordx4 v[200:203], v96, s[8:11], s49 offen sc1
    buffer_load_dwordx4 v[204:207], v96, s[8:11], s50 offen sc1
    buffer_load_dwordx4 v[208:211], v96, s[8:11], s51 offen sc1
    buffer_load_dwordx4 v[212:215], v96, s[8:11], s52 offen sc1
    s_add_u32 s55, s55, 4096
    v_add_u32 v96, s55, v80
    buffer_load_dwordx4 v[216:219], v96, s[8:11], s48 offen sc1
    buffer_load_dwordx4 v[220:223], v96, s[8:11], s49 offen sc1
    buffer_load_dwordx4 v[224:227], v96, s[8:11], s50 offen sc1
    buffer_load_dwordx4 v[228:231], v96, s[8:11], s51 offen sc1
    buffer_load_dwordx4 v[232:235], v96, s[8:11], s52 offen sc1
    s_add_u32 s55, s55, 4096
    v_add_u32 v96, s55, v80
    buffer_load_dwordx4 v[236:239], v96, s[8:11], s48 offen sc1
    buffer_load_dwordx4 v[240:243], v96, s[8:11], s49 offen sc1
    buffer_load_dwordx4 v[244:247], v96, s[8:11], s50 offen sc1
    buffer_load_dwordx4 v[248:251], v96, s[8:11], s51 offen sc1
    buffer_load_dwordx4 v[252:255], v96, s[8:11], s52 offen sc1
    s_add_u32 s55, s55, 4096
    s_mul_i32 s57, s53, 5
    s_lshl_b32 s57, s57, 2
    s_add_u32 s57, s57, s26
    s_lshl_b32 s56, s57, 10
    s_lshl_b32 s62, s26, 10
    s_add_u32 s62, s62, 40960
    v_add_u32 v81, s56, v80
    s_add_u32 s56, s56, 4096
    s_sub_u32 s57, s56, 40960
    s_cmp_ge_u32 s56, s62
    s_cselect_b32 s56, s57, s56
    buffer_load_dwordx4 v[140:143], v81, s[8:11], s36 offen sc1
    buffer_load_dwordx4 v[144:147], v81, s[8:11], s37 offen sc1
    buffer_load_dwordx4 v[148:151], v81, s[8:11], s38 offen sc1
    buffer_load_dwordx4 v[152:155], v81, s[8:11], s39 offen sc1
    buffer_load_dwordx4 v[156:159], v81, s[8:11], s40 offen sc1
    v_add_u32 v82, s56, v80
    s_add_u32 s56, s56, 4096
    s_sub_u32 s57, s56, 40960
    s_cmp_ge_u32 s56, s62
    s_cselect_b32 s56, s57, s56
    buffer_load_dwordx4 v[176:179], v82, s[8:11], s36 offen sc1
    buffer_load_dwordx4 v[180:183], v82, s[8:11], s37 offen sc1
    buffer_load_dwordx4 v[184:187], v82, s[8:11], s38 offen sc1
    buffer_load_dwordx4 v[188:191], v82, s[8:11], s39 offen sc1
    buffer_load_dwordx4 v[192:195], v82, s[8:11], s40 offen sc1
    s_cmp_lg_u32 s3, 7
    s_cbranch_scc1 gated_mix__ssm_conv_s5__linear_kernel_hedgehog__prompt_kernel_rest117
    s_lshr_b32 s57, s27, 1
    s_lshl_b32 s57, s57, 11
    s_add_u32 s57, s57, 18186240
    v_and_b32 v120, 15, v83
    v_lshlrev_b32 v120, 7, v120
    v_add_u32 v120, s57, v120
    s_mov_b32 s58, 0
gated_mix__ssm_conv_s5__linear_kernel_hedgehog__prompt_kernel_sp119:
    buffer_load_dwordx2 v[122:123], v120, s[8:11], 0 offen sc1
    s_waitcnt vmcnt(0)
    v_cmp_ne_u64 vcc, v[122:123], v[116:117]
    s_nop 3
    s_cmp_eq_u64 vcc, 0
    s_cbranch_scc1 gated_mix__ssm_conv_s5__linear_kernel_hedgehog__prompt_kernel_sok121
    s_add_u32 s58, s58, 1
    s_cmp_lt_u32 s58, 400000
    s_cbranch_scc1 gated_mix__ssm_conv_s5__linear_kernel_hedgehog__prompt_kernel_sp119
gated_mix__ssm_conv_s5__linear_kernel_hedgehog__prompt_kernel_sok121:
    v_mov_b32 v120, 152472
    v_mov_b32 v121, 1
    ds_write_b32 v120, v121
gated_mix__ssm_conv_s5__linear_kernel_hedgehog__prompt_kernel_rest117:
    v_mov_b32 v120, 152472
    s_mov_b32 s58, 0
gated_mix__ssm_conv_s5__linear_kernel_hedgehog__prompt_kernel_spin122:
    ds_read_b32 v121, v120
    s_waitcnt lgkmcnt(0)
    v_readfirstlane_b32 s57, v121
    s_nop 3
    s_cmp_ge_u32 s57, 1
    s_cbranch_scc1 gated_mix__ssm_conv_s5__linear_kernel_hedgehog__prompt_kernel_spun123
    s_add_u32 s58, s58, 1
    s_cmp_ge_u32 s58, 8000000
    s_cbranch_scc1 gated_mix__ssm_conv_s5__linear_kernel_hedgehog__prompt_kernel_spun123
    s_sleep 1
    s_branch gated_mix__ssm_conv_s5__linear_kernel_hedgehog__prompt_kernel_spin122
gated_mix__ssm_conv_s5__linear_kernel_hedgehog__prompt_kernel_spun123:
    buffer_load_dwordx4 v[124:127], v81, s[8:11], s32 offen sc1
    buffer_load_dwordx4 v[128:131], v81, s[8:11], s33 offen sc1
    buffer_load_dwordx4 v[132:135], v81, s[8:11], s34 offen sc1
    buffer_load_dwordx4 v[136:139], v81, s[8:11], s35 offen sc1
    s_lshl_b32 s57, s27, 10
    s_add_u32 s57, s57, 17825792
    v_lshrrev_b32 v114, 3, v86
    v_lshlrev_b32 v114, 7, v114
    v_and_b32 v115, 7, v86
    v_lshl_add_u32 v114, v115, 2, v114
    buffer_load_dword v88, v114, s[8:11], s57 offen offset:0 sc1
    buffer_load_dword v89, v114, s[8:11], s57 offen offset:8 sc1
    buffer_load_dword v90, v114, s[8:11], s57 offen offset:512 sc1
    buffer_load_dword v91, v114, s[8:11], s57 offen offset:520 sc1
    buffer_load_dwordx4 v[160:163], v82, s[8:11], s32 offen sc1
    buffer_load_dwordx4 v[164:167], v82, s[8:11], s33 offen sc1
    buffer_load_dwordx4 v[168:171], v82, s[8:11], s34 offen sc1
    buffer_load_dwordx4 v[172:175], v82, s[8:11], s35 offen sc1
    s_waitcnt vmcnt(4)
    v_mfma_f32_16x16x32_bf16 v[0:3], v[140:143], v[124:127], v[0:3]
    v_mfma_f32_16x16x32_bf16 v[4:7], v[144:147], v[124:127], v[4:7]
    v_mfma_f32_16x16x32_bf16 v[8:11], v[148:151], v[124:127], v[8:11]
    v_mfma_f32_16x16x32_bf16 v[12:15], v[152:155], v[124:127], v[12:15]
    v_mfma_f32_16x16x32_bf16 v[16:19], v[156:159], v[124:127], v[16:19]
    v_mfma_f32_16x16x32_bf16 v[20:23], v[140:143], v[128:131], v[20:23]
    v_mfma_f32_16x16x32_bf16 v[24:27], v[144:147], v[128:131], v[24:27]
    v_mfma_f32_16x16x32_bf16 v[28:31], v[148:151], v[128:131], v[28:31]
    v_mfma_f32_16x16x32_bf16 v[32:35], v[152:155], v[128:131], v[32:35]
    v_mfma_f32_16x16x32_bf16 v[36:39], v[156:159], v[128:131], v[36:39]
    v_mfma_f32_16x16x32_bf16 v[40:43], v[140:143], v[132:135], v[40:43]
    v_mfma_f32_16x16x32_bf16 v[44:47], v[144:147], v[132:135], v[44:47]
    v_mfma_f32_16x16x32_bf16 v[48:51], v[148:151], v[132:135], v[48:51]
    v_mfma_f32_16x16x32_bf16 v[52:55], v[152:155], v[132:135], v[52:55]
    v_mfma_f32_16x16x32_bf16 v[56:59], v[156:159], v[132:135], v[56:59]
    v_mfma_f32_16x16x32_bf16 v[60:63], v[140:143], v[136:139], v[60:63]
    v_mfma_f32_16x16x32_bf16 v[64:67], v[144:147], v[136:139], v[64:67]
    v_mfma_f32_16x16x32_bf16 v[68:71], v[148:151], v[136:139], v[68:71]
    v_mfma_f32_16x16x32_bf16 v[72:75], v[152:155], v[136:139], v[72:75]
    v_mfma_f32_16x16x32_bf16 v[76:79], v[156:159], v[136:139], v[76:79]
    v_add_u32 v81, s56, v80
    s_add_u32 s56, s56, 4096
    s_sub_u32 s57, s56, 40960
    s_cmp_ge_u32 s56, s62
    s_cselect_b32 s56, s57, s56
    buffer_load_dwordx4 v[124:127], v81, s[8:11], s32 offen sc1
    buffer_load_dwordx4 v[128:131], v81, s[8:11], s33 offen sc1
    buffer_load_dwordx4 v[132:135], v81, s[8:11], s34 offen sc1
    buffer_load_dwordx4 v[136:139], v81, s[8:11], s35 offen sc1
    buffer_load_dwordx4 v[140:143], v81, s[8:11], s36 offen sc1
    buffer_load_dwordx4 v[144:147], v81, s[8:11], s37 offen sc1
    buffer_load_dwordx4 v[148:151], v81, s[8:11], s38 offen sc1
    buffer_load_dwordx4 v[152:155], v81, s[8:11], s39 offen sc1
    buffer_load_dwordx4 v[156:159], v81, s[8:11], s40 offen sc1
    s_waitcnt vmcnt(9)
    v_mfma_f32_16x16x32_bf16 v[0:3], v[176:179], v[160:163], v[0:3]
    v_mfma_f32_16x16x32_bf16 v[4:7], v[180:183], v[160:163], v[4:7]
    v_mfma_f32_16x16x32_bf16 v[8:11], v[184:187], v[160:163], v[8:11]
    v_mfma_f32_16x16x32_bf16 v[12:15], v[188:191], v[160:163], v[12:15]
    v_mfma_f32_16x16x32_bf16 v[16:19], v[192:195], v[160:163], v[16:19]
    v_mfma_f32_16x16x32_bf16 v[20:23], v[176:179], v[164:167], v[20:23]
    v_mfma_f32_16x16x32_bf16 v[24:27], v[180:183], v[164:167], v[24:27]
    v_mfma_f32_16x16x32_bf16 v[28:31], v[184:187], v[164:167], v[28:31]
    v_mfma_f32_16x16x32_bf16 v[32:35], v[188:191], v[164:167], v[32:35]
    v_mfma_f32_16x16x32_bf16 v[36:39], v[192:195], v[164:167], v[36:39]
    v_mfma_f32_16x16x32_bf16 v[40:43], v[176:179], v[168:171], v[40:43]
    v_mfma_f32_16x16x32_bf16 v[44:47], v[180:183], v[168:171], v[44:47]
    v_mfma_f32_16x16x32_bf16 v[48:51], v[184:187], v[168:171], v[48:51]
    v_mfma_f32_16x16x32_bf16 v[52:55], v[188:191], v[168:171], v[52:55]
    v_mfma_f32_16x16x32_bf16 v[56:59], v[192:195], v[168:171], v[56:59]
    v_mfma_f32_16x16x32_bf16 v[60:63], v[176:179], v[172:175], v[60:63]
    v_mfma_f32_16x16x32_bf16 v[64:67], v[180:183], v[172:175], v[64:67]
    v_mfma_f32_16x16x32_bf16 v[68:71], v[184:187], v[172:175], v[68:71]
    v_mfma_f32_16x16x32_bf16 v[72:75], v[188:191], v[172:175], v[72:75]
    v_mfma_f32_16x16x32_bf16 v[76:79], v[192:195], v[172:175], v[76:79]
    v_add_u32 v82, s56, v80
    s_add_u32 s56, s56, 4096
    s_sub_u32 s57, s56, 40960
    s_cmp_ge_u32 s56, s62
    s_cselect_b32 s56, s57, s56
    buffer_load_dwordx4 v[160:163], v82, s[8:11], s32 offen sc1
    buffer_load_dwordx4 v[164:167], v82, s[8:11], s33 offen sc1
    buffer_load_dwordx4 v[168:171], v82, s[8:11], s34 offen sc1
    buffer_load_dwordx4 v[172:175], v82, s[8:11], s35 offen sc1
    buffer_load_dwordx4 v[176:179], v82, s[8:11], s36 offen sc1
    buffer_load_dwordx4 v[180:183], v82, s[8:11], s37 offen sc1
    buffer_load_dwordx4 v[184:187], v82, s[8:11], s38 offen sc1
    buffer_load_dwordx4 v[188:191], v82, s[8:11], s39 offen sc1
    buffer_load_dwordx4 v[192:195], v82, s[8:11], s40 offen sc1
    s_waitcnt vmcnt(9)
    v_mfma_f32_16x16x32_bf16 v[0:3], v[140:143], v[124:127], v[0:3]
    v_mfma_f32_16x16x32_bf16 v[4:7], v[144:147], v[124:127], v[4:7]
    v_mfma_f32_16x16x32_bf16 v[8:11], v[148:151], v[124:127], v[8:11]
    v_mfma_f32_16x16x32_bf16 v[12:15], v[152:155], v[124:127], v[12:15]
    v_mfma_f32_16x16x32_bf16 v[16:19], v[156:159], v[124:127], v[16:19]
    v_mfma_f32_16x16x32_bf16 v[20:23], v[140:143], v[128:131], v[20:23]
    v_mfma_f32_16x16x32_bf16 v[24:27], v[144:147], v[128:131], v[24:27]
    v_mfma_f32_16x16x32_bf16 v[28:31], v[148:151], v[128:131], v[28:31]
    v_mfma_f32_16x16x32_bf16 v[32:35], v[152:155], v[128:131], v[32:35]
    v_mfma_f32_16x16x32_bf16 v[36:39], v[156:159], v[128:131], v[36:39]
    v_mfma_f32_16x16x32_bf16 v[40:43], v[140:143], v[132:135], v[40:43]
    v_mfma_f32_16x16x32_bf16 v[44:47], v[144:147], v[132:135], v[44:47]
    v_mfma_f32_16x16x32_bf16 v[48:51], v[148:151], v[132:135], v[48:51]
    v_mfma_f32_16x16x32_bf16 v[52:55], v[152:155], v[132:135], v[52:55]
    v_mfma_f32_16x16x32_bf16 v[56:59], v[156:159], v[132:135], v[56:59]
    v_mfma_f32_16x16x32_bf16 v[60:63], v[140:143], v[136:139], v[60:63]
    v_mfma_f32_16x16x32_bf16 v[64:67], v[144:147], v[136:139], v[64:67]
    v_mfma_f32_16x16x32_bf16 v[68:71], v[148:151], v[136:139], v[68:71]
    v_mfma_f32_16x16x32_bf16 v[72:75], v[152:155], v[136:139], v[72:75]
    v_mfma_f32_16x16x32_bf16 v[76:79], v[156:159], v[136:139], v[76:79]
    v_add_u32 v81, s56, v80
    s_add_u32 s56, s56, 4096
    s_sub_u32 s57, s56, 40960
    s_cmp_ge_u32 s56, s62
    s_cselect_b32 s56, s57, s56
    buffer_load_dwordx4 v[124:127], v81, s[8:11], s32 offen sc1
    buffer_load_dwordx4 v[128:131], v81, s[8:11], s33 offen sc1
    buffer_load_dwordx4 v[132:135], v81, s[8:11], s34 offen sc1
    buffer_load_dwordx4 v[136:139], v81, s[8:11], s35 offen sc1
    buffer_load_dwordx4 v[140:143], v81, s[8:11], s36 offen sc1
    buffer_load_dwordx4 v[144:147], v81, s[8:11], s37 offen sc1
    buffer_load_dwordx4 v[148:151], v81, s[8:11], s38 offen sc1
    buffer_load_dwordx4 v[152:155], v81, s[8:11], s39 offen sc1
    buffer_load_dwordx4 v[156:159], v81, s[8:11], s40 offen sc1
    s_waitcnt vmcnt(9)
    v_mfma_f32_16x16x32_bf16 v[0:3], v[176:179], v[160:163], v[0:3]
    v_mfma_f32_16x16x32_bf16 v[4:7], v[180:183], v[160:163], v[4:7]
    v_mfma_f32_16x16x32_bf16 v[8:11], v[184:187], v[160:163], v[8:11]
    v_mfma_f32_16x16x32_bf16 v[12:15], v[188:191], v[160:163], v[12:15]
    v_mfma_f32_16x16x32_bf16 v[16:19], v[192:195], v[160:163], v[16:19]
    v_mfma_f32_16x16x32_bf16 v[20:23], v[176:179], v[164:167], v[20:23]
    v_mfma_f32_16x16x32_bf16 v[24:27], v[180:183], v[164:167], v[24:27]
    v_mfma_f32_16x16x32_bf16 v[28:31], v[184:187], v[164:167], v[28:31]
    v_mfma_f32_16x16x32_bf16 v[32:35], v[188:191], v[164:167], v[32:35]
    v_mfma_f32_16x16x32_bf16 v[36:39], v[192:195], v[164:167], v[36:39]
    v_mfma_f32_16x16x32_bf16 v[40:43], v[176:179], v[168:171], v[40:43]
    v_mfma_f32_16x16x32_bf16 v[44:47], v[180:183], v[168:171], v[44:47]
    v_mfma_f32_16x16x32_bf16 v[48:51], v[184:187], v[168:171], v[48:51]
    v_mfma_f32_16x16x32_bf16 v[52:55], v[188:191], v[168:171], v[52:55]
    v_mfma_f32_16x16x32_bf16 v[56:59], v[192:195], v[168:171], v[56:59]
    v_mfma_f32_16x16x32_bf16 v[60:63], v[176:179], v[172:175], v[60:63]
    v_mfma_f32_16x16x32_bf16 v[64:67], v[180:183], v[172:175], v[64:67]
    v_mfma_f32_16x16x32_bf16 v[68:71], v[184:187], v[172:175], v[68:71]
    v_mfma_f32_16x16x32_bf16 v[72:75], v[188:191], v[172:175], v[72:75]
    v_mfma_f32_16x16x32_bf16 v[76:79], v[192:195], v[172:175], v[76:79]
    s_cmp_lg_u32 s26, 0
    s_cbranch_scc1 gated_mix__ssm_conv_s5__linear_kernel_hedgehog__prompt_kernel_go124
    v_mov_b32 v92, 152492
    v_mov_b32 v93, 1
    ds_write_b32 v92, v93
gated_mix__ssm_conv_s5__linear_kernel_hedgehog__prompt_kernel_go124:
    v_add_u32 v82, s56, v80
    s_add_u32 s56, s56, 4096
    s_sub_u32 s57, s56, 40960
    s_cmp_ge_u32 s56, s62
    s_cselect_b32 s56, s57, s56
    buffer_load_dwordx4 v[160:163], v82, s[8:11], s32 offen sc1
    buffer_load_dwordx4 v[164:167], v82, s[8:11], s33 offen sc1
    buffer_load_dwordx4 v[168:171], v82, s[8:11], s34 offen sc1
    buffer_load_dwordx4 v[172:175], v82, s[8:11], s35 offen sc1
    buffer_load_dwordx4 v[176:179], v82, s[8:11], s36 offen sc1
    buffer_load_dwordx4 v[180:183], v82, s[8:11], s37 offen sc1
    buffer_load_dwordx4 v[184:187], v82, s[8:11], s38 offen sc1
    buffer_load_dwordx4 v[188:191], v82, s[8:11], s39 offen sc1
    buffer_load_dwordx4 v[192:195], v82, s[8:11], s40 offen sc1
    s_waitcnt vmcnt(9)
    v_mfma_f32_16x16x32_bf16 v[0:3], v[140:143], v[124:127], v[0:3]
    v_mfma_f32_16x16x32_bf16 v[4:7], v[144:147], v[124:127], v[4:7]
    v_mfma_f32_16x16x32_bf16 v[8:11], v[148:151], v[124:127], v[8:11]
    v_mfma_f32_16x16x32_bf16 v[12:15], v[152:155], v[124:127], v[12:15]
    v_mfma_f32_16x16x32_bf16 v[16:19], v[156:159], v[124:127], v[16:19]
    v_mfma_f32_16x16x32_bf16 v[20:23], v[140:143], v[128:131], v[20:23]
    v_mfma_f32_16x16x32_bf16 v[24:27], v[144:147], v[128:131], v[24:27]
    v_mfma_f32_16x16x32_bf16 v[28:31], v[148:151], v[128:131], v[28:31]
    v_mfma_f32_16x16x32_bf16 v[32:35], v[152:155], v[128:131], v[32:35]
    v_mfma_f32_16x16x32_bf16 v[36:39], v[156:159], v[128:131], v[36:39]
    v_mfma_f32_16x16x32_bf16 v[40:43], v[140:143], v[132:135], v[40:43]
    v_mfma_f32_16x16x32_bf16 v[44:47], v[144:147], v[132:135], v[44:47]
    v_mfma_f32_16x16x32_bf16 v[48:51], v[148:151], v[132:135], v[48:51]
    v_mfma_f32_16x16x32_bf16 v[52:55], v[152:155], v[132:135], v[52:55]
    v_mfma_f32_16x16x32_bf16 v[56:59], v[156:159], v[132:135], v[56:59]
    v_mfma_f32_16x16x32_bf16 v[60:63], v[140:143], v[136:139], v[60:63]
    v_mfma_f32_16x16x32_bf16 v[64:67], v[144:147], v[136:139], v[64:67]
    v_mfma_f32_16x16x32_bf16 v[68:71], v[148:151], v[136:139], v[68:71]
    v_mfma_f32_16x16x32_bf16 v[72:75], v[152:155], v[136:139], v[72:75]
    v_mfma_f32_16x16x32_bf16 v[76:79], v[156:159], v[136:139], v[76:79]
    v_add_u32 v81, s56, v80
    s_add_u32 s56, s56, 4096
    s_sub_u32 s57, s56, 40960
    s_cmp_ge_u32 s56, s62
    s_cselect_b32 s56, s57, s56
    buffer_load_dwordx4 v[124:127], v81, s[8:11], s32 offen sc1
    buffer_load_dwordx4 v[128:131], v81, s[8:11], s33 offen sc1
    buffer_load_dwordx4 v[132:135], v81, s[8:11], s34 offen sc1
    buffer_load_dwordx4 v[136:139], v81, s[8:11], s35 offen sc1
    buffer_load_dwordx4 v[140:143], v81, s[8:11], s36 offen sc1
    buffer_load_dwordx4 v[144:147], v81, s[8:11], s37 offen sc1
    buffer_load_dwordx4 v[148:151], v81, s[8:11], s38 offen sc1
    buffer_load_dwordx4 v[152:155], v81, s[8:11], s39 offen sc1
    buffer_load_dwordx4 v[156:159], v81, s[8:11], s40 offen sc1
    s_waitcnt vmcnt(9)
    v_mfma_f32_16x16x32_bf16 v[0:3], v[176:179], v[160:163], v[0:3]
    v_mfma_f32_16x16x32_bf16 v[4:7], v[180:183], v[160:163], v[4:7]
    v_mfma_f32_16x16x32_bf16 v[8:11], v[184:187], v[160:163], v[8:11]
    v_mfma_f32_16x16x32_bf16 v[12:15], v[188:191], v[160:163], v[12:15]
    v_mfma_f32_16x16x32_bf16 v[16:19], v[192:195], v[160:163], v[16:19]
    v_mfma_f32_16x16x32_bf16 v[20:23], v[176:179], v[164:167], v[20:23]
    v_mfma_f32_16x16x32_bf16 v[24:27], v[180:183], v[164:167], v[24:27]
    v_mfma_f32_16x16x32_bf16 v[28:31], v[184:187], v[164:167], v[28:31]
    v_mfma_f32_16x16x32_bf16 v[32:35], v[188:191], v[164:167], v[32:35]
    v_mfma_f32_16x16x32_bf16 v[36:39], v[192:195], v[164:167], v[36:39]
    v_mfma_f32_16x16x32_bf16 v[40:43], v[176:179], v[168:171], v[40:43]
    v_mfma_f32_16x16x32_bf16 v[44:47], v[180:183], v[168:171], v[44:47]
    v_mfma_f32_16x16x32_bf16 v[48:51], v[184:187], v[168:171], v[48:51]
    v_mfma_f32_16x16x32_bf16 v[52:55], v[188:191], v[168:171], v[52:55]
    v_mfma_f32_16x16x32_bf16 v[56:59], v[192:195], v[168:171], v[56:59]
    v_mfma_f32_16x16x32_bf16 v[60:63], v[176:179], v[172:175], v[60:63]
    v_mfma_f32_16x16x32_bf16 v[64:67], v[180:183], v[172:175], v[64:67]
    v_mfma_f32_16x16x32_bf16 v[68:71], v[184:187], v[172:175], v[68:71]
    v_mfma_f32_16x16x32_bf16 v[72:75], v[188:191], v[172:175], v[72:75]
    v_mfma_f32_16x16x32_bf16 v[76:79], v[192:195], v[172:175], v[76:79]
    v_add_u32 v82, s56, v80
    s_add_u32 s56, s56, 4096
    s_sub_u32 s57, s56, 40960
    s_cmp_ge_u32 s56, s62
    s_cselect_b32 s56, s57, s56
    buffer_load_dwordx4 v[160:163], v82, s[8:11], s32 offen sc1
    buffer_load_dwordx4 v[164:167], v82, s[8:11], s33 offen sc1
    buffer_load_dwordx4 v[168:171], v82, s[8:11], s34 offen sc1
    buffer_load_dwordx4 v[172:175], v82, s[8:11], s35 offen sc1
    buffer_load_dwordx4 v[176:179], v82, s[8:11], s36 offen sc1
    buffer_load_dwordx4 v[180:183], v82, s[8:11], s37 offen sc1
    buffer_load_dwordx4 v[184:187], v82, s[8:11], s38 offen sc1
    buffer_load_dwordx4 v[188:191], v82, s[8:11], s39 offen sc1
    buffer_load_dwordx4 v[192:195], v82, s[8:11], s40 offen sc1
    s_waitcnt vmcnt(9)
    v_mfma_f32_16x16x32_bf16 v[0:3], v[140:143], v[124:127], v[0:3]
    v_mfma_f32_16x16x32_bf16 v[4:7], v[144:147], v[124:127], v[4:7]
    v_mfma_f32_16x16x32_bf16 v[8:11], v[148:151], v[124:127], v[8:11]
    v_mfma_f32_16x16x32_bf16 v[12:15], v[152:155], v[124:127], v[12:15]
    v_mfma_f32_16x16x32_bf16 v[16:19], v[156:159], v[124:127], v[16:19]
    v_mfma_f32_16x16x32_bf16 v[20:23], v[140:143], v[128:131], v[20:23]
    v_mfma_f32_16x16x32_bf16 v[24:27], v[144:147], v[128:131], v[24:27]
    v_mfma_f32_16x16x32_bf16 v[28:31], v[148:151], v[128:131], v[28:31]
    v_mfma_f32_16x16x32_bf16 v[32:35], v[152:155], v[128:131], v[32:35]
    v_mfma_f32_16x16x32_bf16 v[36:39], v[156:159], v[128:131], v[36:39]
    v_mfma_f32_16x16x32_bf16 v[40:43], v[140:143], v[132:135], v[40:43]
    v_mfma_f32_16x16x32_bf16 v[44:47], v[144:147], v[132:135], v[44:47]
    v_mfma_f32_16x16x32_bf16 v[48:51], v[148:151], v[132:135], v[48:51]
    v_mfma_f32_16x16x32_bf16 v[52:55], v[152:155], v[132:135], v[52:55]
    v_mfma_f32_16x16x32_bf16 v[56:59], v[156:159], v[132:135], v[56:59]
    v_mfma_f32_16x16x32_bf16 v[60:63], v[140:143], v[136:139], v[60:63]
    v_mfma_f32_16x16x32_bf16 v[64:67], v[144:147], v[136:139], v[64:67]
    v_mfma_f32_16x16x32_bf16 v[68:71], v[148:151], v[136:139], v[68:71]
    v_mfma_f32_16x16x32_bf16 v[72:75], v[152:155], v[136:139], v[72:75]
    v_mfma_f32_16x16x32_bf16 v[76:79], v[156:159], v[136:139], v[76:79]
    v_add_u32 v81, s56, v80
    s_add_u32 s56, s56, 4096
    s_sub_u32 s57, s56, 40960
    s_cmp_ge_u32 s56, s62
    s_cselect_b32 s56, s57, s56
    buffer_load_dwordx4 v[124:127], v81, s[8:11], s32 offen sc1
    buffer_load_dwordx4 v[128:131], v81, s[8:11], s33 offen sc1
    buffer_load_dwordx4 v[132:135], v81, s[8:11], s34 offen sc1
    buffer_load_dwordx4 v[136:139], v81, s[8:11], s35 offen sc1
    buffer_load_dwordx4 v[140:143], v81, s[8:11], s36 offen sc1
    buffer_load_dwordx4 v[144:147], v81, s[8:11], s37 offen sc1
    buffer_load_dwordx4 v[148:151], v81, s[8:11], s38 offen sc1
    buffer_load_dwordx4 v[152:155], v81, s[8:11], s39 offen sc1
    buffer_load_dwordx4 v[156:159], v81, s[8:11], s40 offen sc1
    s_waitcnt vmcnt(9)
    v_mfma_f32_16x16x32_bf16 v[0:3], v[176:179], v[160:163], v[0:3]
    v_mfma_f32_16x16x32_bf16 v[4:7], v[180:183], v[160:163], v[4:7]
    v_mfma_f32_16x16x32_bf16 v[8:11], v[184:187], v[160:163], v[8:11]
    v_mfma_f32_16x16x32_bf16 v[12:15], v[188:191], v[160:163], v[12:15]
    v_mfma_f32_16x16x32_bf16 v[16:19], v[192:195], v[160:163], v[16:19]
    v_mfma_f32_16x16x32_bf16 v[20:23], v[176:179], v[164:167], v[20:23]
    v_mfma_f32_16x16x32_bf16 v[24:27], v[180:183], v[164:167], v[24:27]
    v_mfma_f32_16x16x32_bf16 v[28:31], v[184:187], v[164:167], v[28:31]
    v_mfma_f32_16x16x32_bf16 v[32:35], v[188:191], v[164:167], v[32:35]
    v_mfma_f32_16x16x32_bf16 v[36:39], v[192:195], v[164:167], v[36:39]
    v_mfma_f32_16x16x32_bf16 v[40:43], v[176:179], v[168:171], v[40:43]
    v_mfma_f32_16x16x32_bf16 v[44:47], v[180:183], v[168:171], v[44:47]
    v_mfma_f32_16x16x32_bf16 v[48:51], v[184:187], v[168:171], v[48:51]
    v_mfma_f32_16x16x32_bf16 v[52:55], v[188:191], v[168:171], v[52:55]
    v_mfma_f32_16x16x32_bf16 v[56:59], v[192:195], v[168:171], v[56:59]
    v_mfma_f32_16x16x32_bf16 v[60:63], v[176:179], v[172:175], v[60:63]
    v_mfma_f32_16x16x32_bf16 v[64:67], v[180:183], v[172:175], v[64:67]
    v_mfma_f32_16x16x32_bf16 v[68:71], v[184:187], v[172:175], v[68:71]
    v_mfma_f32_16x16x32_bf16 v[72:75], v[188:191], v[172:175], v[72:75]
    v_mfma_f32_16x16x32_bf16 v[76:79], v[192:195], v[172:175], v[76:79]
    v_add_u32 v82, s56, v80
    s_add_u32 s56, s56, 4096
    s_sub_u32 s57, s56, 40960
    s_cmp_ge_u32 s56, s62
    s_cselect_b32 s56, s57, s56
    buffer_load_dwordx4 v[160:163], v82, s[8:11], s32 offen sc1
    buffer_load_dwordx4 v[164:167], v82, s[8:11], s33 offen sc1
    buffer_load_dwordx4 v[168:171], v82, s[8:11], s34 offen sc1
    buffer_load_dwordx4 v[172:175], v82, s[8:11], s35 offen sc1
    buffer_load_dwordx4 v[176:179], v82, s[8:11], s36 offen sc1
    buffer_load_dwordx4 v[180:183], v82, s[8:11], s37 offen sc1
    buffer_load_dwordx4 v[184:187], v82, s[8:11], s38 offen sc1
    buffer_load_dwordx4 v[188:191], v82, s[8:11], s39 offen sc1
    buffer_load_dwordx4 v[192:195], v82, s[8:11], s40 offen sc1
    s_waitcnt vmcnt(9)
    v_mfma_f32_16x16x32_bf16 v[0:3], v[140:143], v[124:127], v[0:3]
    v_mfma_f32_16x16x32_bf16 v[4:7], v[144:147], v[124:127], v[4:7]
    v_mfma_f32_16x16x32_bf16 v[8:11], v[148:151], v[124:127], v[8:11]
    v_mfma_f32_16x16x32_bf16 v[12:15], v[152:155], v[124:127], v[12:15]
    v_mfma_f32_16x16x32_bf16 v[16:19], v[156:159], v[124:127], v[16:19]
    v_mfma_f32_16x16x32_bf16 v[20:23], v[140:143], v[128:131], v[20:23]
    v_mfma_f32_16x16x32_bf16 v[24:27], v[144:147], v[128:131], v[24:27]
    v_mfma_f32_16x16x32_bf16 v[28:31], v[148:151], v[128:131], v[28:31]
    v_mfma_f32_16x16x32_bf16 v[32:35], v[152:155], v[128:131], v[32:35]
    v_mfma_f32_16x16x32_bf16 v[36:39], v[156:159], v[128:131], v[36:39]
    v_mfma_f32_16x16x32_bf16 v[40:43], v[140:143], v[132:135], v[40:43]
    v_mfma_f32_16x16x32_bf16 v[44:47], v[144:147], v[132:135], v[44:47]
    v_mfma_f32_16x16x32_bf16 v[48:51], v[148:151], v[132:135], v[48:51]
    v_mfma_f32_16x16x32_bf16 v[52:55], v[152:155], v[132:135], v[52:55]
    v_mfma_f32_16x16x32_bf16 v[56:59], v[156:159], v[132:135], v[56:59]
    v_mfma_f32_16x16x32_bf16 v[60:63], v[140:143], v[136:139], v[60:63]
    v_mfma_f32_16x16x32_bf16 v[64:67], v[144:147], v[136:139], v[64:67]
    v_mfma_f32_16x16x32_bf16 v[68:71], v[148:151], v[136:139], v[68:71]
    v_mfma_f32_16x16x32_bf16 v[72:75], v[152:155], v[136:139], v[72:75]
    v_mfma_f32_16x16x32_bf16 v[76:79], v[156:159], v[136:139], v[76:79]
    v_mov_b32 v92, 152488
    s_mov_b32 s58, 0
gated_mix__ssm_conv_s5__linear_kernel_hedgehog__prompt_kernel_spin125:
    ds_read_b32 v93, v92
    s_waitcnt lgkmcnt(0)
    v_readfirstlane_b32 s57, v93
    s_nop 3
    s_cmp_ge_u32 s57, 1
    s_cbranch_scc1 gated_mix__ssm_conv_s5__linear_kernel_hedgehog__prompt_kernel_spun126
    s_add_u32 s58, s58, 1
    s_cmp_ge_u32 s58, 8000000
    s_cbranch_scc1 gated_mix__ssm_conv_s5__linear_kernel_hedgehog__prompt_kernel_spun126
    s_sleep 1
    s_branch gated_mix__ssm_conv_s5__linear_kernel_hedgehog__prompt_kernel_spin125
gated_mix__ssm_conv_s5__linear_kernel_hedgehog__prompt_kernel_spun126:
    s_lshl_b32 s56, s26, 10
    v_add_u32 v81, s56, v80
    s_add_u32 s56, s56, 4096
    buffer_load_dwordx4 v[124:127], v81, s[8:11], s44 offen sc1
    buffer_load_dwordx4 v[128:131], v81, s[8:11], s45 offen sc1
    buffer_load_dwordx4 v[132:135], v81, s[8:11], s46 offen sc1
    buffer_load_dwordx4 v[136:139], v81, s[8:11], s47 offen sc1
    s_waitcnt vmcnt(4)
    v_mfma_f32_16x16x32_bf16 v[0:3], v[176:179], v[160:163], v[0:3]
    v_mfma_f32_16x16x32_bf16 v[4:7], v[180:183], v[160:163], v[4:7]
    v_mfma_f32_16x16x32_bf16 v[8:11], v[184:187], v[160:163], v[8:11]
    v_mfma_f32_16x16x32_bf16 v[12:15], v[188:191], v[160:163], v[12:15]
    v_mfma_f32_16x16x32_bf16 v[16:19], v[192:195], v[160:163], v[16:19]
    v_mfma_f32_16x16x32_bf16 v[20:23], v[176:179], v[164:167], v[20:23]
    v_mfma_f32_16x16x32_bf16 v[24:27], v[180:183], v[164:167], v[24:27]
    v_mfma_f32_16x16x32_bf16 v[28:31], v[184:187], v[164:167], v[28:31]
    v_mfma_f32_16x16x32_bf16 v[32:35], v[188:191], v[164:167], v[32:35]
    v_mfma_f32_16x16x32_bf16 v[36:39], v[192:195], v[164:167], v[36:39]
    v_mfma_f32_16x16x32_bf16 v[40:43], v[176:179], v[168:171], v[40:43]
    v_mfma_f32_16x16x32_bf16 v[44:47], v[180:183], v[168:171], v[44:47]
    v_mfma_f32_16x16x32_bf16 v[48:51], v[184:187], v[168:171], v[48:51]
    v_mfma_f32_16x16x32_bf16 v[52:55], v[188:191], v[168:171], v[52:55]
    v_mfma_f32_16x16x32_bf16 v[56:59], v[192:195], v[168:171], v[56:59]
    v_mfma_f32_16x16x32_bf16 v[60:63], v[176:179], v[172:175], v[60:63]
    v_mfma_f32_16x16x32_bf16 v[64:67], v[180:183], v[172:175], v[64:67]
    v_mfma_f32_16x16x32_bf16 v[68:71], v[184:187], v[172:175], v[68:71]
    v_mfma_f32_16x16x32_bf16 v[72:75], v[188:191], v[172:175], v[72:75]
    v_mfma_f32_16x16x32_bf16 v[76:79], v[192:195], v[172:175], v[76:79]
    v_add_u32 v82, s56, v80
    s_add_u32 s56, s56, 4096
    buffer_load_dwordx4 v[160:163], v82, s[8:11], s44 offen sc1
    buffer_load_dwordx4 v[164:167], v82, s[8:11], s45 offen sc1
    buffer_load_dwordx4 v[168:171], v82, s[8:11], s46 offen sc1
    buffer_load_dwordx4 v[172:175], v82, s[8:11], s47 offen sc1
    v_pk_mul_f32 v[0:1], v[0:1], v[88:89] op_sel:[0,0] op_sel_hi:[1,0]
    v_pk_mul_f32 v[2:3], v[2:3], v[88:89] op_sel:[0,0] op_sel_hi:[1,0]
    v_pk_mul_f32 v[4:5], v[4:5], v[88:89] op_sel:[0,0] op_sel_hi:[1,0]
    v_pk_mul_f32 v[6:7], v[6:7], v[88:89] op_sel:[0,0] op_sel_hi:[1,0]
    v_pk_mul_f32 v[8:9], v[8:9], v[88:89] op_sel:[0,0] op_sel_hi:[1,0]
    v_pk_mul_f32 v[10:11], v[10:11], v[88:89] op_sel:[0,0] op_sel_hi:[1,0]
    v_pk_mul_f32 v[12:13], v[12:13], v[88:89] op_sel:[0,0] op_sel_hi:[1,0]
    v_pk_mul_f32 v[14:15], v[14:15], v[88:89] op_sel:[0,0] op_sel_hi:[1,0]
    v_pk_mul_f32 v[16:17], v[16:17], v[88:89] op_sel:[0,0] op_sel_hi:[1,0]
    v_pk_mul_f32 v[18:19], v[18:19], v[88:89] op_sel:[0,0] op_sel_hi:[1,0]
    v_pk_mul_f32 v[20:21], v[20:21], v[88:89] op_sel:[0,1] op_sel_hi:[1,1]
    v_pk_mul_f32 v[22:23], v[22:23], v[88:89] op_sel:[0,1] op_sel_hi:[1,1]
    v_pk_mul_f32 v[24:25], v[24:25], v[88:89] op_sel:[0,1] op_sel_hi:[1,1]
    v_pk_mul_f32 v[26:27], v[26:27], v[88:89] op_sel:[0,1] op_sel_hi:[1,1]
    v_pk_mul_f32 v[28:29], v[28:29], v[88:89] op_sel:[0,1] op_sel_hi:[1,1]
    v_pk_mul_f32 v[30:31], v[30:31], v[88:89] op_sel:[0,1] op_sel_hi:[1,1]
    v_pk_mul_f32 v[32:33], v[32:33], v[88:89] op_sel:[0,1] op_sel_hi:[1,1]
    v_pk_mul_f32 v[34:35], v[34:35], v[88:89] op_sel:[0,1] op_sel_hi:[1,1]
    v_pk_mul_f32 v[36:37], v[36:37], v[88:89] op_sel:[0,1] op_sel_hi:[1,1]
    v_pk_mul_f32 v[38:39], v[38:39], v[88:89] op_sel:[0,1] op_sel_hi:[1,1]
    v_pk_mul_f32 v[40:41], v[40:41], v[90:91] op_sel:[0,0] op_sel_hi:[1,0]
    v_pk_mul_f32 v[42:43], v[42:43], v[90:91] op_sel:[0,0] op_sel_hi:[1,0]
    v_pk_mul_f32 v[44:45], v[44:45], v[90:91] op_sel:[0,0] op_sel_hi:[1,0]
    v_pk_mul_f32 v[46:47], v[46:47], v[90:91] op_sel:[0,0] op_sel_hi:[1,0]
    v_pk_mul_f32 v[48:49], v[48:49], v[90:91] op_sel:[0,0] op_sel_hi:[1,0]
    v_pk_mul_f32 v[50:51], v[50:51], v[90:91] op_sel:[0,0] op_sel_hi:[1,0]
    v_pk_mul_f32 v[52:53], v[52:53], v[90:91] op_sel:[0,0] op_sel_hi:[1,0]
    v_pk_mul_f32 v[54:55], v[54:55], v[90:91] op_sel:[0,0] op_sel_hi:[1,0]
    v_pk_mul_f32 v[56:57], v[56:57], v[90:91] op_sel:[0,0] op_sel_hi:[1,0]
    v_pk_mul_f32 v[58:59], v[58:59], v[90:91] op_sel:[0,0] op_sel_hi:[1,0]
    v_pk_mul_f32 v[60:61], v[60:61], v[90:91] op_sel:[0,1] op_sel_hi:[1,1]
    v_pk_mul_f32 v[62:63], v[62:63], v[90:91] op_sel:[0,1] op_sel_hi:[1,1]
    v_pk_mul_f32 v[64:65], v[64:65], v[90:91] op_sel:[0,1] op_sel_hi:[1,1]
    v_pk_mul_f32 v[66:67], v[66:67], v[90:91] op_sel:[0,1] op_sel_hi:[1,1]
    v_pk_mul_f32 v[68:69], v[68:69], v[90:91] op_sel:[0,1] op_sel_hi:[1,1]
    v_pk_mul_f32 v[70:71], v[70:71], v[90:91] op_sel:[0,1] op_sel_hi:[1,1]
    v_pk_mul_f32 v[72:73], v[72:73], v[90:91] op_sel:[0,1] op_sel_hi:[1,1]
    v_pk_mul_f32 v[74:75], v[74:75], v[90:91] op_sel:[0,1] op_sel_hi:[1,1]
    v_pk_mul_f32 v[76:77], v[76:77], v[90:91] op_sel:[0,1] op_sel_hi:[1,1]
    v_pk_mul_f32 v[78:79], v[78:79], v[90:91] op_sel:[0,1] op_sel_hi:[1,1]
    s_waitcnt vmcnt(4)
    v_mfma_f32_16x16x32_bf16 v[0:3], v[196:199], v[124:127], v[0:3]
    v_mfma_f32_16x16x32_bf16 v[4:7], v[200:203], v[124:127], v[4:7]
    v_mfma_f32_16x16x32_bf16 v[8:11], v[204:207], v[124:127], v[8:11]
    v_mfma_f32_16x16x32_bf16 v[12:15], v[208:211], v[124:127], v[12:15]
    v_mfma_f32_16x16x32_bf16 v[16:19], v[212:215], v[124:127], v[16:19]
    v_mfma_f32_16x16x32_bf16 v[20:23], v[196:199], v[128:131], v[20:23]
    v_mfma_f32_16x16x32_bf16 v[24:27], v[200:203], v[128:131], v[24:27]
    v_mfma_f32_16x16x32_bf16 v[28:31], v[204:207], v[128:131], v[28:31]
    v_mfma_f32_16x16x32_bf16 v[32:35], v[208:211], v[128:131], v[32:35]
    v_mfma_f32_16x16x32_bf16 v[36:39], v[212:215], v[128:131], v[36:39]
    v_mfma_f32_16x16x32_bf16 v[40:43], v[196:199], v[132:135], v[40:43]
    v_mfma_f32_16x16x32_bf16 v[44:47], v[200:203], v[132:135], v[44:47]
    v_mfma_f32_16x16x32_bf16 v[48:51], v[204:207], v[132:135], v[48:51]
    v_mfma_f32_16x16x32_bf16 v[52:55], v[208:211], v[132:135], v[52:55]
    v_mfma_f32_16x16x32_bf16 v[56:59], v[212:215], v[132:135], v[56:59]
    v_mfma_f32_16x16x32_bf16 v[60:63], v[196:199], v[136:139], v[60:63]
    v_mfma_f32_16x16x32_bf16 v[64:67], v[200:203], v[136:139], v[64:67]
    v_mfma_f32_16x16x32_bf16 v[68:71], v[204:207], v[136:139], v[68:71]
    v_mfma_f32_16x16x32_bf16 v[72:75], v[208:211], v[136:139], v[72:75]
    v_mfma_f32_16x16x32_bf16 v[76:79], v[212:215], v[136:139], v[76:79]
    v_add_u32 v81, s56, v80
    s_add_u32 s56, s56, 4096
    buffer_load_dwordx4 v[124:127], v81, s[8:11], s44 offen sc1
    buffer_load_dwordx4 v[128:131], v81, s[8:11], s45 offen sc1
    buffer_load_dwordx4 v[132:135], v81, s[8:11], s46 offen sc1
    buffer_load_dwordx4 v[136:139], v81, s[8:11], s47 offen sc1
    s_waitcnt vmcnt(4)
    v_mfma_f32_16x16x32_bf16 v[0:3], v[216:219], v[160:163], v[0:3]
    v_mfma_f32_16x16x32_bf16 v[4:7], v[220:223], v[160:163], v[4:7]
    v_mfma_f32_16x16x32_bf16 v[8:11], v[224:227], v[160:163], v[8:11]
    v_mfma_f32_16x16x32_bf16 v[12:15], v[228:231], v[160:163], v[12:15]
    v_mfma_f32_16x16x32_bf16 v[16:19], v[232:235], v[160:163], v[16:19]
    v_mfma_f32_16x16x32_bf16 v[20:23], v[216:219], v[164:167], v[20:23]
    v_mfma_f32_16x16x32_bf16 v[24:27], v[220:223], v[164:167], v[24:27]
    v_mfma_f32_16x16x32_bf16 v[28:31], v[224:227], v[164:167], v[28:31]
    v_mfma_f32_16x16x32_bf16 v[32:35], v[228:231], v[164:167], v[32:35]
    v_mfma_f32_16x16x32_bf16 v[36:39], v[232:235], v[164:167], v[36:39]
    v_mfma_f32_16x16x32_bf16 v[40:43], v[216:219], v[168:171], v[40:43]
    v_mfma_f32_16x16x32_bf16 v[44:47], v[220:223], v[168:171], v[44:47]
    v_mfma_f32_16x16x32_bf16 v[48:51], v[224:227], v[168:171], v[48:51]
    v_mfma_f32_16x16x32_bf16 v[52:55], v[228:231], v[168:171], v[52:55]
    v_mfma_f32_16x16x32_bf16 v[56:59], v[232:235], v[168:171], v[56:59]
    v_mfma_f32_16x16x32_bf16 v[60:63], v[216:219], v[172:175], v[60:63]
    v_mfma_f32_16x16x32_bf16 v[64:67], v[220:223], v[172:175], v[64:67]
    v_mfma_f32_16x16x32_bf16 v[68:71], v[224:227], v[172:175], v[68:71]
    v_mfma_f32_16x16x32_bf16 v[72:75], v[228:231], v[172:175], v[72:75]
    v_mfma_f32_16x16x32_bf16 v[76:79], v[232:235], v[172:175], v[76:79]
    v_add_u32 v82, s56, v80
    s_add_u32 s56, s56, 4096
    buffer_load_dwordx4 v[160:163], v82, s[8:11], s44 offen sc1
    buffer_load_dwordx4 v[164:167], v82, s[8:11], s45 offen sc1
    buffer_load_dwordx4 v[168:171], v82, s[8:11], s46 offen sc1
    buffer_load_dwordx4 v[172:175], v82, s[8:11], s47 offen sc1
    buffer_load_dwordx4 v[176:179], v82, s[8:11], s48 offen sc1
    buffer_load_dwordx4 v[180:183], v82, s[8:11], s49 offen sc1
    buffer_load_dwordx4 v[184:187], v82, s[8:11], s50 offen sc1
    buffer_load_dwordx4 v[188:191], v82, s[8:11], s51 offen sc1
    buffer_load_dwordx4 v[192:195], v82, s[8:11], s52 offen sc1
    s_waitcnt vmcnt(9)
    v_mfma_f32_16x16x32_bf16 v[0:3], v[236:239], v[124:127], v[0:3]
    v_mfma_f32_16x16x32_bf16 v[4:7], v[240:243], v[124:127], v[4:7]
    v_mfma_f32_16x16x32_bf16 v[8:11], v[244:247], v[124:127], v[8:11]
    v_mfma_f32_16x16x32_bf16 v[12:15], v[248:251], v[124:127], v[12:15]
    v_mfma_f32_16x16x32_bf16 v[16:19], v[252:255], v[124:127], v[16:19]
    v_mfma_f32_16x16x32_bf16 v[20:23], v[236:239], v[128:131], v[20:23]
    v_mfma_f32_16x16x32_bf16 v[24:27], v[240:243], v[128:131], v[24:27]
    v_mfma_f32_16x16x32_bf16 v[28:31], v[244:247], v[128:131], v[28:31]
    v_mfma_f32_16x16x32_bf16 v[32:35], v[248:251], v[128:131], v[32:35]
    v_mfma_f32_16x16x32_bf16 v[36:39], v[252:255], v[128:131], v[36:39]
    v_mfma_f32_16x16x32_bf16 v[40:43], v[236:239], v[132:135], v[40:43]
    v_mfma_f32_16x16x32_bf16 v[44:47], v[240:243], v[132:135], v[44:47]
    v_mfma_f32_16x16x32_bf16 v[48:51], v[244:247], v[132:135], v[48:51]
    v_mfma_f32_16x16x32_bf16 v[52:55], v[248:251], v[132:135], v[52:55]
    v_mfma_f32_16x16x32_bf16 v[56:59], v[252:255], v[132:135], v[56:59]
    v_mfma_f32_16x16x32_bf16 v[60:63], v[236:239], v[136:139], v[60:63]
    v_mfma_f32_16x16x32_bf16 v[64:67], v[240:243], v[136:139], v[64:67]
    v_mfma_f32_16x16x32_bf16 v[68:71], v[244:247], v[136:139], v[68:71]
    v_mfma_f32_16x16x32_bf16 v[72:75], v[248:251], v[136:139], v[72:75]
    v_mfma_f32_16x16x32_bf16 v[76:79], v[252:255], v[136:139], v[76:79]
    v_add_u32 v81, s56, v80
    v_lshlrev_b32 v94, 3, v83
    v_add_u32 v94, s56, v94
    s_add_u32 s56, s56, 4096
    buffer_load_dwordx2 v[124:125], v94, s[8:11], s44 offen sc1
    buffer_load_dwordx2 v[126:127], v94, s[8:11], s44 offen offset:512 sc1
    buffer_load_dwordx2 v[128:129], v94, s[8:11], s45 offen sc1
    buffer_load_dwordx2 v[130:131], v94, s[8:11], s45 offen offset:512 sc1
    buffer_load_dwordx2 v[132:133], v94, s[8:11], s46 offen sc1
    buffer_load_dwordx2 v[134:135], v94, s[8:11], s46 offen offset:512 sc1
    buffer_load_dwordx2 v[136:137], v94, s[8:11], s47 offen sc1
    buffer_load_dwordx2 v[138:139], v94, s[8:11], s47 offen offset:512 sc1
    buffer_load_dwordx4 v[140:143], v81, s[8:11], s48 offen sc1
    buffer_load_dwordx4 v[144:147], v81, s[8:11], s49 offen sc1
    buffer_load_dwordx4 v[148:151], v81, s[8:11], s50 offen sc1
    buffer_load_dwordx4 v[152:155], v81, s[8:11], s51 offen sc1
    buffer_load_dwordx4 v[156:159], v81, s[8:11], s52 offen sc1
    s_waitcnt vmcnt(13)
    v_mfma_f32_16x16x32_bf16 v[0:3], v[176:179], v[160:163], v[0:3]
    v_mfma_f32_16x16x32_bf16 v[4:7], v[180:183], v[160:163], v[4:7]
    v_mfma_f32_16x16x32_bf16 v[8:11], v[184:187], v[160:163], v[8:11]
    v_mfma_f32_16x16x32_bf16 v[12:15], v[188:191], v[160:163], v[12:15]
    v_mfma_f32_16x16x32_bf16 v[16:19], v[192:195], v[160:163], v[16:19]
    v_mfma_f32_16x16x32_bf16 v[20:23], v[176:179], v[164:167], v[20:23]
    v_mfma_f32_16x16x32_bf16 v[24:27], v[180:183], v[164:167], v[24:27]
    v_mfma_f32_16x16x32_bf16 v[28:31], v[184:187], v[164:167], v[28:31]
    v_mfma_f32_16x16x32_bf16 v[32:35], v[188:191], v[164:167], v[32:35]
    v_mfma_f32_16x16x32_bf16 v[36:39], v[192:195], v[164:167], v[36:39]
    v_mfma_f32_16x16x32_bf16 v[40:43], v[176:179], v[168:171], v[40:43]
    v_mfma_f32_16x16x32_bf16 v[44:47], v[180:183], v[168:171], v[44:47]
    v_mfma_f32_16x16x32_bf16 v[48:51], v[184:187], v[168:171], v[48:51]
    v_mfma_f32_16x16x32_bf16 v[52:55], v[188:191], v[168:171], v[52:55]
    v_mfma_f32_16x16x32_bf16 v[56:59], v[192:195], v[168:171], v[56:59]
    v_mfma_f32_16x16x32_bf16 v[60:63], v[176:179], v[172:175], v[60:63]
    v_mfma_f32_16x16x32_bf16 v[64:67], v[180:183], v[172:175], v[64:67]
    v_mfma_f32_16x16x32_bf16 v[68:71], v[184:187], v[172:175], v[68:71]
    v_mfma_f32_16x16x32_bf16 v[72:75], v[188:191], v[172:175], v[72:75]
    v_mfma_f32_16x16x32_bf16 v[76:79], v[192:195], v[172:175], v[76:79]
    s_waitcnt vmcnt(0)
    v_mul_u32_u24 v94, 2560, v86
    v_lshl_add_u32 v94, v85, 4, v94
    s_mul_i32 s57, s63, 2560
    s_mul_i32 s58, s28, 320
    s_add_u32 s57, s57, s58
    s_cmp_lg_u32 s26, 0
    s_cbranch_scc1 gated_mix__ssm_conv_s5__linear_kernel_hedgehog__prompt_kernel_red1
    v_add_u32 v92, 40960, v80
    v_mfma_f32_16x16x32_bf16 v[20:23], v[140:143], v[128:131], v[20:23]
    v_mfma_f32_16x16x32_bf16 v[24:27], v[144:147], v[128:131], v[24:27]
    v_mfma_f32_16x16x32_bf16 v[28:31], v[148:151], v[128:131], v[28:31]
    v_mfma_f32_16x16x32_bf16 v[32:35], v[152:155], v[128:131], v[32:35]
    v_mfma_f32_16x16x32_bf16 v[36:39], v[156:159], v[128:131], v[36:39]
    v_mfma_f32_16x16x32_bf16 v[40:43], v[140:143], v[132:135], v[40:43]
    v_mfma_f32_16x16x32_bf16 v[44:47], v[144:147], v[132:135], v[44:47]
    v_mfma_f32_16x16x32_bf16 v[48:51], v[148:151], v[132:135], v[48:51]
    v_mfma_f32_16x16x32_bf16 v[52:55], v[152:155], v[132:135], v[52:55]
    v_mfma_f32_16x16x32_bf16 v[56:59], v[156:159], v[132:135], v[56:59]
    ds_write_b128 v80, v[20:23] offset:25600
    ds_write_b128 v80, v[24:27] offset:26624
    ds_write_b128 v80, v[28:31] offset:27648
    ds_write_b128 v80, v[32:35] offset:28672
    ds_write_b128 v80, v[36:39] offset:29696
    v_mfma_f32_16x16x32_bf16 v[60:63], v[140:143], v[136:139], v[60:63]
    v_mfma_f32_16x16x32_bf16 v[64:67], v[144:147], v[136:139], v[64:67]
    v_mfma_f32_16x16x32_bf16 v[68:71], v[148:151], v[136:139], v[68:71]
    v_mfma_f32_16x16x32_bf16 v[72:75], v[152:155], v[136:139], v[72:75]
    v_mfma_f32_16x16x32_bf16 v[76:79], v[156:159], v[136:139], v[76:79]
    ds_write_b128 v80, v[40:43] offset:35840
    ds_write_b128 v80, v[44:47] offset:36864
    ds_write_b128 v80, v[48:51] offset:37888
    ds_write_b128 v80, v[52:55] offset:38912
    ds_write_b128 v80, v[56:59] offset:39936
    v_mfma_f32_16x16x32_bf16 v[0:3], v[140:143], v[124:127], v[0:3]
    v_mfma_f32_16x16x32_bf16 v[4:7], v[144:147], v[124:127], v[4:7]
    v_mfma_f32_16x16x32_bf16 v[8:11], v[148:151], v[124:127], v[8:11]
    v_mfma_f32_16x16x32_bf16 v[12:15], v[152:155], v[124:127], v[12:15]
    v_mfma_f32_16x16x32_bf16 v[16:19], v[156:159], v[124:127], v[16:19]
    ds_write_b128 v92, v[60:63] offset:5120
    ds_write_b128 v92, v[64:67] offset:6144
    ds_write_b128 v92, v[68:71] offset:7168
    ds_write_b128 v92, v[72:75] offset:8192
    ds_write_b128 v92, v[76:79] offset:9216
    s_waitcnt lgkmcnt(0)
    s_barrier
    ds_read_b128 v[20:23], v80 offset:0
    ds_read_b128 v[24:27], v80 offset:1024
    ds_read_b128 v[28:31], v80 offset:2048
    ds_read_b128 v[32:35], v80 offset:3072
    ds_read_b128 v[36:39], v80 offset:4096
    ds_read_b128 v[40:43], v80 offset:5120
    ds_read_b128 v[44:47], v80 offset:6144
    ds_read_b128 v[48:51], v80 offset:7168
    ds_read_b128 v[52:55], v80 offset:8192
    ds_read_b128 v[56:59], v80 offset:9216
    ds_read_b128 v[60:63], v80 offset:10240
    ds_read_b128 v[64:67], v80 offset:11264
    ds_read_b128 v[68:71], v80 offset:12288
    ds_read_b128 v[72:75], v80 offset:13312
    ds_read_b128 v[76:79], v80 offset:14336
    s_waitcnt lgkmcnt(0)
    v_pk_add_f32 v[20:21], v[20:21], v[40:41]
    v_pk_add_f32 v[0:1], v[0:1], v[60:61]
    v_pk_add_f32 v[0:1], v[0:1], v[20:21]
    v_pk_add_f32 v[22:23], v[22:23], v[42:43]
    v_pk_add_f32 v[2:3], v[2:3], v[62:63]
    v_pk_add_f32 v[2:3], v[2:3], v[22:23]
    buffer_store_dwordx4 v[0:3], v94, s[12:15], s57 offen offset:0 nt
    v_pk_add_f32 v[24:25], v[24:25], v[44:45]
    v_pk_add_f32 v[4:5], v[4:5], v[64:65]
    v_pk_add_f32 v[4:5], v[4:5], v[24:25]
    v_pk_add_f32 v[26:27], v[26:27], v[46:47]
    v_pk_add_f32 v[6:7], v[6:7], v[66:67]
    v_pk_add_f32 v[6:7], v[6:7], v[26:27]
    buffer_store_dwordx4 v[4:7], v94, s[12:15], s57 offen offset:64 nt
    v_pk_add_f32 v[28:29], v[28:29], v[48:49]
    v_pk_add_f32 v[8:9], v[8:9], v[68:69]
    v_pk_add_f32 v[8:9], v[8:9], v[28:29]
    v_pk_add_f32 v[30:31], v[30:31], v[50:51]
    v_pk_add_f32 v[10:11], v[10:11], v[70:71]
    v_pk_add_f32 v[10:11], v[10:11], v[30:31]
    buffer_store_dwordx4 v[8:11], v94, s[12:15], s57 offen offset:128 nt
    v_pk_add_f32 v[32:33], v[32:33], v[52:53]
    v_pk_add_f32 v[12:13], v[12:13], v[72:73]
    v_pk_add_f32 v[12:13], v[12:13], v[32:33]
    v_pk_add_f32 v[34:35], v[34:35], v[54:55]
    v_pk_add_f32 v[14:15], v[14:15], v[74:75]
    v_pk_add_f32 v[14:15], v[14:15], v[34:35]
    buffer_store_dwordx4 v[12:15], v94, s[12:15], s57 offen offset:192 nt
    v_pk_add_f32 v[36:37], v[36:37], v[56:57]
    v_pk_add_f32 v[16:17], v[16:17], v[76:77]
    v_pk_add_f32 v[16:17], v[16:17], v[36:37]
    v_pk_add_f32 v[38:39], v[38:39], v[58:59]
    v_pk_add_f32 v[18:19], v[18:19], v[78:79]
    v_pk_add_f32 v[18:19], v[18:19], v[38:39]
    buffer_store_dwordx4 v[16:19], v94, s[12:15], s57 offen offset:256 nt
    s_branch gated_mix__ssm_conv_s5__linear_kernel_hedgehog__prompt_kernel_fin
gated_mix__ssm_conv_s5__linear_kernel_hedgehog__prompt_kernel_red1:
    s_cmp_lg_u32 s26, 1
    s_cbranch_scc1 gated_mix__ssm_conv_s5__linear_kernel_hedgehog__prompt_kernel_red2
    v_add_u32 v92, 40960, v80
    v_mfma_f32_16x16x32_bf16 v[0:3], v[140:143], v[124:127], v[0:3]
    v_mfma_f32_16x16x32_bf16 v[4:7], v[144:147], v[124:127], v[4:7]
    v_mfma_f32_16x16x32_bf16 v[8:11], v[148:151], v[124:127], v[8:11]
    v_mfma_f32_16x16x32_bf16 v[12:15], v[152:155], v[124:127], v[12:15]
    v_mfma_f32_16x16x32_bf16 v[16:19], v[156:159], v[124:127], v[16:19]
    v_mfma_f32_16x16x32_bf16 v[40:43], v[140:143], v[132:135], v[40:43]
    v_mfma_f32_16x16x32_bf16 v[44:47], v[144:147], v[132:135], v[44:47]
    v_mfma_f32_16x16x32_bf16 v[48:51], v[148:151], v[132:135], v[48:51]
    v_mfma_f32_16x16x32_bf16 v[52:55], v[152:155], v[132:135], v[52:55]
    v_mfma_f32_16x16x32_bf16 v[56:59], v[156:159], v[132:135], v[56:59]
    ds_write_b128 v80, v[0:3] offset:0
    ds_write_b128 v80, v[4:7] offset:1024
    ds_write_b128 v80, v[8:11] offset:2048
    ds_write_b128 v80, v[12:15] offset:3072
    ds_write_b128 v80, v[16:19] offset:4096
    v_mfma_f32_16x16x32_bf16 v[60:63], v[140:143], v[136:139], v[60:63]
    v_mfma_f32_16x16x32_bf16 v[64:67], v[144:147], v[136:139], v[64:67]
    v_mfma_f32_16x16x32_bf16 v[68:71], v[148:151], v[136:139], v[68:71]
    v_mfma_f32_16x16x32_bf16 v[72:75], v[152:155], v[136:139], v[72:75]
    v_mfma_f32_16x16x32_bf16 v[76:79], v[156:159], v[136:139], v[76:79]
    ds_write_b128 v92, v[40:43] offset:0
    ds_write_b128 v92, v[44:47] offset:1024
    ds_write_b128 v92, v[48:51] offset:2048
    ds_write_b128 v92, v[52:55] offset:3072
    ds_write_b128 v92, v[56:59] offset:4096
    v_mfma_f32_16x16x32_bf16 v[20:23], v[140:143], v[128:131], v[20:23]
    v_mfma_f32_16x16x32_bf16 v[24:27], v[144:147], v[128:131], v[24:27]
    v_mfma_f32_16x16x32_bf16 v[28:31], v[148:151], v[128:131], v[28:31]
    v_mfma_f32_16x16x32_bf16 v[32:35], v[152:155], v[128:131], v[32:35]
    v_mfma_f32_16x16x32_bf16 v[36:39], v[156:159], v[128:131], v[36:39]
    ds_write_b128 v92, v[60:63] offset:10240
    ds_write_b128 v92, v[64:67] offset:11264
    ds_write_b128 v92, v[68:71] offset:12288
    ds_write_b128 v92, v[72:75] offset:13312
    ds_write_b128 v92, v[76:79] offset:14336
    s_waitcnt lgkmcnt(0)
    s_barrier
    ds_read_b128 v[0:3], v80 offset:15360
    ds_read_b128 v[4:7], v80 offset:16384
    ds_read_b128 v[8:11], v80 offset:17408
    ds_read_b128 v[12:15], v80 offset:18432
    ds_read_b128 v[16:19], v80 offset:19456
    ds_read_b128 v[40:43], v80 offset:20480
    ds_read_b128 v[44:47], v80 offset:21504
    ds_read_b128 v[48:51], v80 offset:22528
    ds_read_b128 v[52:55], v80 offset:23552
    ds_read_b128 v[56:59], v80 offset:24576
    ds_read_b128 v[60:63], v80 offset:25600
    ds_read_b128 v[64:67], v80 offset:26624
    ds_read_b128 v[68:71], v80 offset:27648
    ds_read_b128 v[72:75], v80 offset:28672
    ds_read_b128 v[76:79], v80 offset:29696
    s_waitcnt lgkmcnt(0)
    v_pk_add_f32 v[0:1], v[0:1], v[40:41]
    v_pk_add_f32 v[20:21], v[20:21], v[60:61]
    v_pk_add_f32 v[20:21], v[20:21], v[0:1]
    v_pk_add_f32 v[2:3], v[2:3], v[42:43]
    v_pk_add_f32 v[22:23], v[22:23], v[62:63]
    v_pk_add_f32 v[22:23], v[22:23], v[2:3]
    buffer_store_dwordx4 v[20:23], v94, s[12:15], s57 offen offset:0 nt
    v_pk_add_f32 v[4:5], v[4:5], v[44:45]
    v_pk_add_f32 v[24:25], v[24:25], v[64:65]
    v_pk_add_f32 v[24:25], v[24:25], v[4:5]
    v_pk_add_f32 v[6:7], v[6:7], v[46:47]
    v_pk_add_f32 v[26:27], v[26:27], v[66:67]
    v_pk_add_f32 v[26:27], v[26:27], v[6:7]
    buffer_store_dwordx4 v[24:27], v94, s[12:15], s57 offen offset:64 nt
    v_pk_add_f32 v[8:9], v[8:9], v[48:49]
    v_pk_add_f32 v[28:29], v[28:29], v[68:69]
    v_pk_add_f32 v[28:29], v[28:29], v[8:9]
    v_pk_add_f32 v[10:11], v[10:11], v[50:51]
    v_pk_add_f32 v[30:31], v[30:31], v[70:71]
    v_pk_add_f32 v[30:31], v[30:31], v[10:11]
    buffer_store_dwordx4 v[28:31], v94, s[12:15], s57 offen offset:128 nt
    v_pk_add_f32 v[12:13], v[12:13], v[52:53]
    v_pk_add_f32 v[32:33], v[32:33], v[72:73]
    v_pk_add_f32 v[32:33], v[32:33], v[12:13]
    v_pk_add_f32 v[14:15], v[14:15], v[54:55]
    v_pk_add_f32 v[34:35], v[34:35], v[74:75]
    v_pk_add_f32 v[34:35], v[34:35], v[14:15]
    buffer_store_dwordx4 v[32:35], v94, s[12:15], s57 offen offset:192 nt
    v_pk_add_f32 v[16:17], v[16:17], v[56:57]
    v_pk_add_f32 v[36:37], v[36:37], v[76:77]
    v_pk_add_f32 v[36:37], v[36:37], v[16:17]
    v_pk_add_f32 v[18:19], v[18:19], v[58:59]
    v_pk_add_f32 v[38:39], v[38:39], v[78:79]
    v_pk_add_f32 v[38:39], v[38:39], v[18:19]
    buffer_store_dwordx4 v[36:39], v94, s[12:15], s57 offen offset:256 nt
    s_branch gated_mix__ssm_conv_s5__linear_kernel_hedgehog__prompt_kernel_fin
gated_mix__ssm_conv_s5__linear_kernel_hedgehog__prompt_kernel_red2:
    s_cmp_lg_u32 s26, 2
    s_cbranch_scc1 gated_mix__ssm_conv_s5__linear_kernel_hedgehog__prompt_kernel_red3
    v_add_u32 v92, 40960, v80
    v_mfma_f32_16x16x32_bf16 v[0:3], v[140:143], v[124:127], v[0:3]
    v_mfma_f32_16x16x32_bf16 v[4:7], v[144:147], v[124:127], v[4:7]
    v_mfma_f32_16x16x32_bf16 v[8:11], v[148:151], v[124:127], v[8:11]
    v_mfma_f32_16x16x32_bf16 v[12:15], v[152:155], v[124:127], v[12:15]
    v_mfma_f32_16x16x32_bf16 v[16:19], v[156:159], v[124:127], v[16:19]
    v_mfma_f32_16x16x32_bf16 v[20:23], v[140:143], v[128:131], v[20:23]
    v_mfma_f32_16x16x32_bf16 v[24:27], v[144:147], v[128:131], v[24:27]
    v_mfma_f32_16x16x32_bf16 v[28:31], v[148:151], v[128:131], v[28:31]
    v_mfma_f32_16x16x32_bf16 v[32:35], v[152:155], v[128:131], v[32:35]
    v_mfma_f32_16x16x32_bf16 v[36:39], v[156:159], v[128:131], v[36:39]
    ds_write_b128 v80, v[0:3] offset:5120
    ds_write_b128 v80, v[4:7] offset:6144
    ds_write_b128 v80, v[8:11] offset:7168
    ds_write_b128 v80, v[12:15] offset:8192
    ds_write_b128 v80, v[16:19] offset:9216
    v_mfma_f32_16x16x32_bf16 v[60:63], v[140:143], v[136:139], v[60:63]
    v_mfma_f32_16x16x32_bf16 v[64:67], v[144:147], v[136:139], v[64:67]
    v_mfma_f32_16x16x32_bf16 v[68:71], v[148:151], v[136:139], v[68:71]
    v_mfma_f32_16x16x32_bf16 v[72:75], v[152:155], v[136:139], v[72:75]
    v_mfma_f32_16x16x32_bf16 v[76:79], v[156:159], v[136:139], v[76:79]
    ds_write_b128 v80, v[20:23] offset:15360
    ds_write_b128 v80, v[24:27] offset:16384
    ds_write_b128 v80, v[28:31] offset:17408
    ds_write_b128 v80, v[32:35] offset:18432
    ds_write_b128 v80, v[36:39] offset:19456
    v_mfma_f32_16x16x32_bf16 v[40:43], v[140:143], v[132:135], v[40:43]
    v_mfma_f32_16x16x32_bf16 v[44:47], v[144:147], v[132:135], v[44:47]
    v_mfma_f32_16x16x32_bf16 v[48:51], v[148:151], v[132:135], v[48:51]
    v_mfma_f32_16x16x32_bf16 v[52:55], v[152:155], v[132:135], v[52:55]
    v_mfma_f32_16x16x32_bf16 v[56:59], v[156:159], v[132:135], v[56:59]
    ds_write_b128 v92, v[60:63] offset:15360
    ds_write_b128 v92, v[64:67] offset:16384
    ds_write_b128 v92, v[68:71] offset:17408
    ds_write_b128 v92, v[72:75] offset:18432
    ds_write_b128 v92, v[76:79] offset:19456
    s_waitcnt lgkmcnt(0)
    s_barrier
    ds_read_b128 v[0:3], v80 offset:30720
    ds_read_b128 v[4:7], v80 offset:31744
    ds_read_b128 v[8:11], v80 offset:32768
    ds_read_b128 v[12:15], v80 offset:33792
    ds_read_b128 v[16:19], v80 offset:34816
    ds_read_b128 v[20:23], v80 offset:35840
    ds_read_b128 v[24:27], v80 offset:36864
    ds_read_b128 v[28:31], v80 offset:37888
    ds_read_b128 v[32:35], v80 offset:38912
    ds_read_b128 v[36:39], v80 offset:39936
    ds_read_b128 v[60:63], v92 offset:0
    ds_read_b128 v[64:67], v92 offset:1024
    ds_read_b128 v[68:71], v92 offset:2048
    ds_read_b128 v[72:75], v92 offset:3072
    ds_read_b128 v[76:79], v92 offset:4096
    s_waitcnt lgkmcnt(0)
    v_pk_add_f32 v[0:1], v[0:1], v[20:21]
    v_pk_add_f32 v[40:41], v[40:41], v[60:61]
    v_pk_add_f32 v[40:41], v[40:41], v[0:1]
    v_pk_add_f32 v[2:3], v[2:3], v[22:23]
    v_pk_add_f32 v[42:43], v[42:43], v[62:63]
    v_pk_add_f32 v[42:43], v[42:43], v[2:3]
    buffer_store_dwordx4 v[40:43], v94, s[12:15], s57 offen offset:0 nt
    v_pk_add_f32 v[4:5], v[4:5], v[24:25]
    v_pk_add_f32 v[44:45], v[44:45], v[64:65]
    v_pk_add_f32 v[44:45], v[44:45], v[4:5]
    v_pk_add_f32 v[6:7], v[6:7], v[26:27]
    v_pk_add_f32 v[46:47], v[46:47], v[66:67]
    v_pk_add_f32 v[46:47], v[46:47], v[6:7]
    buffer_store_dwordx4 v[44:47], v94, s[12:15], s57 offen offset:64 nt
    v_pk_add_f32 v[8:9], v[8:9], v[28:29]
    v_pk_add_f32 v[48:49], v[48:49], v[68:69]
    v_pk_add_f32 v[48:49], v[48:49], v[8:9]
    v_pk_add_f32 v[10:11], v[10:11], v[30:31]
    v_pk_add_f32 v[50:51], v[50:51], v[70:71]
    v_pk_add_f32 v[50:51], v[50:51], v[10:11]
    buffer_store_dwordx4 v[48:51], v94, s[12:15], s57 offen offset:128 nt
    v_pk_add_f32 v[12:13], v[12:13], v[32:33]
    v_pk_add_f32 v[52:53], v[52:53], v[72:73]
    v_pk_add_f32 v[52:53], v[52:53], v[12:13]
    v_pk_add_f32 v[14:15], v[14:15], v[34:35]
    v_pk_add_f32 v[54:55], v[54:55], v[74:75]
    v_pk_add_f32 v[54:55], v[54:55], v[14:15]
    buffer_store_dwordx4 v[52:55], v94, s[12:15], s57 offen offset:192 nt
    v_pk_add_f32 v[16:17], v[16:17], v[36:37]
    v_pk_add_f32 v[56:57], v[56:57], v[76:77]
    v_pk_add_f32 v[56:57], v[56:57], v[16:17]
    v_pk_add_f32 v[18:19], v[18:19], v[38:39]
    v_pk_add_f32 v[58:59], v[58:59], v[78:79]
    v_pk_add_f32 v[58:59], v[58:59], v[18:19]
    buffer_store_dwordx4 v[56:59], v94, s[12:15], s57 offen offset:256 nt
    s_branch gated_mix__ssm_conv_s5__linear_kernel_hedgehog__prompt_kernel_fin
gated_mix__ssm_conv_s5__linear_kernel_hedgehog__prompt_kernel_red3:
    v_add_u32 v92, 40960, v80
    v_mfma_f32_16x16x32_bf16 v[0:3], v[140:143], v[124:127], v[0:3]
    v_mfma_f32_16x16x32_bf16 v[4:7], v[144:147], v[124:127], v[4:7]
    v_mfma_f32_16x16x32_bf16 v[8:11], v[148:151], v[124:127], v[8:11]
    v_mfma_f32_16x16x32_bf16 v[12:15], v[152:155], v[124:127], v[12:15]
    v_mfma_f32_16x16x32_bf16 v[16:19], v[156:159], v[124:127], v[16:19]
    v_mfma_f32_16x16x32_bf16 v[20:23], v[140:143], v[128:131], v[20:23]
    v_mfma_f32_16x16x32_bf16 v[24:27], v[144:147], v[128:131], v[24:27]
    v_mfma_f32_16x16x32_bf16 v[28:31], v[148:151], v[128:131], v[28:31]
    v_mfma_f32_16x16x32_bf16 v[32:35], v[152:155], v[128:131], v[32:35]
    v_mfma_f32_16x16x32_bf16 v[36:39], v[156:159], v[128:131], v[36:39]
    ds_write_b128 v80, v[0:3] offset:10240
    ds_write_b128 v80, v[4:7] offset:11264
    ds_write_b128 v80, v[8:11] offset:12288
    ds_write_b128 v80, v[12:15] offset:13312
    ds_write_b128 v80, v[16:19] offset:14336
    v_mfma_f32_16x16x32_bf16 v[40:43], v[140:143], v[132:135], v[40:43]
    v_mfma_f32_16x16x32_bf16 v[44:47], v[144:147], v[132:135], v[44:47]
    v_mfma_f32_16x16x32_bf16 v[48:51], v[148:151], v[132:135], v[48:51]
    v_mfma_f32_16x16x32_bf16 v[52:55], v[152:155], v[132:135], v[52:55]
    v_mfma_f32_16x16x32_bf16 v[56:59], v[156:159], v[132:135], v[56:59]
    ds_write_b128 v80, v[20:23] offset:20480
    ds_write_b128 v80, v[24:27] offset:21504
    ds_write_b128 v80, v[28:31] offset:22528
    ds_write_b128 v80, v[32:35] offset:23552
    ds_write_b128 v80, v[36:39] offset:24576
    v_mfma_f32_16x16x32_bf16 v[60:63], v[140:143], v[136:139], v[60:63]
    v_mfma_f32_16x16x32_bf16 v[64:67], v[144:147], v[136:139], v[64:67]
    v_mfma_f32_16x16x32_bf16 v[68:71], v[148:151], v[136:139], v[68:71]
    v_mfma_f32_16x16x32_bf16 v[72:75], v[152:155], v[136:139], v[72:75]
    v_mfma_f32_16x16x32_bf16 v[76:79], v[156:159], v[136:139], v[76:79]
    ds_write_b128 v80, v[40:43] offset:30720
    ds_write_b128 v80, v[44:47] offset:31744
    ds_write_b128 v80, v[48:51] offset:32768
    ds_write_b128 v80, v[52:55] offset:33792
    ds_write_b128 v80, v[56:59] offset:34816
    s_waitcnt lgkmcnt(0)
    s_barrier
    ds_read_b128 v[0:3], v92 offset:5120
    ds_read_b128 v[4:7], v92 offset:6144
    ds_read_b128 v[8:11], v92 offset:7168
    ds_read_b128 v[12:15], v92 offset:8192
    ds_read_b128 v[16:19], v92 offset:9216
    ds_read_b128 v[20:23], v92 offset:10240
    ds_read_b128 v[24:27], v92 offset:11264
    ds_read_b128 v[28:31], v92 offset:12288
    ds_read_b128 v[32:35], v92 offset:13312
    ds_read_b128 v[36:39], v92 offset:14336
    ds_read_b128 v[40:43], v92 offset:15360
    ds_read_b128 v[44:47], v92 offset:16384
    ds_read_b128 v[48:51], v92 offset:17408
    ds_read_b128 v[52:55], v92 offset:18432
    ds_read_b128 v[56:59], v92 offset:19456
    s_waitcnt lgkmcnt(0)
    v_pk_add_f32 v[0:1], v[0:1], v[20:21]
    v_pk_add_f32 v[60:61], v[60:61], v[40:41]
    v_pk_add_f32 v[60:61], v[60:61], v[0:1]
    v_pk_add_f32 v[2:3], v[2:3], v[22:23]
    v_pk_add_f32 v[62:63], v[62:63], v[42:43]
    v_pk_add_f32 v[62:63], v[62:63], v[2:3]
    buffer_store_dwordx4 v[60:63], v94, s[12:15], s57 offen offset:0 nt
    v_pk_add_f32 v[4:5], v[4:5], v[24:25]
    v_pk_add_f32 v[64:65], v[64:65], v[44:45]
    v_pk_add_f32 v[64:65], v[64:65], v[4:5]
    v_pk_add_f32 v[6:7], v[6:7], v[26:27]
    v_pk_add_f32 v[66:67], v[66:67], v[46:47]
    v_pk_add_f32 v[66:67], v[66:67], v[6:7]
    buffer_store_dwordx4 v[64:67], v94, s[12:15], s57 offen offset:64 nt
    v_pk_add_f32 v[8:9], v[8:9], v[28:29]
    v_pk_add_f32 v[68:69], v[68:69], v[48:49]
    v_pk_add_f32 v[68:69], v[68:69], v[8:9]
    v_pk_add_f32 v[10:11], v[10:11], v[30:31]
    v_pk_add_f32 v[70:71], v[70:71], v[50:51]
    v_pk_add_f32 v[70:71], v[70:71], v[10:11]
    buffer_store_dwordx4 v[68:71], v94, s[12:15], s57 offen offset:128 nt
    v_pk_add_f32 v[12:13], v[12:13], v[32:33]
    v_pk_add_f32 v[72:73], v[72:73], v[52:53]
    v_pk_add_f32 v[72:73], v[72:73], v[12:13]
    v_pk_add_f32 v[14:15], v[14:15], v[34:35]
    v_pk_add_f32 v[74:75], v[74:75], v[54:55]
    v_pk_add_f32 v[74:75], v[74:75], v[14:15]
    buffer_store_dwordx4 v[72:75], v94, s[12:15], s57 offen offset:192 nt
    v_pk_add_f32 v[16:17], v[16:17], v[36:37]
    v_pk_add_f32 v[76:77], v[76:77], v[56:57]
    v_pk_add_f32 v[76:77], v[76:77], v[16:17]
    v_pk_add_f32 v[18:19], v[18:19], v[38:39]
    v_pk_add_f32 v[78:79], v[78:79], v[58:59]
    v_pk_add_f32 v[78:79], v[78:79], v[18:19]
    buffer_store_dwordx4 v[76:79], v94, s[12:15], s57 offen offset:256 nt
    s_branch gated_mix__ssm_conv_s5__linear_kernel_hedgehog__prompt_kernel_fin
gated_mix__ssm_conv_s5__linear_kernel_hedgehog__prompt_kernel_ojob:
    s_load_dwordx2 s[4:5], s[0:1], 128
    s_mov_b32 s31, s3
    s_and_b32 s57, s2, 7
    s_lshr_b32 s58, s2, 3
    s_and_b32 s28, s58, 7
    s_lshr_b32 s53, s58, 3
    s_lshl_b32 s27, s57, 2
    s_add_u32 s27, s27, s53
    s_xor_b32 s53, s53, s28
    s_and_b32 s53, s53, 1
    s_and_b32 s29, s58, 3
    s_lshl_b32 s57, s57, 2
    s_add_u32 s29, s29, s57
    s_lshr_b32 s30, s58, 2
    v_mov_b32 v83, v194
    v_mov_b32 v87, v197
    v_lshlrev_b32 v80, 4, v83
    v_and_b32 v84, 15, v83
    v_lshrrev_b32 v85, 4, v83
    v_mov_b32 v60, v250
    v_mov_b32 v61, v251
    v_mov_b32 v62, v250
    v_mov_b32 v63, v251
    s_waitcnt lgkmcnt(0)
    s_mov_b32 s8, s4
    s_and_b32 s9, s5, 0xffff
    s_mov_b32 s10, 20971520
    s_mov_b32 s11, 0x20000
    v_mov_b32 v64, 0
    v_mov_b32 v65, 0
    v_mov_b32 v66, 0
    v_mov_b32 v67, 0
    v_lshlrev_b32 v68, 4, v87
    v_add_u32 v68, 137856, v68
    v_mov_b32 v69, 137856
    v_cmp_gt_u32 vcc, 112, v87
    s_nop 1
    v_cndmask_b32 v68, v69, v68, vcc
    ds_write_b128 v68, v[64:67]
    v_lshlrev_b32 v81, 4, v87
    v_mov_b32 v82, 0x7fffffff
    v_cmp_gt_u32 vcc, 210, v87
    s_nop 1
    v_cndmask_b32 v81, v82, v81, vcc
    s_nop 0
    s_mov_b64 s[62:63], vcc
    s_lshl_b32 s54, s29, 16
    s_add_u32 s54, s54, 18874368
    s_mov_b32 s55, 0
gated_mix__ssm_conv_s5__linear_kernel_hedgehog__prompt_kernel_kvp127:
    s_add_u32 s58, s54, 0
    buffer_load_dwordx4 v[92:95], v81, s[8:11], s58 offen sc1
    s_add_u32 s59, s54, 4096
    buffer_load_dwordx4 v[96:99], v81, s[8:11], s59 offen sc1
    s_add_u32 s58, s54, 8192
    buffer_load_dwordx4 v[100:103], v81, s[8:11], s58 offen sc1
    s_add_u32 s59, s54, 12288
    buffer_load_dwordx4 v[104:107], v81, s[8:11], s59 offen sc1
    s_add_u32 s58, s54, 16384
    buffer_load_dwordx4 v[108:111], v81, s[8:11], s58 offen sc1
    s_add_u32 s59, s54, 20480
    buffer_load_dwordx4 v[112:115], v81, s[8:11], s59 offen sc1
    s_add_u32 s58, s54, 24576
    buffer_load_dwordx4 v[116:119], v81, s[8:11], s58 offen sc1
    s_add_u32 s59, s54, 28672
    buffer_load_dwordx4 v[120:123], v81, s[8:11], s59 offen sc1
    s_add_u32 s58, s54, 32768
    buffer_load_dwordx4 v[124:127], v81, s[8:11], s58 offen sc1
    s_add_u32 s59, s54, 36864
    buffer_load_dwordx4 v[128:131], v81, s[8:11], s59 offen sc1
    s_add_u32 s58, s54, 40960
    buffer_load_dwordx4 v[132:135], v81, s[8:11], s58 offen sc1
    s_add_u32 s59, s54, 45056
    buffer_load_dwordx4 v[136:139], v81, s[8:11], s59 offen sc1
    s_add_u32 s58, s54, 49152
    buffer_load_dwordx4 v[140:143], v81, s[8:11], s58 offen sc1
    s_add_u32 s59, s54, 53248
    buffer_load_dwordx4 v[144:147], v81, s[8:11], s59 offen sc1
    s_add_u32 s58, s54, 57344
    buffer_load_dwordx4 v[148:151], v81, s[8:11], s58 offen sc1
    s_add_u32 s59, s54, 61440
    buffer_load_dwordx4 v[152:155], v81, s[8:11], s59 offen sc1
gated_mix__ssm_conv_s5__linear_kernel_hedgehog__prompt_kernel_kv1129:
    s_waitcnt vmcnt(0)
    s_mov_b64 s[6:7], 0
    v_cmp_ne_u64 vcc, v[94:95], v[60:61]
    s_nop 3
    s_or_b64 s[6:7], s[6:7], vcc
    v_cmp_ne_u64 vcc, v[98:99], v[60:61]
    s_nop 3
    s_or_b64 s[6:7], s[6:7], vcc
    v_cmp_ne_u64 vcc, v[102:103], v[60:61]
    s_nop 3
    s_or_b64 s[6:7], s[6:7], vcc
    v_cmp_ne_u64 vcc, v[106:107], v[60:61]
    s_nop 3
    s_or_b64 s[6:7], s[6:7], vcc
    v_cmp_ne_u64 vcc, v[110:111], v[60:61]
    s_nop 3
    s_or_b64 s[6:7], s[6:7], vcc
    v_cmp_ne_u64 vcc, v[114:115], v[60:61]
    s_nop 3
    s_or_b64 s[6:7], s[6:7], vcc
    v_cmp_ne_u64 vcc, v[118:119], v[60:61]
    s_nop 3
    s_or_b64 s[6:7], s[6:7], vcc
    v_cmp_ne_u64 vcc, v[122:123], v[60:61]
    s_nop 3
    s_or_b64 s[6:7], s[6:7], vcc
    v_cmp_ne_u64 vcc, v[126:127], v[60:61]
    s_nop 3
    s_or_b64 s[6:7], s[6:7], vcc
    v_cmp_ne_u64 vcc, v[130:131], v[60:61]
    s_nop 3
    s_or_b64 s[6:7], s[6:7], vcc
    v_cmp_ne_u64 vcc, v[134:135], v[60:61]
    s_nop 3
    s_or_b64 s[6:7], s[6:7], vcc
    v_cmp_ne_u64 vcc, v[138:139], v[60:61]
    s_nop 3
    s_or_b64 s[6:7], s[6:7], vcc
    v_cmp_ne_u64 vcc, v[142:143], v[60:61]
    s_nop 3
    s_or_b64 s[6:7], s[6:7], vcc
    v_cmp_ne_u64 vcc, v[146:147], v[60:61]
    s_nop 3
    s_or_b64 s[6:7], s[6:7], vcc
    v_cmp_ne_u64 vcc, v[150:151], v[60:61]
    s_nop 3
    s_or_b64 s[6:7], s[6:7], vcc
    v_cmp_ne_u64 vcc, v[154:155], v[60:61]
    s_nop 3
    s_or_b64 s[6:7], s[6:7], vcc
    s_and_b64 s[6:7], s[6:7], s[62:63]
    s_cmp_eq_u64 s[6:7], 0
    s_cbranch_scc1 gated_mix__ssm_conv_s5__linear_kernel_hedgehog__prompt_kernel_kvok128
    s_add_u32 s55, s55, 1
    s_cmp_lt_u32 s55, 400000
    s_cbranch_scc1 gated_mix__ssm_conv_s5__linear_kernel_hedgehog__prompt_kernel_kvp127
gated_mix__ssm_conv_s5__linear_kernel_hedgehog__prompt_kernel_kvok128:
    s_cmp_lg_u32 s31, 0
    s_cbranch_scc1 gated_mix__ssm_conv_s5__linear_kernel_hedgehog__prompt_kernel_noto1130
    s_lshl_b32 s57, s30, 5
    v_and_b32 v70, 31, v83
    v_add_u32 v70, s57, v70
    v_lshlrev_b32 v70, 7, v70
    v_add_u32 v70, 18219008, v70
    s_mov_b32 s57, 0
gated_mix__ssm_conv_s5__linear_kernel_hedgehog__prompt_kernel_poll131:
    buffer_load_dwordx2 v[72:73], v70, s[8:11], 0 offen sc1
    s_waitcnt vmcnt(0)
    v_cmp_ne_u64 vcc, v[72:73], v[60:61]
    s_nop 3
    s_cmp_eq_u64 vcc, 0
    s_cbranch_scc1 gated_mix__ssm_conv_s5__linear_kernel_hedgehog__prompt_kernel_polled132
    s_add_u32 s57, s57, 1
    s_cmp_ge_u32 s57, 400000
    s_cbranch_scc1 gated_mix__ssm_conv_s5__linear_kernel_hedgehog__prompt_kernel_polled132
    s_sleep 1
    s_branch gated_mix__ssm_conv_s5__linear_kernel_hedgehog__prompt_kernel_poll131
gated_mix__ssm_conv_s5__linear_kernel_hedgehog__prompt_kernel_polled132:
    v_mov_b32 v72, 152476
    v_mov_b32 v73, 1
    ds_write_b32 v72, v73
gated_mix__ssm_conv_s5__linear_kernel_hedgehog__prompt_kernel_noto1130:
    v_lshlrev_b32 v160, 16, v92
    v_and_b32 v161, 0xffff0000, v92
    v_lshlrev_b32 v162, 16, v93
    v_and_b32 v163, 0xffff0000, v93
    v_lshlrev_b32 v74, 16, v96
    v_and_b32 v75, 0xffff0000, v96
    v_lshlrev_b32 v76, 16, v97
    v_and_b32 v77, 0xffff0000, v97
    v_pk_add_f32 v[160:161], v[160:161], v[74:75]
    v_pk_add_f32 v[162:163], v[162:163], v[76:77]
    v_lshlrev_b32 v70, 16, v100
    v_and_b32 v71, 0xffff0000, v100
    v_lshlrev_b32 v72, 16, v101
    v_and_b32 v73, 0xffff0000, v101
    v_pk_add_f32 v[160:161], v[160:161], v[70:71]
    v_pk_add_f32 v[162:163], v[162:163], v[72:73]
    v_lshlrev_b32 v74, 16, v104
    v_and_b32 v75, 0xffff0000, v104
    v_lshlrev_b32 v76, 16, v105
    v_and_b32 v77, 0xffff0000, v105
    v_pk_add_f32 v[160:161], v[160:161], v[74:75]
    v_pk_add_f32 v[162:163], v[162:163], v[76:77]
    v_lshlrev_b32 v70, 16, v108
    v_and_b32 v71, 0xffff0000, v108
    v_lshlrev_b32 v72, 16, v109
    v_and_b32 v73, 0xffff0000, v109
    v_pk_add_f32 v[160:161], v[160:161], v[70:71]
    v_pk_add_f32 v[162:163], v[162:163], v[72:73]
    v_lshlrev_b32 v74, 16, v112
    v_and_b32 v75, 0xffff0000, v112
    v_lshlrev_b32 v76, 16, v113
    v_and_b32 v77, 0xffff0000, v113
    v_pk_add_f32 v[160:161], v[160:161], v[74:75]
    v_pk_add_f32 v[162:163], v[162:163], v[76:77]
    v_lshlrev_b32 v70, 16, v116
    v_and_b32 v71, 0xffff0000, v116
    v_lshlrev_b32 v72, 16, v117
    v_and_b32 v73, 0xffff0000, v117
    v_pk_add_f32 v[160:161], v[160:161], v[70:71]
    v_pk_add_f32 v[162:163], v[162:163], v[72:73]
    v_lshlrev_b32 v74, 16, v120
    v_and_b32 v75, 0xffff0000, v120
    v_lshlrev_b32 v76, 16, v121
    v_and_b32 v77, 0xffff0000, v121
    v_pk_add_f32 v[160:161], v[160:161], v[74:75]
    v_pk_add_f32 v[162:163], v[162:163], v[76:77]
    v_lshlrev_b32 v70, 16, v124
    v_and_b32 v71, 0xffff0000, v124
    v_lshlrev_b32 v72, 16, v125
    v_and_b32 v73, 0xffff0000, v125
    v_pk_add_f32 v[160:161], v[160:161], v[70:71]
    v_pk_add_f32 v[162:163], v[162:163], v[72:73]
    v_lshlrev_b32 v74, 16, v128
    v_and_b32 v75, 0xffff0000, v128
    v_lshlrev_b32 v76, 16, v129
    v_and_b32 v77, 0xffff0000, v129
    v_pk_add_f32 v[160:161], v[160:161], v[74:75]
    v_pk_add_f32 v[162:163], v[162:163], v[76:77]
    v_lshlrev_b32 v70, 16, v132
    v_and_b32 v71, 0xffff0000, v132
    v_lshlrev_b32 v72, 16, v133
    v_and_b32 v73, 0xffff0000, v133
    v_pk_add_f32 v[160:161], v[160:161], v[70:71]
    v_pk_add_f32 v[162:163], v[162:163], v[72:73]
    v_lshlrev_b32 v74, 16, v136
    v_and_b32 v75, 0xffff0000, v136
    v_lshlrev_b32 v76, 16, v137
    v_and_b32 v77, 0xffff0000, v137
    v_pk_add_f32 v[160:161], v[160:161], v[74:75]
    v_pk_add_f32 v[162:163], v[162:163], v[76:77]
    v_lshlrev_b32 v70, 16, v140
    v_and_b32 v71, 0xffff0000, v140
    v_lshlrev_b32 v72, 16, v141
    v_and_b32 v73, 0xffff0000, v141
    v_pk_add_f32 v[160:161], v[160:161], v[70:71]
    v_pk_add_f32 v[162:163], v[162:163], v[72:73]
    v_lshlrev_b32 v74, 16, v144
    v_and_b32 v75, 0xffff0000, v144
    v_lshlrev_b32 v76, 16, v145
    v_and_b32 v77, 0xffff0000, v145
    v_pk_add_f32 v[160:161], v[160:161], v[74:75]
    v_pk_add_f32 v[162:163], v[162:163], v[76:77]
    v_lshlrev_b32 v70, 16, v148
    v_and_b32 v71, 0xffff0000, v148
    v_lshlrev_b32 v72, 16, v149
    v_and_b32 v73, 0xffff0000, v149
    v_pk_add_f32 v[160:161], v[160:161], v[70:71]
    v_pk_add_f32 v[162:163], v[162:163], v[72:73]
    v_lshlrev_b32 v74, 16, v152
    v_and_b32 v75, 0xffff0000, v152
    v_lshlrev_b32 v76, 16, v153
    v_and_b32 v77, 0xffff0000, v153
    v_pk_add_f32 v[160:161], v[160:161], v[74:75]
    v_pk_add_f32 v[162:163], v[162:163], v[76:77]
    v_mov_b32 v72, 152476
    s_mov_b32 s58, 0
gated_mix__ssm_conv_s5__linear_kernel_hedgehog__prompt_kernel_spin133:
    ds_read_b32 v73, v72
    s_waitcnt lgkmcnt(0)
    v_readfirstlane_b32 s57, v73
    s_nop 3
    s_cmp_ge_u32 s57, 1
    s_cbranch_scc1 gated_mix__ssm_conv_s5__linear_kernel_hedgehog__prompt_kernel_spun134
    s_add_u32 s58, s58, 1
    s_cmp_ge_u32 s58, 8000000
    s_cbranch_scc1 gated_mix__ssm_conv_s5__linear_kernel_hedgehog__prompt_kernel_spun134
    s_sleep 1
    s_branch gated_mix__ssm_conv_s5__linear_kernel_hedgehog__prompt_kernel_spin133
gated_mix__ssm_conv_s5__linear_kernel_hedgehog__prompt_kernel_spun134:
    s_lshl_b32 s57, s29, 5
    s_lshl_b32 s58, s30, 2
    s_add_u32 s57, s57, s58
    s_add_u32 s57, s57, s31
    s_mul_i32 s57, s57, 5120
    s_add_u32 s57, s57, 5242880
    s_add_u32 s58, s57, 4096
    buffer_load_dwordx4 v[0:3], v80, s[8:11], s57 offen offset:0 sc1
    buffer_load_dwordx4 v[4:7], v80, s[8:11], s57 offen offset:1024 sc1
    buffer_load_dwordx4 v[8:11], v80, s[8:11], s57 offen offset:2048 sc1
    buffer_load_dwordx4 v[12:15], v80, s[8:11], s57 offen offset:3072 sc1
    buffer_load_dwordx4 v[16:19], v80, s[8:11], s58 offen sc1
    s_lshl_b32 s57, s30, 2
    s_add_u32 s57, s57, s31
    s_lshl_b32 s57, s57, 10
    s_add_u32 s57, s57, 17825792
    v_lshrrev_b32 v74, 2, v84
    v_lshlrev_b32 v74, 7, v74
    v_and_b32 v75, 1, v84
    v_lshl_add_u32 v74, v75, 4, v74
    v_bfe_u32 v75, v84, 1, 1
    v_lshl_add_u32 v74, v75, 2, v74
    v_lshrrev_b32 v75, 1, v85
    v_lshl_add_u32 v74, v75, 9, v74
    v_and_b32 v75, 1, v85
    v_lshl_add_u32 v74, v75, 3, v74
    buffer_load_dword v86, v74, s[8:11], s57 offen sc1
    v_mov_b32 v70, 152508
    v_mov_b32 v71, 1
    s_mov_b64 s[60:61], exec
    s_mov_b64 exec, 1
    ds_add_u32 v70, v71
    s_mov_b64 exec, s[60:61]
    v_cvt_pk_bf16_f32 v92, v160, v161
    v_cvt_pk_bf16_f32 v93, v162, v163
    v_lshlrev_b32 v82, 3, v87
    v_add_u32 v82, 136064, v82
    v_mov_b32 v69, 152512
    v_cmp_gt_u32 vcc, 210, v87
    s_nop 1
    v_cndmask_b32 v82, v69, v82, vcc
    ds_write_b64 v82, v[92:93]
    s_waitcnt lgkmcnt(0)
    v_mov_b32 v70, 152480
    v_mov_b32 v71, 1
    s_mov_b64 s[60:61], exec
    s_mov_b64 exec, 1
    ds_add_u32 v70, v71
    s_mov_b64 exec, s[60:61]
    v_mov_b32 v70, 152480
    s_mov_b32 s58, 0
gated_mix__ssm_conv_s5__linear_kernel_hedgehog__prompt_kernel_spin135:
    ds_read_b32 v71, v70
    s_waitcnt lgkmcnt(0)
    v_readfirstlane_b32 s57, v71
    s_nop 3
    s_cmp_ge_u32 s57, 4
    s_cbranch_scc1 gated_mix__ssm_conv_s5__linear_kernel_hedgehog__prompt_kernel_spun136
    s_add_u32 s58, s58, 1
    s_cmp_ge_u32 s58, 8000000
    s_cbranch_scc1 gated_mix__ssm_conv_s5__linear_kernel_hedgehog__prompt_kernel_spun136
    s_sleep 1
    s_branch gated_mix__ssm_conv_s5__linear_kernel_hedgehog__prompt_kernel_spin135
gated_mix__ssm_conv_s5__linear_kernel_hedgehog__prompt_kernel_spun136:
    v_lshrrev_b32 v82, 2, v84
    v_and_b32 v100, 3, v84
    v_mul_u32_u24 v100, 80, v100
    v_add_u32 v100, 136064, v100
    v_cmp_eq_u32 vcc, v82, v85
    v_mov_b32 v101, 137856
    s_nop 0
    v_cndmask_b32 v100, v101, v100, vcc
    v_mov_b32 v102, 137664
    v_cndmask_b32 v102, v101, v102, vcc
    ds_read_b128 v[104:107], v100 offset:0
    ds_read_b128 v[108:111], v100 offset:16
    ds_read_b128 v[112:115], v100 offset:32
    s_waitcnt vmcnt(1)
    ds_read_b128 v[116:119], v100 offset:48
    s_waitcnt lgkmcnt(3)
    v_mfma_f32_16x16x32_bf16 v[20:23], v[104:107], v[0:3], 0
    ds_read_b128 v[104:107], v100 offset:64
    s_waitcnt lgkmcnt(3)
    v_mfma_f32_16x16x32_bf16 v[20:23], v[108:111], v[4:7], v[20:23]
    ds_read_b128 v[108:111], v100 offset:320
    s_waitcnt lgkmcnt(3)
    v_mfma_f32_16x16x32_bf16 v[20:23], v[112:115], v[8:11], v[20:23]
    ds_read_b128 v[112:115], v100 offset:336
    s_waitcnt lgkmcnt(3)
    v_mfma_f32_16x16x32_bf16 v[20:23], v[116:119], v[12:15], v[20:23]
    ds_read_b128 v[116:119], v100 offset:352
    s_waitcnt lgkmcnt(3)
    v_mfma_f32_16x16x32_bf16 v[20:23], v[104:107], v[16:19], v[20:23]
    ds_read_b128 v[104:107], v100 offset:368
    s_waitcnt lgkmcnt(3)
    v_mfma_f32_16x16x32_bf16 v[24:27], v[108:111], v[0:3], 0
    ds_read_b128 v[108:111], v100 offset:384
    s_waitcnt lgkmcnt(3)
    v_mfma_f32_16x16x32_bf16 v[24:27], v[112:115], v[4:7], v[24:27]
    ds_read_b128 v[112:115], v100 offset:640
    s_waitcnt lgkmcnt(3)
    v_mfma_f32_16x16x32_bf16 v[24:27], v[116:119], v[8:11], v[24:27]
    ds_read_b128 v[116:119], v100 offset:656
    s_waitcnt lgkmcnt(3)
    v_mfma_f32_16x16x32_bf16 v[24:27], v[104:107], v[12:15], v[24:27]
    ds_read_b128 v[104:107], v100 offset:672
    s_waitcnt lgkmcnt(3)
    v_mfma_f32_16x16x32_bf16 v[24:27], v[108:111], v[16:19], v[24:27]
    ds_read_b128 v[108:111], v100 offset:688
    s_waitcnt lgkmcnt(3)
    v_mfma_f32_16x16x32_bf16 v[28:31], v[112:115], v[0:3], 0
    ds_read_b128 v[112:115], v100 offset:704
    s_waitcnt lgkmcnt(3)
    v_mfma_f32_16x16x32_bf16 v[28:31], v[116:119], v[4:7], v[28:31]
    ds_read_b128 v[116:119], v100 offset:960
    s_waitcnt lgkmcnt(3)
    v_mfma_f32_16x16x32_bf16 v[28:31], v[104:107], v[8:11], v[28:31]
    ds_read_b128 v[104:107], v100 offset:976
    s_waitcnt lgkmcnt(3)
    v_mfma_f32_16x16x32_bf16 v[28:31], v[108:111], v[12:15], v[28:31]
    ds_read_b128 v[108:111], v100 offset:992
    s_waitcnt lgkmcnt(3)
    v_mfma_f32_16x16x32_bf16 v[28:31], v[112:115], v[16:19], v[28:31]
    ds_read_b128 v[112:115], v100 offset:1008
    s_waitcnt lgkmcnt(3)
    v_mfma_f32_16x16x32_bf16 v[32:35], v[116:119], v[0:3], 0
    ds_read_b128 v[116:119], v100 offset:1024
    s_waitcnt lgkmcnt(3)
    v_mfma_f32_16x16x32_bf16 v[32:35], v[104:107], v[4:7], v[32:35]
    ds_read_b128 v[104:107], v100 offset:1280
    s_waitcnt lgkmcnt(3)
    v_mfma_f32_16x16x32_bf16 v[32:35], v[108:111], v[8:11], v[32:35]
    ds_read_b128 v[108:111], v100 offset:1296
    s_waitcnt lgkmcnt(3)
    v_mfma_f32_16x16x32_bf16 v[32:35], v[112:115], v[12:15], v[32:35]
    ds_read_b128 v[112:115], v100 offset:1312
    s_waitcnt lgkmcnt(3)
    v_mfma_f32_16x16x32_bf16 v[32:35], v[116:119], v[16:19], v[32:35]
    ds_read_b128 v[116:119], v100 offset:1328
    s_waitcnt lgkmcnt(3)
    v_mfma_f32_16x16x32_bf16 v[36:39], v[104:107], v[0:3], 0
    ds_read_b128 v[104:107], v100 offset:1344
    s_waitcnt lgkmcnt(3)
    v_mfma_f32_16x16x32_bf16 v[36:39], v[108:111], v[4:7], v[36:39]
    ds_read_b128 v[108:111], v102 offset:0
    s_waitcnt lgkmcnt(3)
    v_mfma_f32_16x16x32_bf16 v[36:39], v[112:115], v[8:11], v[36:39]
    ds_read_b128 v[112:115], v102 offset:16
    s_waitcnt lgkmcnt(3)
    v_mfma_f32_16x16x32_bf16 v[36:39], v[116:119], v[12:15], v[36:39]
    ds_read_b128 v[116:119], v102 offset:32
    s_waitcnt lgkmcnt(3)
    v_mfma_f32_16x16x32_bf16 v[36:39], v[104:107], v[16:19], v[36:39]
    ds_read_b128 v[104:107], v102 offset:48
    s_waitcnt lgkmcnt(3)
    v_mfma_f32_16x16x32_bf16 v[40:43], v[108:111], v[0:3], 0
    ds_read_b128 v[108:111], v102 offset:64
    s_waitcnt lgkmcnt(3)
    v_mfma_f32_16x16x32_bf16 v[40:43], v[112:115], v[4:7], v[40:43]
    s_waitcnt lgkmcnt(2)
    v_mfma_f32_16x16x32_bf16 v[40:43], v[116:119], v[8:11], v[40:43]
    s_waitcnt lgkmcnt(1)
    v_mfma_f32_16x16x32_bf16 v[40:43], v[104:107], v[12:15], v[40:43]
    s_waitcnt lgkmcnt(0)
    v_mfma_f32_16x16x32_bf16 v[40:43], v[108:111], v[16:19], v[40:43]
    s_waitcnt vmcnt(0)
    s_nop 6
    v_add_f32 v40, 0x358637bd, v40
    v_rcp_f32 v40, v40
    v_sub_f32 v86, 1.0, v86
    v_mul_f32 v40, v40, v86
    v_pk_mul_f32 v[20:21], v[20:21], v[40:41] op_sel_hi:[1,0]
    v_pk_mul_f32 v[22:23], v[22:23], v[40:41] op_sel_hi:[1,0]
    v_pk_mul_f32 v[24:25], v[24:25], v[40:41] op_sel_hi:[1,0]
    v_pk_mul_f32 v[26:27], v[26:27], v[40:41] op_sel_hi:[1,0]
    v_pk_mul_f32 v[28:29], v[28:29], v[40:41] op_sel_hi:[1,0]
    v_pk_mul_f32 v[30:31], v[30:31], v[40:41] op_sel_hi:[1,0]
    v_pk_mul_f32 v[32:33], v[32:33], v[40:41] op_sel_hi:[1,0]
    v_pk_mul_f32 v[34:35], v[34:35], v[40:41] op_sel_hi:[1,0]
    v_pk_mul_f32 v[36:37], v[36:37], v[40:41] op_sel_hi:[1,0]
    v_pk_mul_f32 v[38:39], v[38:39], v[40:41] op_sel_hi:[1,0]
    v_cvt_pk_bf16_f32 v48, v20, v21
    v_cvt_pk_bf16_f32 v49, v22, v23
    v_cvt_pk_bf16_f32 v50, v24, v25
    v_cvt_pk_bf16_f32 v51, v26, v27
    v_cvt_pk_bf16_f32 v52, v28, v29
    v_cvt_pk_bf16_f32 v53, v30, v31
    v_cvt_pk_bf16_f32 v54, v32, v33
    v_cvt_pk_bf16_f32 v55, v34, v35
    v_cvt_pk_bf16_f32 v56, v36, v37
    v_cvt_pk_bf16_f32 v57, v38, v39
    s_lshl_b32 s57, s30, 2
    s_add_u32 s57, s57, s31
    s_mul_i32 s57, s57, 81920
    s_and_b32 s58, s29, 3
    s_lshl_b32 s58, s58, 8
    s_add_u32 s57, s57, s58
    s_add_u32 s57, s57, 13631488
    v_mul_u32_u24 v82, 20480, v85
    v_lshl_add_u32 v82, v84, 4, v82
    s_lshr_b32 s58, s29, 2
    s_lshl_b32 s59, s58, 11
    s_add_u32 s59, s59, s57
    buffer_store_dwordx4 v[48:51], v82, s[8:11], s59 offen sc1
    buffer_store_dwordx4 v[52:55], v82, s[8:11], s59 offen offset:1024 sc1
    s_and_b32 s59, s58, 1
    s_lshl_b32 s59, s59, 9
    s_lshr_b32 s58, s58, 1
    s_add_u32 s58, s58, 16
    s_lshl_b32 s58, s58, 10
    s_add_u32 s59, s59, s58
    s_add_u32 s59, s59, s57
    s_and_b32 s58, s29, 3
    s_lshl_b32 s58, s58, 7
    s_sub_u32 s59, s59, s58
    v_mul_u32_u24 v81, 20480, v85
    v_lshl_add_u32 v81, v84, 3, v81
    buffer_store_dwordx2 v[56:57], v81, s[8:11], s59 offen sc1
    s_waitcnt vmcnt(0)
    v_mov_b32 v70, 152484
    v_mov_b32 v71, 1
    s_mov_b64 s[60:61], exec
    s_mov_b64 exec, 1
    ds_add_rtn_u32 v72, v70, v71
    s_waitcnt lgkmcnt(0)
    s_mov_b64 exec, s[60:61]
    v_readfirstlane_b32 s57, v72
    s_nop 3
    s_cmp_lg_u32 s57, 3
    s_cbranch_scc1 gated_mix__ssm_conv_s5__linear_kernel_hedgehog__prompt_kernel_fin
    s_lshl_b32 s57, s30, 12
    s_add_u32 s57, s57, 18087936
    s_lshl_b32 s58, s29, 7
    s_add_u32 s58, s58, s57
    v_lshlrev_b32 v70, 4, v83
    s_mov_b64 s[60:61], exec
    s_mov_b64 exec, 0xff
    buffer_store_dwordx4 v[60:63], v70, s[8:11], s58 offen sc1
    s_mov_b64 exec, s[60:61]
    s_nop 0
    v_mov_b32 v70, 152492
    s_mov_b32 s59, 0
gated_mix__ssm_conv_s5__linear_kernel_hedgehog__prompt_kernel_spin137:
    ds_read_b32 v71, v70
    s_waitcnt lgkmcnt(0)
    v_readfirstlane_b32 s58, v71
    s_nop 3
    s_cmp_ge_u32 s58, 1
    s_cbranch_scc1 gated_mix__ssm_conv_s5__linear_kernel_hedgehog__prompt_kernel_spun138
    s_add_u32 s59, s59, 1
    s_cmp_ge_u32 s59, 8000000
    s_cbranch_scc1 gated_mix__ssm_conv_s5__linear_kernel_hedgehog__prompt_kernel_spun138
    s_sleep 4
    s_branch gated_mix__ssm_conv_s5__linear_kernel_hedgehog__prompt_kernel_spin137
gated_mix__ssm_conv_s5__linear_kernel_hedgehog__prompt_kernel_spun138:
    s_lshr_b32 s57, s27, 2
    s_lshl_b32 s57, s57, 12
    s_add_u32 s57, s57, 18087936
    v_and_b32 v70, 31, v83
    v_lshlrev_b32 v70, 7, v70
    v_add_u32 v70, s57, v70
    s_mov_b32 s57, 0
gated_mix__ssm_conv_s5__linear_kernel_hedgehog__prompt_kernel_poll139:
    buffer_load_dwordx2 v[72:73], v70, s[8:11], 0 offen sc1
    s_waitcnt vmcnt(0)
    v_cmp_ne_u64 vcc, v[72:73], v[60:61]
    s_nop 3
    s_cmp_eq_u64 vcc, 0
    s_cbranch_scc1 gated_mix__ssm_conv_s5__linear_kernel_hedgehog__prompt_kernel_polled140
    s_add_u32 s57, s57, 1
    s_cmp_ge_u32 s57, 400000
    s_cbranch_scc1 gated_mix__ssm_conv_s5__linear_kernel_hedgehog__prompt_kernel_polled140
    s_sleep 8
    s_branch gated_mix__ssm_conv_s5__linear_kernel_hedgehog__prompt_kernel_poll139
gated_mix__ssm_conv_s5__linear_kernel_hedgehog__prompt_kernel_polled140:
    v_mov_b32 v72, 152488
    v_mov_b32 v73, 1
    ds_write_b32 v72, v73
    s_waitcnt lgkmcnt(0)
    s_branch gated_mix__ssm_conv_s5__linear_kernel_hedgehog__prompt_kernel_fin
gated_mix__ssm_conv_s5__linear_kernel_hedgehog__prompt_kernel_fin:
gated_mix__ssm_conv_s5__linear_kernel_hedgehog__prompt_kernel_end:
    s_endpgm
.section .rodata,"a"
.p2align 6
.amdhsa_kernel gated_mix__ssm_conv_s5__linear_kernel_hedgehog__prompt_kernel
  .amdhsa_next_free_vgpr 256
  .amdhsa_next_free_sgpr 102
  .amdhsa_accum_offset 256
  .amdhsa_group_segment_fixed_size 0
  .amdhsa_kernarg_size 136
  .amdhsa_user_sgpr_count 2
  .amdhsa_user_sgpr_kernarg_segment_ptr 1
  .amdhsa_system_sgpr_workgroup_id_x 1
  .amdhsa_float_denorm_mode_32 3
  .amdhsa_float_denorm_mode_16_64 3
.end_amdhsa_kernel
```
